```python
import torch

def _softmax(x, axis=-1):
    return torch.softmax(x, dim=axis)
def _gelu(x):
    return torch.nn.functional.gelu(x, approximate="tanh")
def _silu(x):
    return torch.nn.functional.silu(x)
def _sigmoid(x):
    return torch.sigmoid(x)
def _layernorm(x, axis=-1, eps=1e-5):
    m = x.mean(dim=axis, keepdim=True)
    v = x.var(dim=axis, keepdim=True, unbiased=False)
    return (x - m) / torch.sqrt(v + eps)
def _scatter_add(tgt, idx, src, axis=0):
    return tgt.clone().index_add_(axis, idx, src)
def _segment_sum(src, seg, n):
    out = torch.zeros((n,) + src.shape[1:], dtype=src.dtype)
    return out.index_add_(0, seg, src)
def _pad(x, pw):
    flat = tuple(v for pair in reversed(pw) for v in pair)
    return torch.nn.functional.pad(x, flat)

kernel_name = 'interleave_layers__linear_attn_block__spectral_fnet__prompt'

def setup_inputs():

    _w = (lambda a: (lambda t: t.to(torch.bfloat16) if t.is_floating_point() else t)(torch.as_tensor(a)))
    def _A_setup():
        B, S, D = 1, 2048, 1024
        return {
            "x": _w((lambda *s: torch.randn(*s, dtype=torch.bfloat16) * 0.4)(B, S, D)),
            "wqkv": _w((lambda *s: torch.randn(*s, dtype=torch.bfloat16) * 1.6)(D, 3 * D)),
            "wo": _w((lambda *s: torch.randn(*s, dtype=torch.bfloat16) * 1.6)(D, D)),
        }
    _A_in = _A_setup()

    def _B_setup():
        B, S, D = 1, 2048, 1024
        ns = torch.arange(S)[:, None] * torch.arange(S)[None, :]
        nd = torch.arange(D)[:, None] * torch.arange(D)[None, :]
        Ws_re = torch.cos(-2.0 * torch.pi * ns / S).to(float)
        Ws_im = torch.sin(-2.0 * torch.pi * ns / S).to(float)
        Wd_re = torch.cos(-2.0 * torch.pi * nd / D).to(float)
        Wd_im = torch.sin(-2.0 * torch.pi * nd / D).to(float)
        return {
            "x": _w((lambda *s: torch.randn(*s, dtype=torch.bfloat16) * 0.4)(B, S, D)),
            "dft_seq_re": _w(Ws_re),
            "dft_seq_im": _w(Ws_im),
            "dft_hid_re": _w(Wd_re),
            "dft_hid_im": _w(Wd_im),
        }
    _B_in = _B_setup()

    return {
        "A_x": _A_in["x"],
        "A_wqkv": _A_in["wqkv"],
        "A_wo": _A_in["wo"],
        "B_x": _B_in["x"],
        "B_dft_seq_re": _B_in["dft_seq_re"],
        "B_dft_seq_im": _B_in["dft_seq_im"],
        "B_dft_hid_re": _B_in["dft_hid_re"],
        "B_dft_hid_im": _B_in["dft_hid_im"],
    }

def reference(A_x, A_wqkv, A_wo, B_x, B_dft_seq_re, B_dft_seq_im, B_dft_hid_re, B_dft_hid_im):
    def _A_ref(x, wqkv, wo):
        B, S, D = x.shape
        H = 32; Dh = D // H
        qkv = (lambda x, *d: x.permute(*d))((x @ wqkv).reshape(B, S, 3, H, Dh), 2, 0, 3, 1, 4)
        q, k, v = qkv[0], qkv[1], qkv[2]
        phi = lambda t: torch.where(t > 0, t + 1, torch.exp(t)) + 1e-6
        pq, pk = phi(q), phi(k)
        kv = torch.einsum("bhsd,bhse->bhde", pk, v)
        z = torch.einsum("bhsd->bhd", pk)
        num = torch.einsum("bhqd,bhde->bhqe", pq, kv)
        den = torch.einsum("bhqd,bhd->bhq", pq, z)[..., None] + 1e-6
        o = num / den
        return (lambda x, *d: x.permute(*d))(o, 0, 2, 1, 3).reshape(B, S, D) @ wo

    def _B_ref(x, dft_seq_re, dft_seq_im, dft_hid_re, dft_hid_im):
        a = torch.einsum("bsd,ed->bse", x, dft_hid_re)
        b = torch.einsum("bsd,ed->bse", x, dft_hid_im)
        y = torch.einsum("ts,bse->bte", dft_seq_re, a) - torch.einsum("ts,bse->bte", dft_seq_im, b)
        return y

    x = A_x
    x = x + _A_ref(_layernorm(x, axis=-1), A_wqkv, A_wo)
    x = x + _B_ref(_layernorm(x, axis=-1), B_dft_seq_re, B_dft_seq_im, B_dft_hid_re, B_dft_hid_im)
    x = x + _A_ref(_layernorm(x, axis=-1), A_wqkv, A_wo)
    x = x + _B_ref(_layernorm(x, axis=-1), B_dft_seq_re, B_dft_seq_im, B_dft_hid_re, B_dft_hid_im)
    return x
```

```asm
; @launch grid=(256,1,1) block=(512,1,1) lds=163840
.amdgcn_target "amdgcn-amd-amdhsa--gfx950"
.text
.globl interleave_layers__linear_attn_block__spectral_fnet__prompt_kernel
.p2align 8
.type interleave_layers__linear_attn_block__spectral_fnet__prompt_kernel,@function
interleave_layers__linear_attn_block__spectral_fnet__prompt_kernel:
    s_cmp_ge_u32 s2, 256
    s_cbranch_scc1 L_exit
    s_load_dwordx4 s[4:7], s[0:1], 0
    s_load_dwordx2 s[8:9], s[0:1], 16
    s_load_dwordx2 s[10:11], s[0:1], 64
    s_load_dwordx4 s[12:15], s[0:1], 72
    v_lshrrev_b32 v1, 6, v0
    s_mov_b32 s40, 0
    s_mov_b32 s41, 0
    v_readfirstlane_b32 s3, v1
    v_and_b32 v1, 63, v0
    s_waitcnt lgkmcnt(0)
    s_mov_b32 s16, s4
    s_mov_b32 s17, s5
    s_mov_b32 s18, 4194304
    s_mov_b32 s19, 0x00020000
    s_mov_b32 s20, s6
    s_mov_b32 s21, s7
    s_mov_b32 s22, 6291456
    s_mov_b32 s23, 0x00020000
    s_mov_b32 s24, s8
    s_mov_b32 s25, s9
    s_mov_b32 s26, 2097152
    s_mov_b32 s27, 0x00020000
    s_mov_b32 s28, s14
    s_mov_b32 s29, s15
    s_mov_b32 s30, 50331648
    s_mov_b32 s31, 0x00020000
    s_mov_b32 s32, s10
    s_mov_b32 s33, s11
    s_mov_b32 s34, 4194304
    s_mov_b32 s35, 0x00020000
    s_mov_b32 s36, s12
    s_mov_b32 s37, s13
    s_mov_b32 s38, 256
    s_mov_b32 s39, 0x00020000
    v_lshlrev_b32 v250, 12, v1
    v_and_b32 v251, 15, v1
    v_lshlrev_b32 v251, 8, v251
    v_mov_b32 v252, 1
    s_and_b32 s74, s2, 15
    s_lshl_b32 s74, s74, 8
    s_and_b32 s75, s2, 7
    s_lshl_b32 s75, s75, 12
    s_and_b32 s44, s2, 7
    s_lshr_b32 s45, s2, 3
    s_and_b32 s42, s45, 15
    s_lshr_b32 s45, s45, 4
    s_lshl_b32 s44, s44, 1
    s_add_u32 s43, s44, s45
    s_cmp_ge_u32 s3, 4
    s_cbranch_scc1 L_r_loader_1
    s_lshr_b32 s48, s3, 1
    s_and_b32 s49, s3, 1
    s_lshl_b32 s56, s42, 7
    s_lshl_b32 s57, s43, 3
    s_add_u32 s56, s56, s57
    s_lshl_b32 s57, s3, 1
    s_add_u32 s56, s56, s57
    s_lshl_b32 s57, s56, 11
    v_lshlrev_b32 v11, 4, v1
    buffer_load_dwordx4 v[112:115], v11, s[16:19], s57 offen
    buffer_load_dwordx4 v[116:119], v11, s[16:19], s57 offen offset:1024
    s_add_u32 s57, s57, 2048
    buffer_load_dwordx4 v[120:123], v11, s[16:19], s57 offen
    buffer_load_dwordx4 v[124:127], v11, s[16:19], s57 offen offset:1024
    v_lshrrev_b32 v12, 2, v1
    s_movk_i32 s57, 6144
    v_mul_lo_u32 v12, v12, s57
    v_and_b32 v13, 3, v1
    v_lshl_add_u32 v12, v13, 4, v12
    s_add_u32 s58, s3, 4
    s_min_u32 s58, s58, 5
    s_lshr_b32 s59, s3, 1
    s_lshl_b32 s59, s59, 11
    s_and_b32 s60, s3, 1
    s_lshl_b32 s60, s60, 6
    s_add_u32 s59, s59, s60
    s_mul_i32 s60, s42, 393216
    s_add_u32 s59, s59, s60
    s_lshl_b32 s60, s43, 7
    s_add_u32 s59, s59, s60
    buffer_load_dwordx4 v[128:131], v12, s[20:23], s59 offen
    s_add_u32 s59, s59, 98304
    buffer_load_dwordx4 v[132:135], v12, s[20:23], s59 offen
    s_add_u32 s59, s59, 98304
    buffer_load_dwordx4 v[136:139], v12, s[20:23], s59 offen
    s_add_u32 s59, s59, 98304
    buffer_load_dwordx4 v[140:143], v12, s[20:23], s59 offen
    s_lshr_b32 s59, s58, 1
    s_lshl_b32 s59, s59, 11
    s_and_b32 s60, s58, 1
    s_lshl_b32 s60, s60, 6
    s_add_u32 s59, s59, s60
    s_mul_i32 s60, s42, 393216
    s_add_u32 s59, s59, s60
    s_lshl_b32 s60, s43, 7
    s_add_u32 s59, s59, s60
    buffer_load_dwordx4 v[144:147], v12, s[20:23], s59 offen
    s_add_u32 s59, s59, 98304
    buffer_load_dwordx4 v[148:151], v12, s[20:23], s59 offen
    s_add_u32 s59, s59, 98304
    buffer_load_dwordx4 v[152:155], v12, s[20:23], s59 offen
    s_add_u32 s59, s59, 98304
    buffer_load_dwordx4 v[156:159], v12, s[20:23], s59 offen
    s_cmp_lg_u32 s3, 3
    s_cbranch_scc1 L_w_3
    s_cmp_gt_u32 s2, 4
    s_cbranch_scc1 L_w_3
    s_cmp_eq_u32 s2, 4
    s_cbranch_scc1 L_rc4_4
    v_and_b32 v2, 15, v1
    v_lshrrev_b32 v3, 4, v1
    s_lshl_b32 s60, s2, 4
    v_add_u32 v4, s60, v2
    v_lshlrev_b32 v5, 3, v3
    v_add_u32 v5, 0, v5
    v_mul_u32_u24 v5, v5, v4
    v_and_b32 v5, 63, v5
    v_cvt_f32_u32 v5, v5
    v_mul_f32 v5, 0x3c800000, v5
    v_cos_f32 v6, v5
    v_sin_f32 v7, v5
    s_nop 0
    v_mul_f32 v6, 0x3e000000, v6
    v_mul_f32 v7, 0x3e000000, v7
    v_lshlrev_b32 v5, 3, v3
    v_add_u32 v5, 1, v5
    v_mul_u32_u24 v5, v5, v4
    v_and_b32 v5, 63, v5
    v_cvt_f32_u32 v5, v5
    v_mul_f32 v5, 0x3c800000, v5
    v_cos_f32 v8, v5
    v_sin_f32 v9, v5
    s_nop 0
    v_mul_f32 v8, 0x3e000000, v8
    v_mul_f32 v9, 0x3e000000, v9
    v_cvt_pk_f16_f32 v160, v6, v8
    v_cvt_pk_f16_f32 v168, v7, v9
    v_xor_b32 v176, 0x80008000, v168
    v_lshlrev_b32 v5, 3, v3
    v_add_u32 v5, 2, v5
    v_mul_u32_u24 v5, v5, v4
    v_and_b32 v5, 63, v5
    v_cvt_f32_u32 v5, v5
    v_mul_f32 v5, 0x3c800000, v5
    v_cos_f32 v6, v5
    v_sin_f32 v7, v5
    s_nop 0
    v_mul_f32 v6, 0x3e000000, v6
    v_mul_f32 v7, 0x3e000000, v7
    v_lshlrev_b32 v5, 3, v3
    v_add_u32 v5, 3, v5
    v_mul_u32_u24 v5, v5, v4
    v_and_b32 v5, 63, v5
    v_cvt_f32_u32 v5, v5
    v_mul_f32 v5, 0x3c800000, v5
    v_cos_f32 v8, v5
    v_sin_f32 v9, v5
    s_nop 0
    v_mul_f32 v8, 0x3e000000, v8
    v_mul_f32 v9, 0x3e000000, v9
    v_cvt_pk_f16_f32 v161, v6, v8
    v_cvt_pk_f16_f32 v169, v7, v9
    v_xor_b32 v177, 0x80008000, v169
    v_lshlrev_b32 v5, 3, v3
    v_add_u32 v5, 4, v5
    v_mul_u32_u24 v5, v5, v4
    v_and_b32 v5, 63, v5
    v_cvt_f32_u32 v5, v5
    v_mul_f32 v5, 0x3c800000, v5
    v_cos_f32 v6, v5
    v_sin_f32 v7, v5
    s_nop 0
    v_mul_f32 v6, 0x3e000000, v6
    v_mul_f32 v7, 0x3e000000, v7
    v_lshlrev_b32 v5, 3, v3
    v_add_u32 v5, 5, v5
    v_mul_u32_u24 v5, v5, v4
    v_and_b32 v5, 63, v5
    v_cvt_f32_u32 v5, v5
    v_mul_f32 v5, 0x3c800000, v5
    v_cos_f32 v8, v5
    v_sin_f32 v9, v5
    s_nop 0
    v_mul_f32 v8, 0x3e000000, v8
    v_mul_f32 v9, 0x3e000000, v9
    v_cvt_pk_f16_f32 v162, v6, v8
    v_cvt_pk_f16_f32 v170, v7, v9
    v_xor_b32 v178, 0x80008000, v170
    v_lshlrev_b32 v5, 3, v3
    v_add_u32 v5, 6, v5
    v_mul_u32_u24 v5, v5, v4
    v_and_b32 v5, 63, v5
    v_cvt_f32_u32 v5, v5
    v_mul_f32 v5, 0x3c800000, v5
    v_cos_f32 v6, v5
    v_sin_f32 v7, v5
    s_nop 0
    v_mul_f32 v6, 0x3e000000, v6
    v_mul_f32 v7, 0x3e000000, v7
    v_lshlrev_b32 v5, 3, v3
    v_add_u32 v5, 7, v5
    v_mul_u32_u24 v5, v5, v4
    v_and_b32 v5, 63, v5
    v_cvt_f32_u32 v5, v5
    v_mul_f32 v5, 0x3c800000, v5
    v_cos_f32 v8, v5
    v_sin_f32 v9, v5
    s_nop 0
    v_mul_f32 v8, 0x3e000000, v8
    v_mul_f32 v9, 0x3e000000, v9
    v_cvt_pk_f16_f32 v163, v6, v8
    v_cvt_pk_f16_f32 v171, v7, v9
    v_xor_b32 v179, 0x80008000, v171
    v_lshlrev_b32 v5, 3, v3
    v_add_u32 v5, 32, v5
    v_mul_u32_u24 v5, v5, v4
    v_and_b32 v5, 63, v5
    v_cvt_f32_u32 v5, v5
    v_mul_f32 v5, 0x3c800000, v5
    v_cos_f32 v6, v5
    v_sin_f32 v7, v5
    s_nop 0
    v_mul_f32 v6, 0x3e000000, v6
    v_mul_f32 v7, 0x3e000000, v7
    v_lshlrev_b32 v5, 3, v3
    v_add_u32 v5, 33, v5
    v_mul_u32_u24 v5, v5, v4
    v_and_b32 v5, 63, v5
    v_cvt_f32_u32 v5, v5
    v_mul_f32 v5, 0x3c800000, v5
    v_cos_f32 v8, v5
    v_sin_f32 v9, v5
    s_nop 0
    v_mul_f32 v8, 0x3e000000, v8
    v_mul_f32 v9, 0x3e000000, v9
    v_cvt_pk_f16_f32 v164, v6, v8
    v_cvt_pk_f16_f32 v172, v7, v9
    v_xor_b32 v180, 0x80008000, v172
    v_lshlrev_b32 v5, 3, v3
    v_add_u32 v5, 34, v5
    v_mul_u32_u24 v5, v5, v4
    v_and_b32 v5, 63, v5
    v_cvt_f32_u32 v5, v5
    v_mul_f32 v5, 0x3c800000, v5
    v_cos_f32 v6, v5
    v_sin_f32 v7, v5
    s_nop 0
    v_mul_f32 v6, 0x3e000000, v6
    v_mul_f32 v7, 0x3e000000, v7
    v_lshlrev_b32 v5, 3, v3
    v_add_u32 v5, 35, v5
    v_mul_u32_u24 v5, v5, v4
    v_and_b32 v5, 63, v5
    v_cvt_f32_u32 v5, v5
    v_mul_f32 v5, 0x3c800000, v5
    v_cos_f32 v8, v5
    v_sin_f32 v9, v5
    s_nop 0
    v_mul_f32 v8, 0x3e000000, v8
    v_mul_f32 v9, 0x3e000000, v9
    v_cvt_pk_f16_f32 v165, v6, v8
    v_cvt_pk_f16_f32 v173, v7, v9
    v_xor_b32 v181, 0x80008000, v173
    v_lshlrev_b32 v5, 3, v3
    v_add_u32 v5, 36, v5
    v_mul_u32_u24 v5, v5, v4
    v_and_b32 v5, 63, v5
    v_cvt_f32_u32 v5, v5
    v_mul_f32 v5, 0x3c800000, v5
    v_cos_f32 v6, v5
    v_sin_f32 v7, v5
    s_nop 0
    v_mul_f32 v6, 0x3e000000, v6
    v_mul_f32 v7, 0x3e000000, v7
    v_lshlrev_b32 v5, 3, v3
    v_add_u32 v5, 37, v5
    v_mul_u32_u24 v5, v5, v4
    v_and_b32 v5, 63, v5
    v_cvt_f32_u32 v5, v5
    v_mul_f32 v5, 0x3c800000, v5
    v_cos_f32 v8, v5
    v_sin_f32 v9, v5
    s_nop 0
    v_mul_f32 v8, 0x3e000000, v8
    v_mul_f32 v9, 0x3e000000, v9
    v_cvt_pk_f16_f32 v166, v6, v8
    v_cvt_pk_f16_f32 v174, v7, v9
    v_xor_b32 v182, 0x80008000, v174
    v_lshlrev_b32 v5, 3, v3
    v_add_u32 v5, 38, v5
    v_mul_u32_u24 v5, v5, v4
    v_and_b32 v5, 63, v5
    v_cvt_f32_u32 v5, v5
    v_mul_f32 v5, 0x3c800000, v5
    v_cos_f32 v6, v5
    v_sin_f32 v7, v5
    s_nop 0
    v_mul_f32 v6, 0x3e000000, v6
    v_mul_f32 v7, 0x3e000000, v7
    v_lshlrev_b32 v5, 3, v3
    v_add_u32 v5, 39, v5
    v_mul_u32_u24 v5, v5, v4
    v_and_b32 v5, 63, v5
    v_cvt_f32_u32 v5, v5
    v_mul_f32 v5, 0x3c800000, v5
    v_cos_f32 v8, v5
    v_sin_f32 v9, v5
    s_nop 0
    v_mul_f32 v8, 0x3e000000, v8
    v_mul_f32 v9, 0x3e000000, v9
    v_cvt_pk_f16_f32 v167, v6, v8
    v_cvt_pk_f16_f32 v175, v7, v9
    v_xor_b32 v183, 0x80008000, v175
    v_lshlrev_b32 v5, 2, v3
    v_add_u32 v5, 0, v5
    v_mul_u32_u24 v5, v5, v4
    v_and_b32 v5, 2047, v5
    v_cvt_f32_u32 v5, v5
    v_mul_f32 v5, 0x3a000000, v5
    v_cos_f32 v184, v5
    v_sin_f32 v192, v5
    s_nop 0
    v_lshlrev_b32 v5, 2, v3
    v_add_u32 v5, 1, v5
    v_mul_u32_u24 v5, v5, v4
    v_and_b32 v5, 2047, v5
    v_cvt_f32_u32 v5, v5
    v_mul_f32 v5, 0x3a000000, v5
    v_cos_f32 v185, v5
    v_sin_f32 v193, v5
    s_nop 0
    v_lshlrev_b32 v5, 2, v3
    v_add_u32 v5, 2, v5
    v_mul_u32_u24 v5, v5, v4
    v_and_b32 v5, 2047, v5
    v_cvt_f32_u32 v5, v5
    v_mul_f32 v5, 0x3a000000, v5
    v_cos_f32 v186, v5
    v_sin_f32 v194, v5
    s_nop 0
    v_lshlrev_b32 v5, 2, v3
    v_add_u32 v5, 3, v5
    v_mul_u32_u24 v5, v5, v4
    v_and_b32 v5, 2047, v5
    v_cvt_f32_u32 v5, v5
    v_mul_f32 v5, 0x3a000000, v5
    v_cos_f32 v187, v5
    v_sin_f32 v195, v5
    s_nop 0
    v_lshlrev_b32 v5, 2, v3
    v_add_u32 v5, 16, v5
    v_mul_u32_u24 v5, v5, v4
    v_and_b32 v5, 2047, v5
    v_cvt_f32_u32 v5, v5
    v_mul_f32 v5, 0x3a000000, v5
    v_cos_f32 v188, v5
    v_sin_f32 v196, v5
    s_nop 0
    v_lshlrev_b32 v5, 2, v3
    v_add_u32 v5, 17, v5
    v_mul_u32_u24 v5, v5, v4
    v_and_b32 v5, 2047, v5
    v_cvt_f32_u32 v5, v5
    v_mul_f32 v5, 0x3a000000, v5
    v_cos_f32 v189, v5
    v_sin_f32 v197, v5
    s_nop 0
    v_lshlrev_b32 v5, 2, v3
    v_add_u32 v5, 18, v5
    v_mul_u32_u24 v5, v5, v4
    v_and_b32 v5, 2047, v5
    v_cvt_f32_u32 v5, v5
    v_mul_f32 v5, 0x3a000000, v5
    v_cos_f32 v190, v5
    v_sin_f32 v198, v5
    s_nop 0
    v_lshlrev_b32 v5, 2, v3
    v_add_u32 v5, 19, v5
    v_mul_u32_u24 v5, v5, v4
    v_and_b32 v5, 2047, v5
    v_cvt_f32_u32 v5, v5
    v_mul_f32 v5, 0x3a000000, v5
    v_cos_f32 v191, v5
    v_sin_f32 v199, v5
    s_nop 0
    v_add_u32 v10, 0, v2
    v_lshlrev_b32 v5, 2, v3
    v_add_u32 v5, 0, v5
    v_mul_u32_u24 v5, v5, v10
    v_and_b32 v5, 31, v5
    v_cvt_f32_u32 v5, v5
    v_mul_f32 v5, 0x3d000000, v5
    v_cos_f32 v6, v5
    v_sin_f32 v7, v5
    s_nop 0
    v_mul_f32 v6, 0x3e000000, v6
    v_mul_f32 v7, 0x3e000000, v7
    v_lshlrev_b32 v5, 2, v3
    v_add_u32 v5, 1, v5
    v_mul_u32_u24 v5, v5, v10
    v_and_b32 v5, 31, v5
    v_cvt_f32_u32 v5, v5
    v_mul_f32 v5, 0x3d000000, v5
    v_cos_f32 v8, v5
    v_sin_f32 v9, v5
    s_nop 0
    v_mul_f32 v8, 0x3e000000, v8
    v_mul_f32 v9, 0x3e000000, v9
    v_cvt_pk_f16_f32 v200, v6, v8
    v_cvt_pk_f16_f32 v208, v7, v9
    v_xor_b32 v216, 0x80008000, v208
    v_lshlrev_b32 v5, 2, v3
    v_add_u32 v5, 2, v5
    v_mul_u32_u24 v5, v5, v10
    v_and_b32 v5, 31, v5
    v_cvt_f32_u32 v5, v5
    v_mul_f32 v5, 0x3d000000, v5
    v_cos_f32 v6, v5
    v_sin_f32 v7, v5
    s_nop 0
    v_mul_f32 v6, 0x3e000000, v6
    v_mul_f32 v7, 0x3e000000, v7
    v_lshlrev_b32 v5, 2, v3
    v_add_u32 v5, 3, v5
    v_mul_u32_u24 v5, v5, v10
    v_and_b32 v5, 31, v5
    v_cvt_f32_u32 v5, v5
    v_mul_f32 v5, 0x3d000000, v5
    v_cos_f32 v8, v5
    v_sin_f32 v9, v5
    s_nop 0
    v_mul_f32 v8, 0x3e000000, v8
    v_mul_f32 v9, 0x3e000000, v9
    v_cvt_pk_f16_f32 v201, v6, v8
    v_cvt_pk_f16_f32 v209, v7, v9
    v_xor_b32 v217, 0x80008000, v209
    v_lshlrev_b32 v5, 2, v3
    v_add_u32 v5, 16, v5
    v_mul_u32_u24 v5, v5, v10
    v_and_b32 v5, 31, v5
    v_cvt_f32_u32 v5, v5
    v_mul_f32 v5, 0x3d000000, v5
    v_cos_f32 v6, v5
    v_sin_f32 v7, v5
    s_nop 0
    v_mul_f32 v6, 0x3e000000, v6
    v_mul_f32 v7, 0x3e000000, v7
    v_lshlrev_b32 v5, 2, v3
    v_add_u32 v5, 17, v5
    v_mul_u32_u24 v5, v5, v10
    v_and_b32 v5, 31, v5
    v_cvt_f32_u32 v5, v5
    v_mul_f32 v5, 0x3d000000, v5
    v_cos_f32 v8, v5
    v_sin_f32 v9, v5
    s_nop 0
    v_mul_f32 v8, 0x3e000000, v8
    v_mul_f32 v9, 0x3e000000, v9
    v_cvt_pk_f16_f32 v202, v6, v8
    v_cvt_pk_f16_f32 v210, v7, v9
    v_xor_b32 v218, 0x80008000, v210
    v_lshlrev_b32 v5, 2, v3
    v_add_u32 v5, 18, v5
    v_mul_u32_u24 v5, v5, v10
    v_and_b32 v5, 31, v5
    v_cvt_f32_u32 v5, v5
    v_mul_f32 v5, 0x3d000000, v5
    v_cos_f32 v6, v5
    v_sin_f32 v7, v5
    s_nop 0
    v_mul_f32 v6, 0x3e000000, v6
    v_mul_f32 v7, 0x3e000000, v7
    v_lshlrev_b32 v5, 2, v3
    v_add_u32 v5, 19, v5
    v_mul_u32_u24 v5, v5, v10
    v_and_b32 v5, 31, v5
    v_cvt_f32_u32 v5, v5
    v_mul_f32 v5, 0x3d000000, v5
    v_cos_f32 v8, v5
    v_sin_f32 v9, v5
    s_nop 0
    v_mul_f32 v8, 0x3e000000, v8
    v_mul_f32 v9, 0x3e000000, v9
    v_cvt_pk_f16_f32 v203, v6, v8
    v_cvt_pk_f16_f32 v211, v7, v9
    v_xor_b32 v219, 0x80008000, v211
    v_add_u32 v10, 16, v2
    v_lshlrev_b32 v5, 2, v3
    v_add_u32 v5, 0, v5
    v_mul_u32_u24 v5, v5, v10
    v_and_b32 v5, 31, v5
    v_cvt_f32_u32 v5, v5
    v_mul_f32 v5, 0x3d000000, v5
    v_cos_f32 v6, v5
    v_sin_f32 v7, v5
    s_nop 0
    v_mul_f32 v6, 0x3e000000, v6
    v_mul_f32 v7, 0x3e000000, v7
    v_lshlrev_b32 v5, 2, v3
    v_add_u32 v5, 1, v5
    v_mul_u32_u24 v5, v5, v10
    v_and_b32 v5, 31, v5
    v_cvt_f32_u32 v5, v5
    v_mul_f32 v5, 0x3d000000, v5
    v_cos_f32 v8, v5
    v_sin_f32 v9, v5
    s_nop 0
    v_mul_f32 v8, 0x3e000000, v8
    v_mul_f32 v9, 0x3e000000, v9
    v_cvt_pk_f16_f32 v204, v6, v8
    v_cvt_pk_f16_f32 v212, v7, v9
    v_xor_b32 v220, 0x80008000, v212
    v_lshlrev_b32 v5, 2, v3
    v_add_u32 v5, 2, v5
    v_mul_u32_u24 v5, v5, v10
    v_and_b32 v5, 31, v5
    v_cvt_f32_u32 v5, v5
    v_mul_f32 v5, 0x3d000000, v5
    v_cos_f32 v6, v5
    v_sin_f32 v7, v5
    s_nop 0
    v_mul_f32 v6, 0x3e000000, v6
    v_mul_f32 v7, 0x3e000000, v7
    v_lshlrev_b32 v5, 2, v3
    v_add_u32 v5, 3, v5
    v_mul_u32_u24 v5, v5, v10
    v_and_b32 v5, 31, v5
    v_cvt_f32_u32 v5, v5
    v_mul_f32 v5, 0x3d000000, v5
    v_cos_f32 v8, v5
    v_sin_f32 v9, v5
    s_nop 0
    v_mul_f32 v8, 0x3e000000, v8
    v_mul_f32 v9, 0x3e000000, v9
    v_cvt_pk_f16_f32 v205, v6, v8
    v_cvt_pk_f16_f32 v213, v7, v9
    v_xor_b32 v221, 0x80008000, v213
    v_lshlrev_b32 v5, 2, v3
    v_add_u32 v5, 16, v5
    v_mul_u32_u24 v5, v5, v10
    v_and_b32 v5, 31, v5
    v_cvt_f32_u32 v5, v5
    v_mul_f32 v5, 0x3d000000, v5
    v_cos_f32 v6, v5
    v_sin_f32 v7, v5
    s_nop 0
    v_mul_f32 v6, 0x3e000000, v6
    v_mul_f32 v7, 0x3e000000, v7
    v_lshlrev_b32 v5, 2, v3
    v_add_u32 v5, 17, v5
    v_mul_u32_u24 v5, v5, v10
    v_and_b32 v5, 31, v5
    v_cvt_f32_u32 v5, v5
    v_mul_f32 v5, 0x3d000000, v5
    v_cos_f32 v8, v5
    v_sin_f32 v9, v5
    s_nop 0
    v_mul_f32 v8, 0x3e000000, v8
    v_mul_f32 v9, 0x3e000000, v9
    v_cvt_pk_f16_f32 v206, v6, v8
    v_cvt_pk_f16_f32 v214, v7, v9
    v_xor_b32 v222, 0x80008000, v214
    v_lshlrev_b32 v5, 2, v3
    v_add_u32 v5, 18, v5
    v_mul_u32_u24 v5, v5, v10
    v_and_b32 v5, 31, v5
    v_cvt_f32_u32 v5, v5
    v_mul_f32 v5, 0x3d000000, v5
    v_cos_f32 v6, v5
    v_sin_f32 v7, v5
    s_nop 0
    v_mul_f32 v6, 0x3e000000, v6
    v_mul_f32 v7, 0x3e000000, v7
    v_lshlrev_b32 v5, 2, v3
    v_add_u32 v5, 19, v5
    v_mul_u32_u24 v5, v5, v10
    v_and_b32 v5, 31, v5
    v_cvt_f32_u32 v5, v5
    v_mul_f32 v5, 0x3d000000, v5
    v_cos_f32 v8, v5
    v_sin_f32 v9, v5
    s_nop 0
    v_mul_f32 v8, 0x3e000000, v8
    v_mul_f32 v9, 0x3e000000, v9
    v_cvt_pk_f16_f32 v207, v6, v8
    v_cvt_pk_f16_f32 v215, v7, v9
    v_xor_b32 v223, 0x80008000, v215
    s_lshl_b32 s45, s2, 14
    s_add_u32 s45, s45, 262144
    v_lshlrev_b32 v2, 4, v1
    buffer_store_dwordx4 v[160:163], v2, s[28:31], s45 offen offset:0 sc1
    buffer_store_dwordx4 v[164:167], v2, s[28:31], s45 offen offset:1024 sc1
    buffer_store_dwordx4 v[168:171], v2, s[28:31], s45 offen offset:2048 sc1
    buffer_store_dwordx4 v[172:175], v2, s[28:31], s45 offen offset:3072 sc1
    s_add_u32 s45, s45, 4096
    buffer_store_dwordx4 v[176:179], v2, s[28:31], s45 offen offset:0 sc1
    buffer_store_dwordx4 v[180:183], v2, s[28:31], s45 offen offset:1024 sc1
    buffer_store_dwordx4 v[184:187], v2, s[28:31], s45 offen offset:2048 sc1
    buffer_store_dwordx4 v[188:191], v2, s[28:31], s45 offen offset:3072 sc1
    s_add_u32 s45, s45, 4096
    buffer_store_dwordx4 v[192:195], v2, s[28:31], s45 offen offset:0 sc1
    buffer_store_dwordx4 v[196:199], v2, s[28:31], s45 offen offset:1024 sc1
    buffer_store_dwordx4 v[200:203], v2, s[28:31], s45 offen offset:2048 sc1
    buffer_store_dwordx4 v[204:207], v2, s[28:31], s45 offen offset:3072 sc1
    s_add_u32 s45, s45, 4096
    buffer_store_dwordx4 v[208:211], v2, s[28:31], s45 offen offset:0 sc1
    buffer_store_dwordx4 v[212:215], v2, s[28:31], s45 offen offset:1024 sc1
    buffer_store_dwordx4 v[216:219], v2, s[28:31], s45 offen offset:2048 sc1
    buffer_store_dwordx4 v[220:223], v2, s[28:31], s45 offen offset:3072 sc1
    s_waitcnt vmcnt(0)
    s_branch L_w_3
L_rc4_4:
    v_and_b32 v2, 31, v1
    v_lshrrev_b32 v3, 5, v1
    v_and_b32 v4, 1, v2
    v_lshlrev_b32 v4, 31, v4
    v_or_b32 v4, 0x3f800000, v4
    v_lshlrev_b32 v5, 3, v3
    v_add_u32 v5, 0, v5
    v_mul_u32_u24 v5, v5, v2
    v_and_b32 v5, 31, v5
    v_cvt_f32_u32 v5, v5
    v_mul_f32 v5, 0x3d000000, v5
    v_cos_f32 v6, v5
    v_sin_f32 v7, v5
    s_nop 0
    v_mul_f32 v6, 0x3d800000, v6
    v_mul_f32 v7, 0x3d800000, v7
    v_fma_f32 v8, -v4, v7, v6
    v_fma_f32 v9, v4, v6, v7
    v_sub_f32 v9, 0, v9
    v_fma_f32 v10, v4, v7, v6
    v_fma_f32 v11, v4, v6, -v7
    v_lshlrev_b32 v5, 3, v3
    v_add_u32 v5, 1, v5
    v_mul_u32_u24 v5, v5, v2
    v_and_b32 v5, 31, v5
    v_cvt_f32_u32 v5, v5
    v_mul_f32 v5, 0x3d000000, v5
    v_cos_f32 v6, v5
    v_sin_f32 v7, v5
    s_nop 0
    v_mul_f32 v6, 0x3d800000, v6
    v_mul_f32 v7, 0x3d800000, v7
    v_fma_f32 v12, -v4, v7, v6
    v_fma_f32 v13, v4, v6, v7
    v_sub_f32 v13, 0, v13
    v_fma_f32 v14, v4, v7, v6
    v_fma_f32 v15, v4, v6, -v7
    v_cvt_pk_f16_f32 v160, v8, v12
    v_cvt_pk_f16_f32 v164, v9, v13
    v_cvt_pk_f16_f32 v172, v10, v14
    v_cvt_pk_f16_f32 v176, v11, v15
    v_xor_b32 v168, 0x80008000, v164
    v_xor_b32 v180, 0x80008000, v172
    v_lshlrev_b32 v5, 3, v3
    v_add_u32 v5, 2, v5
    v_mul_u32_u24 v5, v5, v2
    v_and_b32 v5, 31, v5
    v_cvt_f32_u32 v5, v5
    v_mul_f32 v5, 0x3d000000, v5
    v_cos_f32 v6, v5
    v_sin_f32 v7, v5
    s_nop 0
    v_mul_f32 v6, 0x3d800000, v6
    v_mul_f32 v7, 0x3d800000, v7
    v_fma_f32 v8, -v4, v7, v6
    v_fma_f32 v9, v4, v6, v7
    v_sub_f32 v9, 0, v9
    v_fma_f32 v10, v4, v7, v6
    v_fma_f32 v11, v4, v6, -v7
    v_lshlrev_b32 v5, 3, v3
    v_add_u32 v5, 3, v5
    v_mul_u32_u24 v5, v5, v2
    v_and_b32 v5, 31, v5
    v_cvt_f32_u32 v5, v5
    v_mul_f32 v5, 0x3d000000, v5
    v_cos_f32 v6, v5
    v_sin_f32 v7, v5
    s_nop 0
    v_mul_f32 v6, 0x3d800000, v6
    v_mul_f32 v7, 0x3d800000, v7
    v_fma_f32 v12, -v4, v7, v6
    v_fma_f32 v13, v4, v6, v7
    v_sub_f32 v13, 0, v13
    v_fma_f32 v14, v4, v7, v6
    v_fma_f32 v15, v4, v6, -v7
    v_cvt_pk_f16_f32 v161, v8, v12
    v_cvt_pk_f16_f32 v165, v9, v13
    v_cvt_pk_f16_f32 v173, v10, v14
    v_cvt_pk_f16_f32 v177, v11, v15
    v_xor_b32 v169, 0x80008000, v165
    v_xor_b32 v181, 0x80008000, v173
    v_lshlrev_b32 v5, 3, v3
    v_add_u32 v5, 4, v5
    v_mul_u32_u24 v5, v5, v2
    v_and_b32 v5, 31, v5
    v_cvt_f32_u32 v5, v5
    v_mul_f32 v5, 0x3d000000, v5
    v_cos_f32 v6, v5
    v_sin_f32 v7, v5
    s_nop 0
    v_mul_f32 v6, 0x3d800000, v6
    v_mul_f32 v7, 0x3d800000, v7
    v_fma_f32 v8, -v4, v7, v6
    v_fma_f32 v9, v4, v6, v7
    v_sub_f32 v9, 0, v9
    v_fma_f32 v10, v4, v7, v6
    v_fma_f32 v11, v4, v6, -v7
    v_lshlrev_b32 v5, 3, v3
    v_add_u32 v5, 5, v5
    v_mul_u32_u24 v5, v5, v2
    v_and_b32 v5, 31, v5
    v_cvt_f32_u32 v5, v5
    v_mul_f32 v5, 0x3d000000, v5
    v_cos_f32 v6, v5
    v_sin_f32 v7, v5
    s_nop 0
    v_mul_f32 v6, 0x3d800000, v6
    v_mul_f32 v7, 0x3d800000, v7
    v_fma_f32 v12, -v4, v7, v6
    v_fma_f32 v13, v4, v6, v7
    v_sub_f32 v13, 0, v13
    v_fma_f32 v14, v4, v7, v6
    v_fma_f32 v15, v4, v6, -v7
    v_cvt_pk_f16_f32 v162, v8, v12
    v_cvt_pk_f16_f32 v166, v9, v13
    v_cvt_pk_f16_f32 v174, v10, v14
    v_cvt_pk_f16_f32 v178, v11, v15
    v_xor_b32 v170, 0x80008000, v166
    v_xor_b32 v182, 0x80008000, v174
    v_lshlrev_b32 v5, 3, v3
    v_add_u32 v5, 6, v5
    v_mul_u32_u24 v5, v5, v2
    v_and_b32 v5, 31, v5
    v_cvt_f32_u32 v5, v5
    v_mul_f32 v5, 0x3d000000, v5
    v_cos_f32 v6, v5
    v_sin_f32 v7, v5
    s_nop 0
    v_mul_f32 v6, 0x3d800000, v6
    v_mul_f32 v7, 0x3d800000, v7
    v_fma_f32 v8, -v4, v7, v6
    v_fma_f32 v9, v4, v6, v7
    v_sub_f32 v9, 0, v9
    v_fma_f32 v10, v4, v7, v6
    v_fma_f32 v11, v4, v6, -v7
    v_lshlrev_b32 v5, 3, v3
    v_add_u32 v5, 7, v5
    v_mul_u32_u24 v5, v5, v2
    v_and_b32 v5, 31, v5
    v_cvt_f32_u32 v5, v5
    v_mul_f32 v5, 0x3d000000, v5
    v_cos_f32 v6, v5
    v_sin_f32 v7, v5
    s_nop 0
    v_mul_f32 v6, 0x3d800000, v6
    v_mul_f32 v7, 0x3d800000, v7
    v_fma_f32 v12, -v4, v7, v6
    v_fma_f32 v13, v4, v6, v7
    v_sub_f32 v13, 0, v13
    v_fma_f32 v14, v4, v7, v6
    v_fma_f32 v15, v4, v6, -v7
    v_cvt_pk_f16_f32 v163, v8, v12
    v_cvt_pk_f16_f32 v167, v9, v13
    v_cvt_pk_f16_f32 v175, v10, v14
    v_cvt_pk_f16_f32 v179, v11, v15
    v_xor_b32 v171, 0x80008000, v167
    v_xor_b32 v183, 0x80008000, v175
    v_lshlrev_b32 v5, 2, v3
    v_add_u32 v5, 0, v5
    v_mul_u32_u24 v5, v5, v2
    v_and_b32 v5, 1023, v5
    v_cvt_f32_u32 v5, v5
    v_mul_f32 v5, 0x3a800000, v5
    v_cos_f32 v184, v5
    v_sin_f32 v200, v5
    s_nop 0
    v_lshlrev_b32 v5, 2, v3
    v_add_u32 v5, 1, v5
    v_mul_u32_u24 v5, v5, v2
    v_and_b32 v5, 1023, v5
    v_cvt_f32_u32 v5, v5
    v_mul_f32 v5, 0x3a800000, v5
    v_cos_f32 v185, v5
    v_sin_f32 v201, v5
    s_nop 0
    v_lshlrev_b32 v5, 2, v3
    v_add_u32 v5, 2, v5
    v_mul_u32_u24 v5, v5, v2
    v_and_b32 v5, 1023, v5
    v_cvt_f32_u32 v5, v5
    v_mul_f32 v5, 0x3a800000, v5
    v_cos_f32 v186, v5
    v_sin_f32 v202, v5
    s_nop 0
    v_lshlrev_b32 v5, 2, v3
    v_add_u32 v5, 3, v5
    v_mul_u32_u24 v5, v5, v2
    v_and_b32 v5, 1023, v5
    v_cvt_f32_u32 v5, v5
    v_mul_f32 v5, 0x3a800000, v5
    v_cos_f32 v187, v5
    v_sin_f32 v203, v5
    s_nop 0
    v_lshlrev_b32 v5, 2, v3
    v_add_u32 v5, 8, v5
    v_mul_u32_u24 v5, v5, v2
    v_and_b32 v5, 1023, v5
    v_cvt_f32_u32 v5, v5
    v_mul_f32 v5, 0x3a800000, v5
    v_cos_f32 v188, v5
    v_sin_f32 v204, v5
    s_nop 0
    v_lshlrev_b32 v5, 2, v3
    v_add_u32 v5, 9, v5
    v_mul_u32_u24 v5, v5, v2
    v_and_b32 v5, 1023, v5
    v_cvt_f32_u32 v5, v5
    v_mul_f32 v5, 0x3a800000, v5
    v_cos_f32 v189, v5
    v_sin_f32 v205, v5
    s_nop 0
    v_lshlrev_b32 v5, 2, v3
    v_add_u32 v5, 10, v5
    v_mul_u32_u24 v5, v5, v2
    v_and_b32 v5, 1023, v5
    v_cvt_f32_u32 v5, v5
    v_mul_f32 v5, 0x3a800000, v5
    v_cos_f32 v190, v5
    v_sin_f32 v206, v5
    s_nop 0
    v_lshlrev_b32 v5, 2, v3
    v_add_u32 v5, 11, v5
    v_mul_u32_u24 v5, v5, v2
    v_and_b32 v5, 1023, v5
    v_cvt_f32_u32 v5, v5
    v_mul_f32 v5, 0x3a800000, v5
    v_cos_f32 v191, v5
    v_sin_f32 v207, v5
    s_nop 0
    v_lshlrev_b32 v5, 2, v3
    v_add_u32 v5, 16, v5
    v_mul_u32_u24 v5, v5, v2
    v_and_b32 v5, 1023, v5
    v_cvt_f32_u32 v5, v5
    v_mul_f32 v5, 0x3a800000, v5
    v_cos_f32 v192, v5
    v_sin_f32 v208, v5
    s_nop 0
    v_lshlrev_b32 v5, 2, v3
    v_add_u32 v5, 17, v5
    v_mul_u32_u24 v5, v5, v2
    v_and_b32 v5, 1023, v5
    v_cvt_f32_u32 v5, v5
    v_mul_f32 v5, 0x3a800000, v5
    v_cos_f32 v193, v5
    v_sin_f32 v209, v5
    s_nop 0
    v_lshlrev_b32 v5, 2, v3
    v_add_u32 v5, 18, v5
    v_mul_u32_u24 v5, v5, v2
    v_and_b32 v5, 1023, v5
    v_cvt_f32_u32 v5, v5
    v_mul_f32 v5, 0x3a800000, v5
    v_cos_f32 v194, v5
    v_sin_f32 v210, v5
    s_nop 0
    v_lshlrev_b32 v5, 2, v3
    v_add_u32 v5, 19, v5
    v_mul_u32_u24 v5, v5, v2
    v_and_b32 v5, 1023, v5
    v_cvt_f32_u32 v5, v5
    v_mul_f32 v5, 0x3a800000, v5
    v_cos_f32 v195, v5
    v_sin_f32 v211, v5
    s_nop 0
    v_lshlrev_b32 v5, 2, v3
    v_add_u32 v5, 24, v5
    v_mul_u32_u24 v5, v5, v2
    v_and_b32 v5, 1023, v5
    v_cvt_f32_u32 v5, v5
    v_mul_f32 v5, 0x3a800000, v5
    v_cos_f32 v196, v5
    v_sin_f32 v212, v5
    s_nop 0
    v_lshlrev_b32 v5, 2, v3
    v_add_u32 v5, 25, v5
    v_mul_u32_u24 v5, v5, v2
    v_and_b32 v5, 1023, v5
    v_cvt_f32_u32 v5, v5
    v_mul_f32 v5, 0x3a800000, v5
    v_cos_f32 v197, v5
    v_sin_f32 v213, v5
    s_nop 0
    v_lshlrev_b32 v5, 2, v3
    v_add_u32 v5, 26, v5
    v_mul_u32_u24 v5, v5, v2
    v_and_b32 v5, 1023, v5
    v_cvt_f32_u32 v5, v5
    v_mul_f32 v5, 0x3a800000, v5
    v_cos_f32 v198, v5
    v_sin_f32 v214, v5
    s_nop 0
    v_lshlrev_b32 v5, 2, v3
    v_add_u32 v5, 27, v5
    v_mul_u32_u24 v5, v5, v2
    v_and_b32 v5, 1023, v5
    v_cvt_f32_u32 v5, v5
    v_mul_f32 v5, 0x3a800000, v5
    v_cos_f32 v199, v5
    v_sin_f32 v215, v5
    s_nop 0
    v_lshlrev_b32 v5, 2, v3
    v_add_u32 v5, 0, v5
    v_mul_u32_u24 v5, v5, v2
    v_and_b32 v5, 31, v5
    v_cvt_f32_u32 v5, v5
    v_mul_f32 v5, 0x3d000000, v5
    v_cos_f32 v6, v5
    v_sin_f32 v7, v5
    s_nop 0
    v_lshlrev_b32 v5, 2, v3
    v_add_u32 v5, 1, v5
    v_mul_u32_u24 v5, v5, v2
    v_and_b32 v5, 31, v5
    v_cvt_f32_u32 v5, v5
    v_mul_f32 v5, 0x3d000000, v5
    v_cos_f32 v8, v5
    v_sin_f32 v9, v5
    s_nop 0
    v_cvt_pk_f16_f32 v216, v6, v8
    v_cvt_pk_f16_f32 v224, v7, v9
    v_lshlrev_b32 v5, 2, v3
    v_add_u32 v5, 2, v5
    v_mul_u32_u24 v5, v5, v2
    v_and_b32 v5, 31, v5
    v_cvt_f32_u32 v5, v5
    v_mul_f32 v5, 0x3d000000, v5
    v_cos_f32 v6, v5
    v_sin_f32 v7, v5
    s_nop 0
    v_lshlrev_b32 v5, 2, v3
    v_add_u32 v5, 3, v5
    v_mul_u32_u24 v5, v5, v2
    v_and_b32 v5, 31, v5
    v_cvt_f32_u32 v5, v5
    v_mul_f32 v5, 0x3d000000, v5
    v_cos_f32 v8, v5
    v_sin_f32 v9, v5
    s_nop 0
    v_cvt_pk_f16_f32 v217, v6, v8
    v_cvt_pk_f16_f32 v225, v7, v9
    v_lshlrev_b32 v5, 2, v3
    v_add_u32 v5, 8, v5
    v_mul_u32_u24 v5, v5, v2
    v_and_b32 v5, 31, v5
    v_cvt_f32_u32 v5, v5
    v_mul_f32 v5, 0x3d000000, v5
    v_cos_f32 v6, v5
    v_sin_f32 v7, v5
    s_nop 0
    v_lshlrev_b32 v5, 2, v3
    v_add_u32 v5, 9, v5
    v_mul_u32_u24 v5, v5, v2
    v_and_b32 v5, 31, v5
    v_cvt_f32_u32 v5, v5
    v_mul_f32 v5, 0x3d000000, v5
    v_cos_f32 v8, v5
    v_sin_f32 v9, v5
    s_nop 0
    v_cvt_pk_f16_f32 v218, v6, v8
    v_cvt_pk_f16_f32 v226, v7, v9
    v_lshlrev_b32 v5, 2, v3
    v_add_u32 v5, 10, v5
    v_mul_u32_u24 v5, v5, v2
    v_and_b32 v5, 31, v5
    v_cvt_f32_u32 v5, v5
    v_mul_f32 v5, 0x3d000000, v5
    v_cos_f32 v6, v5
    v_sin_f32 v7, v5
    s_nop 0
    v_lshlrev_b32 v5, 2, v3
    v_add_u32 v5, 11, v5
    v_mul_u32_u24 v5, v5, v2
    v_and_b32 v5, 31, v5
    v_cvt_f32_u32 v5, v5
    v_mul_f32 v5, 0x3d000000, v5
    v_cos_f32 v8, v5
    v_sin_f32 v9, v5
    s_nop 0
    v_cvt_pk_f16_f32 v219, v6, v8
    v_cvt_pk_f16_f32 v227, v7, v9
    v_lshlrev_b32 v5, 2, v3
    v_add_u32 v5, 16, v5
    v_mul_u32_u24 v5, v5, v2
    v_and_b32 v5, 31, v5
    v_cvt_f32_u32 v5, v5
    v_mul_f32 v5, 0x3d000000, v5
    v_cos_f32 v6, v5
    v_sin_f32 v7, v5
    s_nop 0
    v_lshlrev_b32 v5, 2, v3
    v_add_u32 v5, 17, v5
    v_mul_u32_u24 v5, v5, v2
    v_and_b32 v5, 31, v5
    v_cvt_f32_u32 v5, v5
    v_mul_f32 v5, 0x3d000000, v5
    v_cos_f32 v8, v5
    v_sin_f32 v9, v5
    s_nop 0
    v_cvt_pk_f16_f32 v220, v6, v8
    v_cvt_pk_f16_f32 v228, v7, v9
    v_lshlrev_b32 v5, 2, v3
    v_add_u32 v5, 18, v5
    v_mul_u32_u24 v5, v5, v2
    v_and_b32 v5, 31, v5
    v_cvt_f32_u32 v5, v5
    v_mul_f32 v5, 0x3d000000, v5
    v_cos_f32 v6, v5
    v_sin_f32 v7, v5
    s_nop 0
    v_lshlrev_b32 v5, 2, v3
    v_add_u32 v5, 19, v5
    v_mul_u32_u24 v5, v5, v2
    v_and_b32 v5, 31, v5
    v_cvt_f32_u32 v5, v5
    v_mul_f32 v5, 0x3d000000, v5
    v_cos_f32 v8, v5
    v_sin_f32 v9, v5
    s_nop 0
    v_cvt_pk_f16_f32 v221, v6, v8
    v_cvt_pk_f16_f32 v229, v7, v9
    v_lshlrev_b32 v5, 2, v3
    v_add_u32 v5, 24, v5
    v_mul_u32_u24 v5, v5, v2
    v_and_b32 v5, 31, v5
    v_cvt_f32_u32 v5, v5
    v_mul_f32 v5, 0x3d000000, v5
    v_cos_f32 v6, v5
    v_sin_f32 v7, v5
    s_nop 0
    v_lshlrev_b32 v5, 2, v3
    v_add_u32 v5, 25, v5
    v_mul_u32_u24 v5, v5, v2
    v_and_b32 v5, 31, v5
    v_cvt_f32_u32 v5, v5
    v_mul_f32 v5, 0x3d000000, v5
    v_cos_f32 v8, v5
    v_sin_f32 v9, v5
    s_nop 0
    v_cvt_pk_f16_f32 v222, v6, v8
    v_cvt_pk_f16_f32 v230, v7, v9
    v_lshlrev_b32 v5, 2, v3
    v_add_u32 v5, 26, v5
    v_mul_u32_u24 v5, v5, v2
    v_and_b32 v5, 31, v5
    v_cvt_f32_u32 v5, v5
    v_mul_f32 v5, 0x3d000000, v5
    v_cos_f32 v6, v5
    v_sin_f32 v7, v5
    s_nop 0
    v_lshlrev_b32 v5, 2, v3
    v_add_u32 v5, 27, v5
    v_mul_u32_u24 v5, v5, v2
    v_and_b32 v5, 31, v5
    v_cvt_f32_u32 v5, v5
    v_mul_f32 v5, 0x3d000000, v5
    v_cos_f32 v8, v5
    v_sin_f32 v9, v5
    s_nop 0
    v_cvt_pk_f16_f32 v223, v6, v8
    v_cvt_pk_f16_f32 v231, v7, v9
    s_mov_b32 s45, 327680
    v_lshlrev_b32 v2, 4, v1
    buffer_store_dwordx4 v[160:163], v2, s[28:31], s45 offen offset:0 sc1
    buffer_store_dwordx4 v[164:167], v2, s[28:31], s45 offen offset:1024 sc1
    buffer_store_dwordx4 v[168:171], v2, s[28:31], s45 offen offset:2048 sc1
    buffer_store_dwordx4 v[172:175], v2, s[28:31], s45 offen offset:3072 sc1
    s_add_u32 s45, s45, 4096
    buffer_store_dwordx4 v[176:179], v2, s[28:31], s45 offen offset:0 sc1
    buffer_store_dwordx4 v[180:183], v2, s[28:31], s45 offen offset:1024 sc1
    buffer_store_dwordx4 v[184:187], v2, s[28:31], s45 offen offset:2048 sc1
    buffer_store_dwordx4 v[188:191], v2, s[28:31], s45 offen offset:3072 sc1
    s_add_u32 s45, s45, 4096
    buffer_store_dwordx4 v[192:195], v2, s[28:31], s45 offen offset:0 sc1
    buffer_store_dwordx4 v[196:199], v2, s[28:31], s45 offen offset:1024 sc1
    buffer_store_dwordx4 v[200:203], v2, s[28:31], s45 offen offset:2048 sc1
    buffer_store_dwordx4 v[204:207], v2, s[28:31], s45 offen offset:3072 sc1
    s_add_u32 s45, s45, 4096
    buffer_store_dwordx4 v[208:211], v2, s[28:31], s45 offen offset:0 sc1
    buffer_store_dwordx4 v[212:215], v2, s[28:31], s45 offen offset:1024 sc1
    buffer_store_dwordx4 v[216:219], v2, s[28:31], s45 offen offset:2048 sc1
    buffer_store_dwordx4 v[220:223], v2, s[28:31], s45 offen offset:3072 sc1
    s_add_u32 s45, s45, 4096
    buffer_store_dwordx4 v[224:227], v2, s[28:31], s45 offen offset:0 sc1
    buffer_store_dwordx4 v[228:231], v2, s[28:31], s45 offen offset:1024 sc1
    s_waitcnt vmcnt(0)
L_w_3:
    v_and_b32 v5, 15, v1
    v_lshrrev_b32 v6, 4, v1
    v_bfe_u32 v7, v1, 1, 3
    v_lshlrev_b32 v8, 7, v5
    s_lshl_b32 s50, s48, 13
    v_add_u32 v8, s50, v8
    v_add_u32 v9, 0, v6
    v_xor_b32 v9, v9, v7
    v_lshl_add_u32 v192, v9, 4, v8
    v_add_u32 v9, 4, v6
    v_xor_b32 v9, v9, v7
    v_lshl_add_u32 v193, v9, 4, v8
    v_bfe_u32 v5, v1, 2, 2
    v_and_b32 v7, 3, v1
    v_lshlrev_b32 v10, 7, v5
    v_lshl_add_u32 v10, v6, 10, v10
    v_lshl_add_u32 v10, v7, 3, v10
    v_lshrrev_b32 v5, 1, v5
    v_and_b32 v9, 1, v6
    v_lshl_add_u32 v5, v9, 1, v5
    s_lshl_b32 s50, s49, 1
    v_xor_b32 v5, s50, v5
    v_xor_b32 v9, 0, v5
    v_lshl_add_u32 v194, v9, 5, v10
    v_add_u32 v194, 65536, v194
    v_add_u32 v195, 49152, v194
    v_xor_b32 v9, 1, v5
    v_lshl_add_u32 v196, v9, 5, v10
    v_add_u32 v196, 65536, v196
    v_add_u32 v197, 49152, v196
    v_mov_b32 v16, 0
    v_mov_b32 v17, 0
    v_mov_b32 v18, 0
    v_mov_b32 v19, 0
    v_mov_b32 v20, 0
    v_mov_b32 v21, 0
    v_mov_b32 v22, 0
    v_mov_b32 v23, 0
    v_mov_b32 v24, 0
    v_mov_b32 v25, 0
    v_mov_b32 v26, 0
    v_mov_b32 v27, 0
    v_mov_b32 v28, 0
    v_mov_b32 v29, 0
    v_mov_b32 v30, 0
    v_mov_b32 v31, 0
    v_mov_b32 v32, 0
    v_mov_b32 v33, 0
    v_mov_b32 v34, 0
    v_mov_b32 v35, 0
    v_mov_b32 v36, 0
    v_mov_b32 v37, 0
    v_mov_b32 v38, 0
    v_mov_b32 v39, 0
    v_mov_b32 v40, 0
    v_mov_b32 v41, 0
    v_mov_b32 v42, 0
    v_mov_b32 v43, 0
    v_mov_b32 v44, 0
    v_mov_b32 v45, 0
    v_mov_b32 v46, 0
    v_mov_b32 v47, 0
    v_mov_b32 v48, 0
    v_mov_b32 v49, 0
    v_mov_b32 v50, 0
    v_mov_b32 v51, 0
    v_mov_b32 v52, 0
    v_mov_b32 v53, 0
    v_mov_b32 v54, 0
    v_mov_b32 v55, 0
    v_mov_b32 v56, 0
    v_mov_b32 v57, 0
    v_mov_b32 v58, 0
    v_mov_b32 v59, 0
    v_mov_b32 v60, 0
    v_mov_b32 v61, 0
    v_mov_b32 v62, 0
    v_mov_b32 v63, 0
    v_mov_b32 v64, 0
    v_mov_b32 v65, 0
    v_mov_b32 v66, 0
    v_mov_b32 v67, 0
    v_mov_b32 v68, 0
    v_mov_b32 v69, 0
    v_mov_b32 v70, 0
    v_mov_b32 v71, 0
    v_mov_b32 v72, 0
    v_mov_b32 v73, 0
    v_mov_b32 v74, 0
    v_mov_b32 v75, 0
    v_mov_b32 v76, 0
    v_mov_b32 v77, 0
    v_mov_b32 v78, 0
    v_mov_b32 v79, 0
    v_mov_b32 v80, 0
    v_mov_b32 v81, 0
    v_mov_b32 v82, 0
    v_mov_b32 v83, 0
    v_mov_b32 v84, 0
    v_mov_b32 v85, 0
    v_mov_b32 v86, 0
    v_mov_b32 v87, 0
    v_mov_b32 v88, 0
    v_mov_b32 v89, 0
    v_mov_b32 v90, 0
    v_mov_b32 v91, 0
    v_mov_b32 v92, 0
    v_mov_b32 v93, 0
    v_mov_b32 v94, 0
    v_mov_b32 v95, 0
    v_mov_b32 v96, 0
    v_mov_b32 v97, 0
    v_mov_b32 v98, 0
    v_mov_b32 v99, 0
    v_mov_b32 v100, 0
    v_mov_b32 v101, 0
    v_mov_b32 v102, 0
    v_mov_b32 v103, 0
    v_mov_b32 v104, 0
    v_mov_b32 v105, 0
    v_mov_b32 v106, 0
    v_mov_b32 v107, 0
    v_mov_b32 v108, 0
    v_mov_b32 v109, 0
    v_mov_b32 v110, 0
    v_mov_b32 v111, 0
    v_mov_b32 v14, 0x3f803f80
    v_mov_b32 v15, 0x00003f80
    v_mov_b32 v10, 0x3f800000
    v_mov_b32 v160, 0
    v_mov_b32 v161, 0
    v_mov_b32 v162, 0
    v_mov_b32 v163, 0
    v_mov_b32 v168, 0
    v_mov_b32 v169, 0
    v_mov_b32 v170, 0
    v_mov_b32 v171, 0
    v_mov_b32 v172, 0
    v_mov_b32 v173, 0
    v_mov_b32 v174, 0
    v_mov_b32 v175, 0
    v_mov_b32 v176, 0
    v_mov_b32 v177, 0
    v_mov_b32 v178, 0
    v_mov_b32 v179, 0
    v_mov_b32 v180, 0
    v_mov_b32 v181, 0
    v_mov_b32 v182, 0
    v_mov_b32 v183, 0
    s_waitcnt vmcnt(0)
    v_dot2_f32_bf16 v160, v112, v14, v160
    v_dot2_f32_bf16 v162, v112, v112, v162
    v_dot2_f32_bf16 v161, v120, v14, v161
    v_dot2_f32_bf16 v163, v120, v120, v163
    v_dot2_f32_bf16 v160, v113, v14, v160
    v_dot2_f32_bf16 v162, v113, v113, v162
    v_dot2_f32_bf16 v161, v121, v14, v161
    v_dot2_f32_bf16 v163, v121, v121, v163
    v_dot2_f32_bf16 v160, v114, v14, v160
    v_dot2_f32_bf16 v162, v114, v114, v162
    v_dot2_f32_bf16 v161, v122, v14, v161
    v_dot2_f32_bf16 v163, v122, v122, v163
    v_dot2_f32_bf16 v160, v115, v14, v160
    v_dot2_f32_bf16 v162, v115, v115, v162
    v_dot2_f32_bf16 v161, v123, v14, v161
    v_dot2_f32_bf16 v163, v123, v123, v163
    v_dot2_f32_bf16 v160, v116, v14, v160
    v_dot2_f32_bf16 v162, v116, v116, v162
    v_dot2_f32_bf16 v161, v124, v14, v161
    v_dot2_f32_bf16 v163, v124, v124, v163
    v_dot2_f32_bf16 v160, v117, v14, v160
    v_dot2_f32_bf16 v162, v117, v117, v162
    v_dot2_f32_bf16 v161, v125, v14, v161
    v_dot2_f32_bf16 v163, v125, v125, v163
    v_dot2_f32_bf16 v160, v118, v14, v160
    v_dot2_f32_bf16 v162, v118, v118, v162
    v_dot2_f32_bf16 v161, v126, v14, v161
    v_dot2_f32_bf16 v163, v126, v126, v163
    v_dot2_f32_bf16 v160, v119, v14, v160
    v_dot2_f32_bf16 v162, v119, v119, v162
    v_dot2_f32_bf16 v161, v127, v14, v161
    v_dot2_f32_bf16 v163, v127, v127, v163
    v_dot2_f32_bf16 v168, v128, v15, v168
    v_dot2_f32_bf16 v169, v128, v10, v169
    v_dot2_f32_bf16 v170, v129, v15, v170
    v_dot2_f32_bf16 v171, v129, v10, v171
    v_dot2_f32_bf16 v172, v130, v15, v172
    v_dot2_f32_bf16 v173, v130, v10, v173
    v_dot2_f32_bf16 v174, v131, v15, v174
    v_dot2_f32_bf16 v175, v131, v10, v175
    v_dot2_f32_bf16 v176, v144, v15, v176
    v_dot2_f32_bf16 v177, v144, v10, v177
    v_dot2_f32_bf16 v178, v145, v15, v178
    v_dot2_f32_bf16 v179, v145, v10, v179
    v_dot2_f32_bf16 v180, v146, v15, v180
    v_dot2_f32_bf16 v181, v146, v10, v181
    v_dot2_f32_bf16 v182, v147, v15, v182
    v_dot2_f32_bf16 v183, v147, v10, v183
    v_dot2_f32_bf16 v168, v132, v15, v168
    v_dot2_f32_bf16 v169, v132, v10, v169
    v_dot2_f32_bf16 v170, v133, v15, v170
    v_dot2_f32_bf16 v171, v133, v10, v171
    v_dot2_f32_bf16 v172, v134, v15, v172
    v_dot2_f32_bf16 v173, v134, v10, v173
    v_dot2_f32_bf16 v174, v135, v15, v174
    v_dot2_f32_bf16 v175, v135, v10, v175
    v_dot2_f32_bf16 v176, v148, v15, v176
    v_dot2_f32_bf16 v177, v148, v10, v177
    v_dot2_f32_bf16 v178, v149, v15, v178
    v_dot2_f32_bf16 v179, v149, v10, v179
    v_dot2_f32_bf16 v180, v150, v15, v180
    v_dot2_f32_bf16 v181, v150, v10, v181
    v_dot2_f32_bf16 v182, v151, v15, v182
    v_dot2_f32_bf16 v183, v151, v10, v183
    v_dot2_f32_bf16 v168, v136, v15, v168
    v_dot2_f32_bf16 v169, v136, v10, v169
    v_dot2_f32_bf16 v170, v137, v15, v170
    v_dot2_f32_bf16 v171, v137, v10, v171
    v_dot2_f32_bf16 v172, v138, v15, v172
    v_dot2_f32_bf16 v173, v138, v10, v173
    v_dot2_f32_bf16 v174, v139, v15, v174
    v_dot2_f32_bf16 v175, v139, v10, v175
    v_dot2_f32_bf16 v176, v152, v15, v176
    v_dot2_f32_bf16 v177, v152, v10, v177
    v_dot2_f32_bf16 v178, v153, v15, v178
    v_dot2_f32_bf16 v179, v153, v10, v179
    v_dot2_f32_bf16 v180, v154, v15, v180
    v_dot2_f32_bf16 v181, v154, v10, v181
    v_dot2_f32_bf16 v182, v155, v15, v182
    v_dot2_f32_bf16 v183, v155, v10, v183
    v_dot2_f32_bf16 v168, v140, v15, v168
    v_dot2_f32_bf16 v169, v140, v10, v169
    v_dot2_f32_bf16 v170, v141, v15, v170
    v_dot2_f32_bf16 v171, v141, v10, v171
    v_dot2_f32_bf16 v172, v142, v15, v172
    v_dot2_f32_bf16 v173, v142, v10, v173
    v_dot2_f32_bf16 v174, v143, v15, v174
    v_dot2_f32_bf16 v175, v143, v10, v175
    v_dot2_f32_bf16 v176, v156, v15, v176
    v_dot2_f32_bf16 v177, v156, v10, v177
    v_dot2_f32_bf16 v178, v157, v15, v178
    v_dot2_f32_bf16 v179, v157, v10, v179
    v_dot2_f32_bf16 v180, v158, v15, v180
    v_dot2_f32_bf16 v181, v158, v10, v181
    v_dot2_f32_bf16 v182, v159, v15, v182
    v_dot2_f32_bf16 v183, v159, v10, v183
    s_nop 2
    s_nop 1
    v_add_f32_dpp v168, v168, v168 row_shr:4 row_mask:0xf bank_mask:0xf bound_ctrl:0
    v_add_f32_dpp v169, v169, v169 row_shr:4 row_mask:0xf bank_mask:0xf bound_ctrl:0
    v_add_f32_dpp v170, v170, v170 row_shr:4 row_mask:0xf bank_mask:0xf bound_ctrl:0
    v_add_f32_dpp v171, v171, v171 row_shr:4 row_mask:0xf bank_mask:0xf bound_ctrl:0
    v_add_f32_dpp v172, v172, v172 row_shr:4 row_mask:0xf bank_mask:0xf bound_ctrl:0
    v_add_f32_dpp v173, v173, v173 row_shr:4 row_mask:0xf bank_mask:0xf bound_ctrl:0
    v_add_f32_dpp v174, v174, v174 row_shr:4 row_mask:0xf bank_mask:0xf bound_ctrl:0
    v_add_f32_dpp v175, v175, v175 row_shr:4 row_mask:0xf bank_mask:0xf bound_ctrl:0
    v_add_f32_dpp v176, v176, v176 row_shr:4 row_mask:0xf bank_mask:0xf bound_ctrl:0
    v_add_f32_dpp v177, v177, v177 row_shr:4 row_mask:0xf bank_mask:0xf bound_ctrl:0
    v_add_f32_dpp v178, v178, v178 row_shr:4 row_mask:0xf bank_mask:0xf bound_ctrl:0
    v_add_f32_dpp v179, v179, v179 row_shr:4 row_mask:0xf bank_mask:0xf bound_ctrl:0
    v_add_f32_dpp v180, v180, v180 row_shr:4 row_mask:0xf bank_mask:0xf bound_ctrl:0
    v_add_f32_dpp v181, v181, v181 row_shr:4 row_mask:0xf bank_mask:0xf bound_ctrl:0
    v_add_f32_dpp v182, v182, v182 row_shr:4 row_mask:0xf bank_mask:0xf bound_ctrl:0
    v_add_f32_dpp v183, v183, v183 row_shr:4 row_mask:0xf bank_mask:0xf bound_ctrl:0
    s_nop 1
    v_add_f32_dpp v168, v168, v168 row_shr:8 row_mask:0xf bank_mask:0xf bound_ctrl:0
    v_add_f32_dpp v169, v169, v169 row_shr:8 row_mask:0xf bank_mask:0xf bound_ctrl:0
    v_add_f32_dpp v170, v170, v170 row_shr:8 row_mask:0xf bank_mask:0xf bound_ctrl:0
    v_add_f32_dpp v171, v171, v171 row_shr:8 row_mask:0xf bank_mask:0xf bound_ctrl:0
    v_add_f32_dpp v172, v172, v172 row_shr:8 row_mask:0xf bank_mask:0xf bound_ctrl:0
    v_add_f32_dpp v173, v173, v173 row_shr:8 row_mask:0xf bank_mask:0xf bound_ctrl:0
    v_add_f32_dpp v174, v174, v174 row_shr:8 row_mask:0xf bank_mask:0xf bound_ctrl:0
    v_add_f32_dpp v175, v175, v175 row_shr:8 row_mask:0xf bank_mask:0xf bound_ctrl:0
    v_add_f32_dpp v176, v176, v176 row_shr:8 row_mask:0xf bank_mask:0xf bound_ctrl:0
    v_add_f32_dpp v177, v177, v177 row_shr:8 row_mask:0xf bank_mask:0xf bound_ctrl:0
    v_add_f32_dpp v178, v178, v178 row_shr:8 row_mask:0xf bank_mask:0xf bound_ctrl:0
    v_add_f32_dpp v179, v179, v179 row_shr:8 row_mask:0xf bank_mask:0xf bound_ctrl:0
    v_add_f32_dpp v180, v180, v180 row_shr:8 row_mask:0xf bank_mask:0xf bound_ctrl:0
    v_add_f32_dpp v181, v181, v181 row_shr:8 row_mask:0xf bank_mask:0xf bound_ctrl:0
    v_add_f32_dpp v182, v182, v182 row_shr:8 row_mask:0xf bank_mask:0xf bound_ctrl:0
    v_add_f32_dpp v183, v183, v183 row_shr:8 row_mask:0xf bank_mask:0xf bound_ctrl:0
    v_mov_b32 v204, v168
    v_mov_b32 v205, v169
    v_mov_b32 v206, v170
    v_mov_b32 v207, v171
    v_mov_b32 v208, v172
    v_mov_b32 v209, v173
    v_mov_b32 v210, v174
    v_mov_b32 v211, v175
    v_mov_b32 v212, v176
    v_mov_b32 v213, v177
    v_mov_b32 v214, v178
    v_mov_b32 v215, v179
    v_mov_b32 v216, v180
    v_mov_b32 v217, v181
    v_mov_b32 v218, v182
    v_mov_b32 v219, v183
    s_nop 1
    v_permlane16_swap_b32 v168, v204
    v_permlane16_swap_b32 v169, v205
    v_permlane16_swap_b32 v170, v206
    v_permlane16_swap_b32 v171, v207
    v_permlane16_swap_b32 v172, v208
    v_permlane16_swap_b32 v173, v209
    v_permlane16_swap_b32 v174, v210
    v_permlane16_swap_b32 v175, v211
    v_permlane16_swap_b32 v176, v212
    v_permlane16_swap_b32 v177, v213
    v_permlane16_swap_b32 v178, v214
    v_permlane16_swap_b32 v179, v215
    v_permlane16_swap_b32 v180, v216
    v_permlane16_swap_b32 v181, v217
    v_permlane16_swap_b32 v182, v218
    v_permlane16_swap_b32 v183, v219
    s_nop 1
    v_add_f32 v168, v168, v204
    v_add_f32 v169, v169, v205
    v_add_f32 v170, v170, v206
    v_add_f32 v171, v171, v207
    v_add_f32 v172, v172, v208
    v_add_f32 v173, v173, v209
    v_add_f32 v174, v174, v210
    v_add_f32 v175, v175, v211
    v_add_f32 v176, v176, v212
    v_add_f32 v177, v177, v213
    v_add_f32 v178, v178, v214
    v_add_f32 v179, v179, v215
    v_add_f32 v180, v180, v216
    v_add_f32 v181, v181, v217
    v_add_f32 v182, v182, v218
    v_add_f32 v183, v183, v219
    v_mov_b32 v204, v168
    v_mov_b32 v205, v169
    v_mov_b32 v206, v170
    v_mov_b32 v207, v171
    v_mov_b32 v208, v172
    v_mov_b32 v209, v173
    v_mov_b32 v210, v174
    v_mov_b32 v211, v175
    v_mov_b32 v212, v176
    v_mov_b32 v213, v177
    v_mov_b32 v214, v178
    v_mov_b32 v215, v179
    v_mov_b32 v216, v180
    v_mov_b32 v217, v181
    v_mov_b32 v218, v182
    v_mov_b32 v219, v183
    s_nop 1
    v_permlane32_swap_b32 v168, v204
    v_permlane32_swap_b32 v169, v205
    v_permlane32_swap_b32 v170, v206
    v_permlane32_swap_b32 v171, v207
    v_permlane32_swap_b32 v172, v208
    v_permlane32_swap_b32 v173, v209
    v_permlane32_swap_b32 v174, v210
    v_permlane32_swap_b32 v175, v211
    v_permlane32_swap_b32 v176, v212
    v_permlane32_swap_b32 v177, v213
    v_permlane32_swap_b32 v178, v214
    v_permlane32_swap_b32 v179, v215
    v_permlane32_swap_b32 v180, v216
    v_permlane32_swap_b32 v181, v217
    v_permlane32_swap_b32 v182, v218
    v_permlane32_swap_b32 v183, v219
    s_nop 1
    v_add_f32 v168, v168, v204
    v_add_f32 v169, v169, v205
    v_add_f32 v170, v170, v206
    v_add_f32 v171, v171, v207
    v_add_f32 v172, v172, v208
    v_add_f32 v173, v173, v209
    v_add_f32 v174, v174, v210
    v_add_f32 v175, v175, v211
    v_add_f32 v176, v176, v212
    v_add_f32 v177, v177, v213
    v_add_f32 v178, v178, v214
    v_add_f32 v179, v179, v215
    v_add_f32 v180, v180, v216
    v_add_f32 v181, v181, v217
    v_add_f32 v182, v182, v218
    v_add_f32 v183, v183, v219
    v_and_b32 v13, 3, v1
    v_lshlrev_b32 v13, 5, v13
    s_mov_b64 s[46:47], exec
    s_mov_b32 exec_lo, 0xf000
    s_mov_b32 exec_hi, 0
    s_lshl_b32 s59, s42, 4
    s_add_u32 s59, s59, s43
    s_mul_i32 s59, s59, 768
    s_and_b32 s60, s3, 1
    s_mul_i32 s60, s60, 384
    s_add_u32 s59, s59, s60
    s_lshr_b32 s60, s3, 1
    s_lshl_b32 s60, s60, 7
    s_add_u32 s59, s59, s60
    s_add_u32 s59, s59, 393216
    buffer_store_dwordx4 v[168:171], v13, s[28:31], s59 offen sc1
    buffer_store_dwordx4 v[172:175], v13, s[28:31], s59 offen offset:16 sc1
    s_lshl_b32 s59, s42, 4
    s_add_u32 s59, s59, s43
    s_mul_i32 s59, s59, 768
    s_and_b32 s60, s58, 1
    s_mul_i32 s60, s60, 384
    s_add_u32 s59, s59, s60
    s_lshr_b32 s60, s58, 1
    s_lshl_b32 s60, s60, 7
    s_add_u32 s59, s59, s60
    s_add_u32 s59, s59, 393216
    buffer_store_dwordx4 v[176:179], v13, s[28:31], s59 offen sc1
    buffer_store_dwordx4 v[180:183], v13, s[28:31], s59 offen offset:16 sc1
    s_mov_b64 exec, s[46:47]
    s_nop 1
    v_add_f32_dpp v160, v160, v160 quad_perm:[1,0,3,2] row_mask:0xf bank_mask:0xf
    v_add_f32_dpp v161, v161, v161 quad_perm:[1,0,3,2] row_mask:0xf bank_mask:0xf
    v_add_f32_dpp v162, v162, v162 quad_perm:[1,0,3,2] row_mask:0xf bank_mask:0xf
    v_add_f32_dpp v163, v163, v163 quad_perm:[1,0,3,2] row_mask:0xf bank_mask:0xf
    s_nop 1
    v_add_f32_dpp v160, v160, v160 quad_perm:[2,3,0,1] row_mask:0xf bank_mask:0xf
    v_add_f32_dpp v161, v161, v161 quad_perm:[2,3,0,1] row_mask:0xf bank_mask:0xf
    v_add_f32_dpp v162, v162, v162 quad_perm:[2,3,0,1] row_mask:0xf bank_mask:0xf
    v_add_f32_dpp v163, v163, v163 quad_perm:[2,3,0,1] row_mask:0xf bank_mask:0xf
    s_nop 1
    v_add_f32_dpp v160, v160, v160 row_half_mirror row_mask:0xf bank_mask:0xf
    v_add_f32_dpp v161, v161, v161 row_half_mirror row_mask:0xf bank_mask:0xf
    v_add_f32_dpp v162, v162, v162 row_half_mirror row_mask:0xf bank_mask:0xf
    v_add_f32_dpp v163, v163, v163 row_half_mirror row_mask:0xf bank_mask:0xf
    s_nop 1
    v_add_f32_dpp v160, v160, v160 row_mirror row_mask:0xf bank_mask:0xf
    v_add_f32_dpp v161, v161, v161 row_mirror row_mask:0xf bank_mask:0xf
    v_add_f32_dpp v162, v162, v162 row_mirror row_mask:0xf bank_mask:0xf
    v_add_f32_dpp v163, v163, v163 row_mirror row_mask:0xf bank_mask:0xf
    v_mov_b32 v204, v160
    v_mov_b32 v205, v161
    v_mov_b32 v206, v162
    v_mov_b32 v207, v163
    s_nop 1
    v_permlane16_swap_b32 v160, v204
    v_permlane16_swap_b32 v161, v205
    v_permlane16_swap_b32 v162, v206
    v_permlane16_swap_b32 v163, v207
    s_nop 1
    v_add_f32 v160, v160, v204
    v_add_f32 v161, v161, v205
    v_add_f32 v162, v162, v206
    v_add_f32 v163, v163, v207
    v_mov_b32 v204, v160
    v_mov_b32 v205, v161
    v_mov_b32 v206, v162
    v_mov_b32 v207, v163
    s_nop 1
    v_permlane32_swap_b32 v160, v204
    v_permlane32_swap_b32 v161, v205
    v_permlane32_swap_b32 v162, v206
    v_permlane32_swap_b32 v163, v207
    s_nop 1
    v_add_f32 v160, v160, v204
    v_add_f32 v161, v161, v205
    v_add_f32 v162, v162, v206
    v_add_f32 v163, v163, v207
    v_mul_f32 v160, 0x3a800000, v160
    v_mul_f32 v162, 0x3a800000, v162
    v_fma_f32 v162, -v160, v160, v162
    v_max_f32 v162, 0, v162
    v_add_f32 v162, 0x3727c5ac, v162
    v_rsq_f32 v162, v162
    v_mul_f32 v161, 0x3a800000, v161
    v_mul_f32 v163, 0x3a800000, v163
    v_fma_f32 v163, -v161, v161, v163
    v_max_f32 v163, 0, v163
    v_add_f32 v163, 0x3727c5ac, v163
    v_rsq_f32 v163, v163
    v_cmp_eq_u32 vcc, 1, v1
    s_nop 1
    v_cndmask_b32 v160, v160, v161, vcc
    v_cndmask_b32 v161, v162, v163, vcc
    v_lshlrev_b32 v13, 3, v1
    s_lshl_b32 s59, s56, 3
    s_add_u32 s59, s59, 360448
    s_mov_b64 s[46:47], exec
    s_mov_b32 exec_lo, 0x3
    s_mov_b32 exec_hi, 0x0
    buffer_store_dwordx2 v[160:161], v13, s[28:31], s59 offen sc1
    s_mov_b64 exec, s[46:47]
    s_cmp_lg_u32 s3, 0
    s_cbranch_scc1 L_w_5
    s_mul_i32 s45, s2, 800
    v_mov_b32 v4, 0
    v_mov_b32 v5, 0
    v_mov_b32 v6, 0
    v_mov_b32 v7, 0
    s_mov_b64 s[46:47], exec
    s_mov_b32 exec_lo, 0xffffffff
    s_mov_b32 exec_hi, 0x3ffff
    buffer_store_dwordx4 v[4:7], v11, s[28:31], s45 offen sc1
    s_mov_b64 exec, s[46:47]
L_w_5:
    s_cmp_lg_u32 s3, 1
    s_cbranch_scc1 L_w_6
L_w_6:
    s_lshl_b32 s58, s43, 4
    s_add_u32 s58, s58, s42
    s_mul_i32 s58, s58, 24
    s_lshl_b32 s59, s49, 1
    s_add_u32 s58, s58, s59
    s_lshl_b32 s58, s58, 10
    s_add_u32 s58, s58, 40894464
    s_mov_b32 s57, 0
    v_lshlrev_b32 v198, 4, v1
    s_lshr_b32 s61, s3, 1
    s_lshl_b32 s62, s2, 1
    s_add_u32 s62, s62, s61
    s_lshr_b32 s63, s62, 4
    s_and_b32 s62, s62, 15
    v_lshrrev_b32 v12, 4, v1
    v_bfe_u32 v13, v1, 2, 2
    v_and_b32 v14, 3, v1
    v_lshlrev_b32 v15, 9, v12
    v_lshl_add_u32 v15, v13, 7, v15
    v_lshl_add_u32 v15, v14, 3, v15
    s_lshl_b32 s61, s61, 12
    s_and_b32 s64, s3, 1
    s_lshl_b32 s65, s64, 6
    s_add_u32 s61, s61, s65
    s_add_u32 s61, s61, 139264
    v_add_u32 v15, s61, v15
    s_and_b32 s61, s62, 7
    s_lshl_b32 s61, s61, 5
    s_add_u32 s61, s61, s63
    s_lshl_b32 s61, s61, 3
    s_lshr_b32 s62, s62, 3
    s_lshl_b32 s62, s62, 2
    s_add_u32 s61, s61, s62
    s_lshl_b32 s64, s64, 1
    s_add_u32 s61, s61, s64
    s_lshl_b32 s61, s61, 10
    s_add_u32 s61, s61, 47185920
    s_barrier
    ds_read_b64_tr_b16 v[200:201], v15 offset:0
    ds_read_b64_tr_b16 v[202:203], v15 offset:2048
    ds_read_b64_tr_b16 v[204:205], v15 offset:32
    ds_read_b64_tr_b16 v[206:207], v15 offset:2080
    ds_read_b128 v[112:115], v192 offset:0
    ds_read_b64_tr_b16 v[128:129], v194 offset:0
    ds_read_b64_tr_b16 v[130:131], v194 offset:512
    ds_read_b64_tr_b16 v[132:133], v196 offset:0
    ds_read_b64_tr_b16 v[134:135], v196 offset:512
    ds_read_b64_tr_b16 v[136:137], v194 offset:8192
    ds_read_b64_tr_b16 v[138:139], v194 offset:8704
    ds_read_b64_tr_b16 v[140:141], v196 offset:8192
    ds_read_b64_tr_b16 v[142:143], v196 offset:8704
    ds_read_b64_tr_b16 v[144:145], v194 offset:16384
    ds_read_b64_tr_b16 v[146:147], v194 offset:16896
    s_waitcnt lgkmcnt(14)
    ds_read_b64_tr_b16 v[148:149], v196 offset:16384
    s_waitcnt lgkmcnt(14)
    ds_read_b64_tr_b16 v[150:151], v196 offset:16896
    s_waitcnt lgkmcnt(14)
    ds_read_b128 v[116:119], v192 offset:2048
    s_waitcnt lgkmcnt(14)
    ds_read_b128 v[120:123], v192 offset:4096
    s_waitcnt lgkmcnt(14)
    ds_read_b128 v[124:127], v192 offset:6144
    s_waitcnt lgkmcnt(15)
    buffer_store_dwordx4 v[200:203], v198, s[28:31], s61 offen offset:0 sc1
    buffer_store_dwordx4 v[204:207], v198, s[28:31], s61 offen offset:1024 sc1
    s_mov_b32 s55, 3
L_rc_7:
    s_cmp_eq_u32 s57, s42
    s_cbranch_scc1 L_cp_8
    s_waitcnt lgkmcnt(0)
    v_mfma_f32_16x16x32_bf16 v[16:19], v[128:131], v[112:115], v[16:19]
    ds_read_b128 v[152:155], v193 offset:0
    v_mfma_f32_16x16x32_bf16 v[32:35], v[132:135], v[112:115], v[32:35]
    ds_read_b64_tr_b16 v[168:169], v194 offset:4096
    v_mfma_f32_16x16x32_bf16 v[48:51], v[112:115], v[136:139], v[48:51]
    ds_read_b64_tr_b16 v[170:171], v194 offset:4608
    v_mfma_f32_16x16x32_bf16 v[52:55], v[112:115], v[140:143], v[52:55]
    ds_read_b64_tr_b16 v[172:173], v196 offset:4096
    v_mfma_f32_16x16x32_bf16 v[80:83], v[112:115], v[144:147], v[80:83]
    ds_read_b64_tr_b16 v[174:175], v196 offset:4608
    v_mfma_f32_16x16x32_bf16 v[84:87], v[112:115], v[148:151], v[84:87]
    ds_read_b64_tr_b16 v[176:177], v194 offset:12288
    v_mfma_f32_16x16x32_bf16 v[20:23], v[128:131], v[116:119], v[20:23]
    ds_read_b64_tr_b16 v[178:179], v194 offset:12800
    v_mfma_f32_16x16x32_bf16 v[36:39], v[132:135], v[116:119], v[36:39]
    ds_read_b64_tr_b16 v[180:181], v196 offset:12288
    v_mfma_f32_16x16x32_bf16 v[56:59], v[116:119], v[136:139], v[56:59]
    ds_read_b64_tr_b16 v[182:183], v196 offset:12800
    v_mfma_f32_16x16x32_bf16 v[60:63], v[116:119], v[140:143], v[60:63]
    ds_read_b64_tr_b16 v[184:185], v194 offset:20480
    v_mfma_f32_16x16x32_bf16 v[88:91], v[116:119], v[144:147], v[88:91]
    ds_read_b64_tr_b16 v[186:187], v194 offset:20992
    v_mfma_f32_16x16x32_bf16 v[92:95], v[116:119], v[148:151], v[92:95]
    ds_read_b64_tr_b16 v[188:189], v196 offset:20480
    v_mfma_f32_16x16x32_bf16 v[24:27], v[128:131], v[120:123], v[24:27]
    ds_read_b64_tr_b16 v[190:191], v196 offset:20992
    v_mfma_f32_16x16x32_bf16 v[40:43], v[132:135], v[120:123], v[40:43]
    ds_read_b128 v[156:159], v193 offset:2048
    v_mfma_f32_16x16x32_bf16 v[64:67], v[120:123], v[136:139], v[64:67]
    ds_read_b128 v[160:163], v193 offset:4096
    v_mfma_f32_16x16x32_bf16 v[68:71], v[120:123], v[140:143], v[68:71]
    s_waitcnt lgkmcnt(14)
    ds_read_b128 v[164:167], v193 offset:6144
    v_mfma_f32_16x16x32_bf16 v[96:99], v[120:123], v[144:147], v[96:99]
    v_mfma_f32_16x16x32_bf16 v[100:103], v[120:123], v[148:151], v[100:103]
    v_mfma_f32_16x16x32_bf16 v[28:31], v[128:131], v[124:127], v[28:31]
    v_mfma_f32_16x16x32_bf16 v[44:47], v[132:135], v[124:127], v[44:47]
    v_mfma_f32_16x16x32_bf16 v[72:75], v[124:127], v[136:139], v[72:75]
    v_mfma_f32_16x16x32_bf16 v[76:79], v[124:127], v[140:143], v[76:79]
    v_mfma_f32_16x16x32_bf16 v[104:107], v[124:127], v[144:147], v[104:107]
    v_mfma_f32_16x16x32_bf16 v[108:111], v[124:127], v[148:151], v[108:111]
L_cpb_9:
    s_cmp_eq_u32 s57, s42
    s_cbranch_scc1 L_cp_10
    s_waitcnt lgkmcnt(0)
    v_mfma_f32_16x16x32_bf16 v[16:19], v[168:171], v[152:155], v[16:19]
    v_mfma_f32_16x16x32_bf16 v[32:35], v[172:175], v[152:155], v[32:35]
    s_barrier
    ds_read_b128 v[112:115], v192 offset:16384
    v_mfma_f32_16x16x32_bf16 v[48:51], v[152:155], v[176:179], v[48:51]
    ds_read_b64_tr_b16 v[128:129], v194 offset:24576
    v_mfma_f32_16x16x32_bf16 v[52:55], v[152:155], v[180:183], v[52:55]
    ds_read_b64_tr_b16 v[130:131], v194 offset:25088
    v_mfma_f32_16x16x32_bf16 v[80:83], v[152:155], v[184:187], v[80:83]
    ds_read_b64_tr_b16 v[132:133], v196 offset:24576
    v_mfma_f32_16x16x32_bf16 v[84:87], v[152:155], v[188:191], v[84:87]
    ds_read_b64_tr_b16 v[134:135], v196 offset:25088
    v_mfma_f32_16x16x32_bf16 v[20:23], v[168:171], v[156:159], v[20:23]
    ds_read_b64_tr_b16 v[136:137], v194 offset:32768
    v_mfma_f32_16x16x32_bf16 v[36:39], v[172:175], v[156:159], v[36:39]
    ds_read_b64_tr_b16 v[138:139], v194 offset:33280
    v_mfma_f32_16x16x32_bf16 v[56:59], v[156:159], v[176:179], v[56:59]
    ds_read_b64_tr_b16 v[140:141], v196 offset:32768
    v_mfma_f32_16x16x32_bf16 v[60:63], v[156:159], v[180:183], v[60:63]
    ds_read_b64_tr_b16 v[142:143], v196 offset:33280
    v_mfma_f32_16x16x32_bf16 v[88:91], v[156:159], v[184:187], v[88:91]
    ds_read_b64_tr_b16 v[144:145], v194 offset:40960
    v_mfma_f32_16x16x32_bf16 v[92:95], v[156:159], v[188:191], v[92:95]
    ds_read_b64_tr_b16 v[146:147], v194 offset:41472
    v_mfma_f32_16x16x32_bf16 v[24:27], v[168:171], v[160:163], v[24:27]
    ds_read_b64_tr_b16 v[148:149], v196 offset:40960
    v_mfma_f32_16x16x32_bf16 v[40:43], v[172:175], v[160:163], v[40:43]
    ds_read_b64_tr_b16 v[150:151], v196 offset:41472
    v_mfma_f32_16x16x32_bf16 v[64:67], v[160:163], v[176:179], v[64:67]
    ds_read_b128 v[116:119], v192 offset:18432
    v_mfma_f32_16x16x32_bf16 v[68:71], v[160:163], v[180:183], v[68:71]
    ds_read_b128 v[120:123], v192 offset:20480
    v_mfma_f32_16x16x32_bf16 v[96:99], v[160:163], v[184:187], v[96:99]
    s_waitcnt lgkmcnt(14)
    ds_read_b128 v[124:127], v192 offset:22528
    v_mfma_f32_16x16x32_bf16 v[100:103], v[160:163], v[188:191], v[100:103]
    v_mfma_f32_16x16x32_bf16 v[28:31], v[168:171], v[164:167], v[28:31]
    v_mfma_f32_16x16x32_bf16 v[44:47], v[172:175], v[164:167], v[44:47]
    v_mfma_f32_16x16x32_bf16 v[72:75], v[164:167], v[176:179], v[72:75]
    v_mfma_f32_16x16x32_bf16 v[76:79], v[164:167], v[180:183], v[76:79]
    v_mfma_f32_16x16x32_bf16 v[104:107], v[164:167], v[184:187], v[104:107]
    v_mfma_f32_16x16x32_bf16 v[108:111], v[164:167], v[188:191], v[108:111]
L_cpb_11:
    s_add_u32 s57, s57, 1
    s_cmp_eq_u32 s57, s42
    s_cbranch_scc1 L_cp_12
    s_waitcnt lgkmcnt(0)
    v_mfma_f32_16x16x32_bf16 v[16:19], v[128:131], v[112:115], v[16:19]
    ds_read_b128 v[152:155], v193 offset:16384
    v_mfma_f32_16x16x32_bf16 v[32:35], v[132:135], v[112:115], v[32:35]
    ds_read_b64_tr_b16 v[168:169], v194 offset:28672
    v_mfma_f32_16x16x32_bf16 v[48:51], v[112:115], v[136:139], v[48:51]
    ds_read_b64_tr_b16 v[170:171], v194 offset:29184
    v_mfma_f32_16x16x32_bf16 v[52:55], v[112:115], v[140:143], v[52:55]
    ds_read_b64_tr_b16 v[172:173], v196 offset:28672
    v_mfma_f32_16x16x32_bf16 v[80:83], v[112:115], v[144:147], v[80:83]
    ds_read_b64_tr_b16 v[174:175], v196 offset:29184
    v_mfma_f32_16x16x32_bf16 v[84:87], v[112:115], v[148:151], v[84:87]
    ds_read_b64_tr_b16 v[176:177], v194 offset:36864
    v_mfma_f32_16x16x32_bf16 v[20:23], v[128:131], v[116:119], v[20:23]
    ds_read_b64_tr_b16 v[178:179], v194 offset:37376
    v_mfma_f32_16x16x32_bf16 v[36:39], v[132:135], v[116:119], v[36:39]
    ds_read_b64_tr_b16 v[180:181], v196 offset:36864
    v_mfma_f32_16x16x32_bf16 v[56:59], v[116:119], v[136:139], v[56:59]
    ds_read_b64_tr_b16 v[182:183], v196 offset:37376
    v_mfma_f32_16x16x32_bf16 v[60:63], v[116:119], v[140:143], v[60:63]
    ds_read_b64_tr_b16 v[184:185], v194 offset:45056
    v_mfma_f32_16x16x32_bf16 v[88:91], v[116:119], v[144:147], v[88:91]
    ds_read_b64_tr_b16 v[186:187], v194 offset:45568
    v_mfma_f32_16x16x32_bf16 v[92:95], v[116:119], v[148:151], v[92:95]
    ds_read_b64_tr_b16 v[188:189], v196 offset:45056
    v_mfma_f32_16x16x32_bf16 v[24:27], v[128:131], v[120:123], v[24:27]
    ds_read_b64_tr_b16 v[190:191], v196 offset:45568
    v_mfma_f32_16x16x32_bf16 v[40:43], v[132:135], v[120:123], v[40:43]
    ds_read_b128 v[156:159], v193 offset:18432
    v_mfma_f32_16x16x32_bf16 v[64:67], v[120:123], v[136:139], v[64:67]
    ds_read_b128 v[160:163], v193 offset:20480
    v_mfma_f32_16x16x32_bf16 v[68:71], v[120:123], v[140:143], v[68:71]
    s_waitcnt lgkmcnt(14)
    ds_read_b128 v[164:167], v193 offset:22528
    v_mfma_f32_16x16x32_bf16 v[96:99], v[120:123], v[144:147], v[96:99]
    v_mfma_f32_16x16x32_bf16 v[100:103], v[120:123], v[148:151], v[100:103]
    v_mfma_f32_16x16x32_bf16 v[28:31], v[128:131], v[124:127], v[28:31]
    v_mfma_f32_16x16x32_bf16 v[44:47], v[132:135], v[124:127], v[44:47]
    v_mfma_f32_16x16x32_bf16 v[72:75], v[124:127], v[136:139], v[72:75]
    v_mfma_f32_16x16x32_bf16 v[76:79], v[124:127], v[140:143], v[76:79]
    v_mfma_f32_16x16x32_bf16 v[104:107], v[124:127], v[144:147], v[104:107]
    v_mfma_f32_16x16x32_bf16 v[108:111], v[124:127], v[148:151], v[108:111]
L_cpb_13:
    s_cmp_eq_u32 s57, s42
    s_cbranch_scc1 L_cp_14
    s_waitcnt lgkmcnt(0)
    v_mfma_f32_16x16x32_bf16 v[16:19], v[168:171], v[152:155], v[16:19]
    v_mfma_f32_16x16x32_bf16 v[32:35], v[172:175], v[152:155], v[32:35]
    s_barrier
    ds_read_b128 v[112:115], v192 offset:32768
    v_mfma_f32_16x16x32_bf16 v[48:51], v[152:155], v[176:179], v[48:51]
    ds_read_b64_tr_b16 v[128:129], v195 offset:0
    v_mfma_f32_16x16x32_bf16 v[52:55], v[152:155], v[180:183], v[52:55]
    ds_read_b64_tr_b16 v[130:131], v195 offset:512
    v_mfma_f32_16x16x32_bf16 v[80:83], v[152:155], v[184:187], v[80:83]
    ds_read_b64_tr_b16 v[132:133], v197 offset:0
    v_mfma_f32_16x16x32_bf16 v[84:87], v[152:155], v[188:191], v[84:87]
    ds_read_b64_tr_b16 v[134:135], v197 offset:512
    v_mfma_f32_16x16x32_bf16 v[20:23], v[168:171], v[156:159], v[20:23]
    ds_read_b64_tr_b16 v[136:137], v195 offset:8192
    v_mfma_f32_16x16x32_bf16 v[36:39], v[172:175], v[156:159], v[36:39]
    ds_read_b64_tr_b16 v[138:139], v195 offset:8704
    v_mfma_f32_16x16x32_bf16 v[56:59], v[156:159], v[176:179], v[56:59]
    ds_read_b64_tr_b16 v[140:141], v197 offset:8192
    v_mfma_f32_16x16x32_bf16 v[60:63], v[156:159], v[180:183], v[60:63]
    ds_read_b64_tr_b16 v[142:143], v197 offset:8704
    v_mfma_f32_16x16x32_bf16 v[88:91], v[156:159], v[184:187], v[88:91]
    ds_read_b64_tr_b16 v[144:145], v195 offset:16384
    v_mfma_f32_16x16x32_bf16 v[92:95], v[156:159], v[188:191], v[92:95]
    ds_read_b64_tr_b16 v[146:147], v195 offset:16896
    v_mfma_f32_16x16x32_bf16 v[24:27], v[168:171], v[160:163], v[24:27]
    ds_read_b64_tr_b16 v[148:149], v197 offset:16384
    v_mfma_f32_16x16x32_bf16 v[40:43], v[172:175], v[160:163], v[40:43]
    ds_read_b64_tr_b16 v[150:151], v197 offset:16896
    v_mfma_f32_16x16x32_bf16 v[64:67], v[160:163], v[176:179], v[64:67]
    ds_read_b128 v[116:119], v192 offset:34816
    v_mfma_f32_16x16x32_bf16 v[68:71], v[160:163], v[180:183], v[68:71]
    ds_read_b128 v[120:123], v192 offset:36864
    v_mfma_f32_16x16x32_bf16 v[96:99], v[160:163], v[184:187], v[96:99]
    s_waitcnt lgkmcnt(14)
    ds_read_b128 v[124:127], v192 offset:38912
    v_mfma_f32_16x16x32_bf16 v[100:103], v[160:163], v[188:191], v[100:103]
    v_mfma_f32_16x16x32_bf16 v[28:31], v[168:171], v[164:167], v[28:31]
    v_mfma_f32_16x16x32_bf16 v[44:47], v[172:175], v[164:167], v[44:47]
    v_mfma_f32_16x16x32_bf16 v[72:75], v[164:167], v[176:179], v[72:75]
    v_mfma_f32_16x16x32_bf16 v[76:79], v[164:167], v[180:183], v[76:79]
    v_mfma_f32_16x16x32_bf16 v[104:107], v[164:167], v[184:187], v[104:107]
    v_mfma_f32_16x16x32_bf16 v[108:111], v[164:167], v[188:191], v[108:111]
L_cpb_15:
    s_add_u32 s57, s57, 1
    s_cmp_eq_u32 s57, s42
    s_cbranch_scc1 L_cp_16
    s_waitcnt lgkmcnt(0)
    v_mfma_f32_16x16x32_bf16 v[16:19], v[128:131], v[112:115], v[16:19]
    ds_read_b128 v[152:155], v193 offset:32768
    v_mfma_f32_16x16x32_bf16 v[32:35], v[132:135], v[112:115], v[32:35]
    ds_read_b64_tr_b16 v[168:169], v195 offset:4096
    v_mfma_f32_16x16x32_bf16 v[48:51], v[112:115], v[136:139], v[48:51]
    ds_read_b64_tr_b16 v[170:171], v195 offset:4608
    v_mfma_f32_16x16x32_bf16 v[52:55], v[112:115], v[140:143], v[52:55]
    ds_read_b64_tr_b16 v[172:173], v197 offset:4096
    v_mfma_f32_16x16x32_bf16 v[80:83], v[112:115], v[144:147], v[80:83]
    ds_read_b64_tr_b16 v[174:175], v197 offset:4608
    v_mfma_f32_16x16x32_bf16 v[84:87], v[112:115], v[148:151], v[84:87]
    ds_read_b64_tr_b16 v[176:177], v195 offset:12288
    v_mfma_f32_16x16x32_bf16 v[20:23], v[128:131], v[116:119], v[20:23]
    ds_read_b64_tr_b16 v[178:179], v195 offset:12800
    v_mfma_f32_16x16x32_bf16 v[36:39], v[132:135], v[116:119], v[36:39]
    ds_read_b64_tr_b16 v[180:181], v197 offset:12288
    v_mfma_f32_16x16x32_bf16 v[56:59], v[116:119], v[136:139], v[56:59]
    ds_read_b64_tr_b16 v[182:183], v197 offset:12800
    v_mfma_f32_16x16x32_bf16 v[60:63], v[116:119], v[140:143], v[60:63]
    ds_read_b64_tr_b16 v[184:185], v195 offset:20480
    v_mfma_f32_16x16x32_bf16 v[88:91], v[116:119], v[144:147], v[88:91]
    ds_read_b64_tr_b16 v[186:187], v195 offset:20992
    v_mfma_f32_16x16x32_bf16 v[92:95], v[116:119], v[148:151], v[92:95]
    ds_read_b64_tr_b16 v[188:189], v197 offset:20480
    v_mfma_f32_16x16x32_bf16 v[24:27], v[128:131], v[120:123], v[24:27]
    ds_read_b64_tr_b16 v[190:191], v197 offset:20992
    v_mfma_f32_16x16x32_bf16 v[40:43], v[132:135], v[120:123], v[40:43]
    ds_read_b128 v[156:159], v193 offset:34816
    v_mfma_f32_16x16x32_bf16 v[64:67], v[120:123], v[136:139], v[64:67]
    ds_read_b128 v[160:163], v193 offset:36864
    v_mfma_f32_16x16x32_bf16 v[68:71], v[120:123], v[140:143], v[68:71]
    s_waitcnt lgkmcnt(14)
    ds_read_b128 v[164:167], v193 offset:38912
    v_mfma_f32_16x16x32_bf16 v[96:99], v[120:123], v[144:147], v[96:99]
    v_mfma_f32_16x16x32_bf16 v[100:103], v[120:123], v[148:151], v[100:103]
    v_mfma_f32_16x16x32_bf16 v[28:31], v[128:131], v[124:127], v[28:31]
    v_mfma_f32_16x16x32_bf16 v[44:47], v[132:135], v[124:127], v[44:47]
    v_mfma_f32_16x16x32_bf16 v[72:75], v[124:127], v[136:139], v[72:75]
    v_mfma_f32_16x16x32_bf16 v[76:79], v[124:127], v[140:143], v[76:79]
    v_mfma_f32_16x16x32_bf16 v[104:107], v[124:127], v[144:147], v[104:107]
    v_mfma_f32_16x16x32_bf16 v[108:111], v[124:127], v[148:151], v[108:111]
L_cpb_17:
    s_cmp_eq_u32 s57, s42
    s_cbranch_scc1 L_cp_18
    s_waitcnt lgkmcnt(0)
    v_mfma_f32_16x16x32_bf16 v[16:19], v[168:171], v[152:155], v[16:19]
    v_mfma_f32_16x16x32_bf16 v[32:35], v[172:175], v[152:155], v[32:35]
    s_barrier
    ds_read_b128 v[112:115], v192 offset:49152
    v_mfma_f32_16x16x32_bf16 v[48:51], v[152:155], v[176:179], v[48:51]
    ds_read_b64_tr_b16 v[128:129], v195 offset:24576
    v_mfma_f32_16x16x32_bf16 v[52:55], v[152:155], v[180:183], v[52:55]
    ds_read_b64_tr_b16 v[130:131], v195 offset:25088
    v_mfma_f32_16x16x32_bf16 v[80:83], v[152:155], v[184:187], v[80:83]
    ds_read_b64_tr_b16 v[132:133], v197 offset:24576
    v_mfma_f32_16x16x32_bf16 v[84:87], v[152:155], v[188:191], v[84:87]
    ds_read_b64_tr_b16 v[134:135], v197 offset:25088
    v_mfma_f32_16x16x32_bf16 v[20:23], v[168:171], v[156:159], v[20:23]
    ds_read_b64_tr_b16 v[136:137], v195 offset:32768
    v_mfma_f32_16x16x32_bf16 v[36:39], v[172:175], v[156:159], v[36:39]
    ds_read_b64_tr_b16 v[138:139], v195 offset:33280
    v_mfma_f32_16x16x32_bf16 v[56:59], v[156:159], v[176:179], v[56:59]
    ds_read_b64_tr_b16 v[140:141], v197 offset:32768
    v_mfma_f32_16x16x32_bf16 v[60:63], v[156:159], v[180:183], v[60:63]
    ds_read_b64_tr_b16 v[142:143], v197 offset:33280
    v_mfma_f32_16x16x32_bf16 v[88:91], v[156:159], v[184:187], v[88:91]
    ds_read_b64_tr_b16 v[144:145], v195 offset:40960
    v_mfma_f32_16x16x32_bf16 v[92:95], v[156:159], v[188:191], v[92:95]
    ds_read_b64_tr_b16 v[146:147], v195 offset:41472
    v_mfma_f32_16x16x32_bf16 v[24:27], v[168:171], v[160:163], v[24:27]
    ds_read_b64_tr_b16 v[148:149], v197 offset:40960
    v_mfma_f32_16x16x32_bf16 v[40:43], v[172:175], v[160:163], v[40:43]
    ds_read_b64_tr_b16 v[150:151], v197 offset:41472
    v_mfma_f32_16x16x32_bf16 v[64:67], v[160:163], v[176:179], v[64:67]
    ds_read_b128 v[116:119], v192 offset:51200
    v_mfma_f32_16x16x32_bf16 v[68:71], v[160:163], v[180:183], v[68:71]
    ds_read_b128 v[120:123], v192 offset:53248
    v_mfma_f32_16x16x32_bf16 v[96:99], v[160:163], v[184:187], v[96:99]
    s_waitcnt lgkmcnt(14)
    ds_read_b128 v[124:127], v192 offset:55296
    v_mfma_f32_16x16x32_bf16 v[100:103], v[160:163], v[188:191], v[100:103]
    v_mfma_f32_16x16x32_bf16 v[28:31], v[168:171], v[164:167], v[28:31]
    v_mfma_f32_16x16x32_bf16 v[44:47], v[172:175], v[164:167], v[44:47]
    v_mfma_f32_16x16x32_bf16 v[72:75], v[164:167], v[176:179], v[72:75]
    v_mfma_f32_16x16x32_bf16 v[76:79], v[164:167], v[180:183], v[76:79]
    v_mfma_f32_16x16x32_bf16 v[104:107], v[164:167], v[184:187], v[104:107]
    v_mfma_f32_16x16x32_bf16 v[108:111], v[164:167], v[188:191], v[108:111]
L_cpb_19:
    s_add_u32 s57, s57, 1
    s_cmp_eq_u32 s57, s42
    s_cbranch_scc1 L_cp_20
    s_waitcnt lgkmcnt(0)
    v_mfma_f32_16x16x32_bf16 v[16:19], v[128:131], v[112:115], v[16:19]
    ds_read_b128 v[152:155], v193 offset:49152
    v_mfma_f32_16x16x32_bf16 v[32:35], v[132:135], v[112:115], v[32:35]
    ds_read_b64_tr_b16 v[168:169], v195 offset:28672
    v_mfma_f32_16x16x32_bf16 v[48:51], v[112:115], v[136:139], v[48:51]
    ds_read_b64_tr_b16 v[170:171], v195 offset:29184
    v_mfma_f32_16x16x32_bf16 v[52:55], v[112:115], v[140:143], v[52:55]
    ds_read_b64_tr_b16 v[172:173], v197 offset:28672
    v_mfma_f32_16x16x32_bf16 v[80:83], v[112:115], v[144:147], v[80:83]
    ds_read_b64_tr_b16 v[174:175], v197 offset:29184
    v_mfma_f32_16x16x32_bf16 v[84:87], v[112:115], v[148:151], v[84:87]
    ds_read_b64_tr_b16 v[176:177], v195 offset:36864
    v_mfma_f32_16x16x32_bf16 v[20:23], v[128:131], v[116:119], v[20:23]
    ds_read_b64_tr_b16 v[178:179], v195 offset:37376
    v_mfma_f32_16x16x32_bf16 v[36:39], v[132:135], v[116:119], v[36:39]
    ds_read_b64_tr_b16 v[180:181], v197 offset:36864
    v_mfma_f32_16x16x32_bf16 v[56:59], v[116:119], v[136:139], v[56:59]
    ds_read_b64_tr_b16 v[182:183], v197 offset:37376
    v_mfma_f32_16x16x32_bf16 v[60:63], v[116:119], v[140:143], v[60:63]
    ds_read_b64_tr_b16 v[184:185], v195 offset:45056
    v_mfma_f32_16x16x32_bf16 v[88:91], v[116:119], v[144:147], v[88:91]
    ds_read_b64_tr_b16 v[186:187], v195 offset:45568
    v_mfma_f32_16x16x32_bf16 v[92:95], v[116:119], v[148:151], v[92:95]
    ds_read_b64_tr_b16 v[188:189], v197 offset:45056
    v_mfma_f32_16x16x32_bf16 v[24:27], v[128:131], v[120:123], v[24:27]
    ds_read_b64_tr_b16 v[190:191], v197 offset:45568
    v_mfma_f32_16x16x32_bf16 v[40:43], v[132:135], v[120:123], v[40:43]
    ds_read_b128 v[156:159], v193 offset:51200
    v_mfma_f32_16x16x32_bf16 v[64:67], v[120:123], v[136:139], v[64:67]
    ds_read_b128 v[160:163], v193 offset:53248
    v_mfma_f32_16x16x32_bf16 v[68:71], v[120:123], v[140:143], v[68:71]
    s_waitcnt lgkmcnt(14)
    ds_read_b128 v[164:167], v193 offset:55296
    v_mfma_f32_16x16x32_bf16 v[96:99], v[120:123], v[144:147], v[96:99]
    v_mfma_f32_16x16x32_bf16 v[100:103], v[120:123], v[148:151], v[100:103]
    v_mfma_f32_16x16x32_bf16 v[28:31], v[128:131], v[124:127], v[28:31]
    v_mfma_f32_16x16x32_bf16 v[44:47], v[132:135], v[124:127], v[44:47]
    v_mfma_f32_16x16x32_bf16 v[72:75], v[124:127], v[136:139], v[72:75]
    v_mfma_f32_16x16x32_bf16 v[76:79], v[124:127], v[140:143], v[76:79]
    v_mfma_f32_16x16x32_bf16 v[104:107], v[124:127], v[144:147], v[104:107]
    v_mfma_f32_16x16x32_bf16 v[108:111], v[124:127], v[148:151], v[108:111]
L_cpb_21:
    s_cmp_eq_u32 s57, s42
    s_cbranch_scc1 L_cp_22
    s_waitcnt lgkmcnt(0)
    v_mfma_f32_16x16x32_bf16 v[16:19], v[168:171], v[152:155], v[16:19]
    v_mfma_f32_16x16x32_bf16 v[32:35], v[172:175], v[152:155], v[32:35]
    s_cmp_eq_u32 s55, 3
    s_cbranch_scc1 L_rare_24
L_back_25:
    s_barrier
    s_cmp_eq_u32 s55, 3
    s_cbranch_scc1 L_rare_26
L_back_27:
    ds_read_b128 v[112:115], v192 offset:0
    v_mfma_f32_16x16x32_bf16 v[48:51], v[152:155], v[176:179], v[48:51]
    ds_read_b64_tr_b16 v[128:129], v194 offset:0
    v_mfma_f32_16x16x32_bf16 v[52:55], v[152:155], v[180:183], v[52:55]
    ds_read_b64_tr_b16 v[130:131], v194 offset:512
    v_mfma_f32_16x16x32_bf16 v[80:83], v[152:155], v[184:187], v[80:83]
    ds_read_b64_tr_b16 v[132:133], v196 offset:0
    v_mfma_f32_16x16x32_bf16 v[84:87], v[152:155], v[188:191], v[84:87]
    ds_read_b64_tr_b16 v[134:135], v196 offset:512
    v_mfma_f32_16x16x32_bf16 v[20:23], v[168:171], v[156:159], v[20:23]
    ds_read_b64_tr_b16 v[136:137], v194 offset:8192
    v_mfma_f32_16x16x32_bf16 v[36:39], v[172:175], v[156:159], v[36:39]
    ds_read_b64_tr_b16 v[138:139], v194 offset:8704
    v_mfma_f32_16x16x32_bf16 v[56:59], v[156:159], v[176:179], v[56:59]
    ds_read_b64_tr_b16 v[140:141], v196 offset:8192
    v_mfma_f32_16x16x32_bf16 v[60:63], v[156:159], v[180:183], v[60:63]
    ds_read_b64_tr_b16 v[142:143], v196 offset:8704
    v_mfma_f32_16x16x32_bf16 v[88:91], v[156:159], v[184:187], v[88:91]
    ds_read_b64_tr_b16 v[144:145], v194 offset:16384
    v_mfma_f32_16x16x32_bf16 v[92:95], v[156:159], v[188:191], v[92:95]
    ds_read_b64_tr_b16 v[146:147], v194 offset:16896
    v_mfma_f32_16x16x32_bf16 v[24:27], v[168:171], v[160:163], v[24:27]
    ds_read_b64_tr_b16 v[148:149], v196 offset:16384
    v_mfma_f32_16x16x32_bf16 v[40:43], v[172:175], v[160:163], v[40:43]
    ds_read_b64_tr_b16 v[150:151], v196 offset:16896
    v_mfma_f32_16x16x32_bf16 v[64:67], v[160:163], v[176:179], v[64:67]
    ds_read_b128 v[116:119], v192 offset:2048
    v_mfma_f32_16x16x32_bf16 v[68:71], v[160:163], v[180:183], v[68:71]
    ds_read_b128 v[120:123], v192 offset:4096
    v_mfma_f32_16x16x32_bf16 v[96:99], v[160:163], v[184:187], v[96:99]
    s_waitcnt lgkmcnt(14)
    ds_read_b128 v[124:127], v192 offset:6144
    v_mfma_f32_16x16x32_bf16 v[100:103], v[160:163], v[188:191], v[100:103]
    v_mfma_f32_16x16x32_bf16 v[28:31], v[168:171], v[164:167], v[28:31]
    v_mfma_f32_16x16x32_bf16 v[44:47], v[172:175], v[164:167], v[44:47]
    v_mfma_f32_16x16x32_bf16 v[72:75], v[164:167], v[176:179], v[72:75]
    v_mfma_f32_16x16x32_bf16 v[76:79], v[164:167], v[180:183], v[76:79]
    v_mfma_f32_16x16x32_bf16 v[104:107], v[164:167], v[184:187], v[104:107]
    v_mfma_f32_16x16x32_bf16 v[108:111], v[164:167], v[188:191], v[108:111]
L_cpb_23:
    s_add_u32 s57, s57, 1
    s_sub_u32 s55, s55, 1
    s_cmp_lg_u32 s55, 0
    s_cbranch_scc1 L_rc_7
    s_cmp_eq_u32 s57, s42
    s_cbranch_scc1 L_cp_28
    s_waitcnt lgkmcnt(0)
    v_mfma_f32_16x16x32_bf16 v[16:19], v[128:131], v[112:115], v[16:19]
    ds_read_b128 v[152:155], v193 offset:0
    v_mfma_f32_16x16x32_bf16 v[32:35], v[132:135], v[112:115], v[32:35]
    ds_read_b64_tr_b16 v[168:169], v194 offset:4096
    v_mfma_f32_16x16x32_bf16 v[48:51], v[112:115], v[136:139], v[48:51]
    ds_read_b64_tr_b16 v[170:171], v194 offset:4608
    v_mfma_f32_16x16x32_bf16 v[52:55], v[112:115], v[140:143], v[52:55]
    ds_read_b64_tr_b16 v[172:173], v196 offset:4096
    v_mfma_f32_16x16x32_bf16 v[80:83], v[112:115], v[144:147], v[80:83]
    ds_read_b64_tr_b16 v[174:175], v196 offset:4608
    v_mfma_f32_16x16x32_bf16 v[84:87], v[112:115], v[148:151], v[84:87]
    ds_read_b64_tr_b16 v[176:177], v194 offset:12288
    v_mfma_f32_16x16x32_bf16 v[20:23], v[128:131], v[116:119], v[20:23]
    ds_read_b64_tr_b16 v[178:179], v194 offset:12800
    v_mfma_f32_16x16x32_bf16 v[36:39], v[132:135], v[116:119], v[36:39]
    ds_read_b64_tr_b16 v[180:181], v196 offset:12288
    v_mfma_f32_16x16x32_bf16 v[56:59], v[116:119], v[136:139], v[56:59]
    ds_read_b64_tr_b16 v[182:183], v196 offset:12800
    v_mfma_f32_16x16x32_bf16 v[60:63], v[116:119], v[140:143], v[60:63]
    ds_read_b64_tr_b16 v[184:185], v194 offset:20480
    v_mfma_f32_16x16x32_bf16 v[88:91], v[116:119], v[144:147], v[88:91]
    ds_read_b64_tr_b16 v[186:187], v194 offset:20992
    v_mfma_f32_16x16x32_bf16 v[92:95], v[116:119], v[148:151], v[92:95]
    ds_read_b64_tr_b16 v[188:189], v196 offset:20480
    v_mfma_f32_16x16x32_bf16 v[24:27], v[128:131], v[120:123], v[24:27]
    ds_read_b64_tr_b16 v[190:191], v196 offset:20992
    v_mfma_f32_16x16x32_bf16 v[40:43], v[132:135], v[120:123], v[40:43]
    ds_read_b128 v[156:159], v193 offset:2048
    v_mfma_f32_16x16x32_bf16 v[64:67], v[120:123], v[136:139], v[64:67]
    ds_read_b128 v[160:163], v193 offset:4096
    v_mfma_f32_16x16x32_bf16 v[68:71], v[120:123], v[140:143], v[68:71]
    s_waitcnt lgkmcnt(14)
    ds_read_b128 v[164:167], v193 offset:6144
    v_mfma_f32_16x16x32_bf16 v[96:99], v[120:123], v[144:147], v[96:99]
    v_mfma_f32_16x16x32_bf16 v[100:103], v[120:123], v[148:151], v[100:103]
    v_mfma_f32_16x16x32_bf16 v[28:31], v[128:131], v[124:127], v[28:31]
    v_mfma_f32_16x16x32_bf16 v[44:47], v[132:135], v[124:127], v[44:47]
    v_mfma_f32_16x16x32_bf16 v[72:75], v[124:127], v[136:139], v[72:75]
    v_mfma_f32_16x16x32_bf16 v[76:79], v[124:127], v[140:143], v[76:79]
    v_mfma_f32_16x16x32_bf16 v[104:107], v[124:127], v[144:147], v[104:107]
    v_mfma_f32_16x16x32_bf16 v[108:111], v[124:127], v[148:151], v[108:111]
L_cpb_29:
    s_cmp_eq_u32 s57, s42
    s_cbranch_scc1 L_cp_30
    s_waitcnt lgkmcnt(0)
    v_mfma_f32_16x16x32_bf16 v[16:19], v[168:171], v[152:155], v[16:19]
    v_mfma_f32_16x16x32_bf16 v[32:35], v[172:175], v[152:155], v[32:35]
    s_barrier
    ds_read_b128 v[112:115], v192 offset:16384
    v_mfma_f32_16x16x32_bf16 v[48:51], v[152:155], v[176:179], v[48:51]
    ds_read_b64_tr_b16 v[128:129], v194 offset:24576
    v_mfma_f32_16x16x32_bf16 v[52:55], v[152:155], v[180:183], v[52:55]
    ds_read_b64_tr_b16 v[130:131], v194 offset:25088
    v_mfma_f32_16x16x32_bf16 v[80:83], v[152:155], v[184:187], v[80:83]
    ds_read_b64_tr_b16 v[132:133], v196 offset:24576
    v_mfma_f32_16x16x32_bf16 v[84:87], v[152:155], v[188:191], v[84:87]
    ds_read_b64_tr_b16 v[134:135], v196 offset:25088
    v_mfma_f32_16x16x32_bf16 v[20:23], v[168:171], v[156:159], v[20:23]
    ds_read_b64_tr_b16 v[136:137], v194 offset:32768
    v_mfma_f32_16x16x32_bf16 v[36:39], v[172:175], v[156:159], v[36:39]
    ds_read_b64_tr_b16 v[138:139], v194 offset:33280
    v_mfma_f32_16x16x32_bf16 v[56:59], v[156:159], v[176:179], v[56:59]
    ds_read_b64_tr_b16 v[140:141], v196 offset:32768
    v_mfma_f32_16x16x32_bf16 v[60:63], v[156:159], v[180:183], v[60:63]
    ds_read_b64_tr_b16 v[142:143], v196 offset:33280
    v_mfma_f32_16x16x32_bf16 v[88:91], v[156:159], v[184:187], v[88:91]
    ds_read_b64_tr_b16 v[144:145], v194 offset:40960
    v_mfma_f32_16x16x32_bf16 v[92:95], v[156:159], v[188:191], v[92:95]
    ds_read_b64_tr_b16 v[146:147], v194 offset:41472
    v_mfma_f32_16x16x32_bf16 v[24:27], v[168:171], v[160:163], v[24:27]
    ds_read_b64_tr_b16 v[148:149], v196 offset:40960
    v_mfma_f32_16x16x32_bf16 v[40:43], v[172:175], v[160:163], v[40:43]
    ds_read_b64_tr_b16 v[150:151], v196 offset:41472
    v_mfma_f32_16x16x32_bf16 v[64:67], v[160:163], v[176:179], v[64:67]
    ds_read_b128 v[116:119], v192 offset:18432
    v_mfma_f32_16x16x32_bf16 v[68:71], v[160:163], v[180:183], v[68:71]
    ds_read_b128 v[120:123], v192 offset:20480
    v_mfma_f32_16x16x32_bf16 v[96:99], v[160:163], v[184:187], v[96:99]
    s_waitcnt lgkmcnt(14)
    ds_read_b128 v[124:127], v192 offset:22528
    v_mfma_f32_16x16x32_bf16 v[100:103], v[160:163], v[188:191], v[100:103]
    v_mfma_f32_16x16x32_bf16 v[28:31], v[168:171], v[164:167], v[28:31]
    v_mfma_f32_16x16x32_bf16 v[44:47], v[172:175], v[164:167], v[44:47]
    v_mfma_f32_16x16x32_bf16 v[72:75], v[164:167], v[176:179], v[72:75]
    v_mfma_f32_16x16x32_bf16 v[76:79], v[164:167], v[180:183], v[76:79]
    v_mfma_f32_16x16x32_bf16 v[104:107], v[164:167], v[184:187], v[104:107]
    v_mfma_f32_16x16x32_bf16 v[108:111], v[164:167], v[188:191], v[108:111]
L_cpb_31:
    s_add_u32 s57, s57, 1
    s_cmp_eq_u32 s57, s42
    s_cbranch_scc1 L_cp_32
    s_waitcnt lgkmcnt(0)
    v_mfma_f32_16x16x32_bf16 v[16:19], v[128:131], v[112:115], v[16:19]
    ds_read_b128 v[152:155], v193 offset:16384
    v_mfma_f32_16x16x32_bf16 v[32:35], v[132:135], v[112:115], v[32:35]
    ds_read_b64_tr_b16 v[168:169], v194 offset:28672
    v_mfma_f32_16x16x32_bf16 v[48:51], v[112:115], v[136:139], v[48:51]
    ds_read_b64_tr_b16 v[170:171], v194 offset:29184
    v_mfma_f32_16x16x32_bf16 v[52:55], v[112:115], v[140:143], v[52:55]
    ds_read_b64_tr_b16 v[172:173], v196 offset:28672
    v_mfma_f32_16x16x32_bf16 v[80:83], v[112:115], v[144:147], v[80:83]
    ds_read_b64_tr_b16 v[174:175], v196 offset:29184
    v_mfma_f32_16x16x32_bf16 v[84:87], v[112:115], v[148:151], v[84:87]
    ds_read_b64_tr_b16 v[176:177], v194 offset:36864
    v_mfma_f32_16x16x32_bf16 v[20:23], v[128:131], v[116:119], v[20:23]
    ds_read_b64_tr_b16 v[178:179], v194 offset:37376
    v_mfma_f32_16x16x32_bf16 v[36:39], v[132:135], v[116:119], v[36:39]
    ds_read_b64_tr_b16 v[180:181], v196 offset:36864
    v_mfma_f32_16x16x32_bf16 v[56:59], v[116:119], v[136:139], v[56:59]
    ds_read_b64_tr_b16 v[182:183], v196 offset:37376
    v_mfma_f32_16x16x32_bf16 v[60:63], v[116:119], v[140:143], v[60:63]
    ds_read_b64_tr_b16 v[184:185], v194 offset:45056
    v_mfma_f32_16x16x32_bf16 v[88:91], v[116:119], v[144:147], v[88:91]
    ds_read_b64_tr_b16 v[186:187], v194 offset:45568
    v_mfma_f32_16x16x32_bf16 v[92:95], v[116:119], v[148:151], v[92:95]
    ds_read_b64_tr_b16 v[188:189], v196 offset:45056
    v_mfma_f32_16x16x32_bf16 v[24:27], v[128:131], v[120:123], v[24:27]
    ds_read_b64_tr_b16 v[190:191], v196 offset:45568
    v_mfma_f32_16x16x32_bf16 v[40:43], v[132:135], v[120:123], v[40:43]
    ds_read_b128 v[156:159], v193 offset:18432
    v_mfma_f32_16x16x32_bf16 v[64:67], v[120:123], v[136:139], v[64:67]
    ds_read_b128 v[160:163], v193 offset:20480
    v_mfma_f32_16x16x32_bf16 v[68:71], v[120:123], v[140:143], v[68:71]
    s_waitcnt lgkmcnt(14)
    ds_read_b128 v[164:167], v193 offset:22528
    v_mfma_f32_16x16x32_bf16 v[96:99], v[120:123], v[144:147], v[96:99]
    v_mfma_f32_16x16x32_bf16 v[100:103], v[120:123], v[148:151], v[100:103]
    v_mfma_f32_16x16x32_bf16 v[28:31], v[128:131], v[124:127], v[28:31]
    v_mfma_f32_16x16x32_bf16 v[44:47], v[132:135], v[124:127], v[44:47]
    v_mfma_f32_16x16x32_bf16 v[72:75], v[124:127], v[136:139], v[72:75]
    v_mfma_f32_16x16x32_bf16 v[76:79], v[124:127], v[140:143], v[76:79]
    v_mfma_f32_16x16x32_bf16 v[104:107], v[124:127], v[144:147], v[104:107]
    v_mfma_f32_16x16x32_bf16 v[108:111], v[124:127], v[148:151], v[108:111]
L_cpb_33:
    s_cmp_eq_u32 s57, s42
    s_cbranch_scc1 L_cp_34
    s_waitcnt lgkmcnt(0)
    v_mfma_f32_16x16x32_bf16 v[16:19], v[168:171], v[152:155], v[16:19]
    v_mfma_f32_16x16x32_bf16 v[32:35], v[172:175], v[152:155], v[32:35]
    s_barrier
    ds_read_b128 v[112:115], v192 offset:32768
    v_mfma_f32_16x16x32_bf16 v[48:51], v[152:155], v[176:179], v[48:51]
    ds_read_b64_tr_b16 v[128:129], v195 offset:0
    v_mfma_f32_16x16x32_bf16 v[52:55], v[152:155], v[180:183], v[52:55]
    ds_read_b64_tr_b16 v[130:131], v195 offset:512
    v_mfma_f32_16x16x32_bf16 v[80:83], v[152:155], v[184:187], v[80:83]
    ds_read_b64_tr_b16 v[132:133], v197 offset:0
    v_mfma_f32_16x16x32_bf16 v[84:87], v[152:155], v[188:191], v[84:87]
    ds_read_b64_tr_b16 v[134:135], v197 offset:512
    v_mfma_f32_16x16x32_bf16 v[20:23], v[168:171], v[156:159], v[20:23]
    ds_read_b64_tr_b16 v[136:137], v195 offset:8192
    v_mfma_f32_16x16x32_bf16 v[36:39], v[172:175], v[156:159], v[36:39]
    ds_read_b64_tr_b16 v[138:139], v195 offset:8704
    v_mfma_f32_16x16x32_bf16 v[56:59], v[156:159], v[176:179], v[56:59]
    ds_read_b64_tr_b16 v[140:141], v197 offset:8192
    v_mfma_f32_16x16x32_bf16 v[60:63], v[156:159], v[180:183], v[60:63]
    ds_read_b64_tr_b16 v[142:143], v197 offset:8704
    v_mfma_f32_16x16x32_bf16 v[88:91], v[156:159], v[184:187], v[88:91]
    ds_read_b64_tr_b16 v[144:145], v195 offset:16384
    v_mfma_f32_16x16x32_bf16 v[92:95], v[156:159], v[188:191], v[92:95]
    ds_read_b64_tr_b16 v[146:147], v195 offset:16896
    v_mfma_f32_16x16x32_bf16 v[24:27], v[168:171], v[160:163], v[24:27]
    ds_read_b64_tr_b16 v[148:149], v197 offset:16384
    v_mfma_f32_16x16x32_bf16 v[40:43], v[172:175], v[160:163], v[40:43]
    ds_read_b64_tr_b16 v[150:151], v197 offset:16896
    v_mfma_f32_16x16x32_bf16 v[64:67], v[160:163], v[176:179], v[64:67]
    ds_read_b128 v[116:119], v192 offset:34816
    v_mfma_f32_16x16x32_bf16 v[68:71], v[160:163], v[180:183], v[68:71]
    ds_read_b128 v[120:123], v192 offset:36864
    v_mfma_f32_16x16x32_bf16 v[96:99], v[160:163], v[184:187], v[96:99]
    s_waitcnt lgkmcnt(14)
    ds_read_b128 v[124:127], v192 offset:38912
    v_mfma_f32_16x16x32_bf16 v[100:103], v[160:163], v[188:191], v[100:103]
    v_mfma_f32_16x16x32_bf16 v[28:31], v[168:171], v[164:167], v[28:31]
    v_mfma_f32_16x16x32_bf16 v[44:47], v[172:175], v[164:167], v[44:47]
    v_mfma_f32_16x16x32_bf16 v[72:75], v[164:167], v[176:179], v[72:75]
    v_mfma_f32_16x16x32_bf16 v[76:79], v[164:167], v[180:183], v[76:79]
    v_mfma_f32_16x16x32_bf16 v[104:107], v[164:167], v[184:187], v[104:107]
    v_mfma_f32_16x16x32_bf16 v[108:111], v[164:167], v[188:191], v[108:111]
L_cpb_35:
    s_add_u32 s57, s57, 1
    s_cmp_eq_u32 s57, s42
    s_cbranch_scc1 L_cp_36
    s_waitcnt lgkmcnt(0)
    v_mfma_f32_16x16x32_bf16 v[16:19], v[128:131], v[112:115], v[16:19]
    ds_read_b128 v[152:155], v193 offset:32768
    v_mfma_f32_16x16x32_bf16 v[32:35], v[132:135], v[112:115], v[32:35]
    ds_read_b64_tr_b16 v[168:169], v195 offset:4096
    v_mfma_f32_16x16x32_bf16 v[48:51], v[112:115], v[136:139], v[48:51]
    ds_read_b64_tr_b16 v[170:171], v195 offset:4608
    v_mfma_f32_16x16x32_bf16 v[52:55], v[112:115], v[140:143], v[52:55]
    ds_read_b64_tr_b16 v[172:173], v197 offset:4096
    v_mfma_f32_16x16x32_bf16 v[80:83], v[112:115], v[144:147], v[80:83]
    ds_read_b64_tr_b16 v[174:175], v197 offset:4608
    v_mfma_f32_16x16x32_bf16 v[84:87], v[112:115], v[148:151], v[84:87]
    ds_read_b64_tr_b16 v[176:177], v195 offset:12288
    v_mfma_f32_16x16x32_bf16 v[20:23], v[128:131], v[116:119], v[20:23]
    ds_read_b64_tr_b16 v[178:179], v195 offset:12800
    v_mfma_f32_16x16x32_bf16 v[36:39], v[132:135], v[116:119], v[36:39]
    ds_read_b64_tr_b16 v[180:181], v197 offset:12288
    v_mfma_f32_16x16x32_bf16 v[56:59], v[116:119], v[136:139], v[56:59]
    ds_read_b64_tr_b16 v[182:183], v197 offset:12800
    v_mfma_f32_16x16x32_bf16 v[60:63], v[116:119], v[140:143], v[60:63]
    ds_read_b64_tr_b16 v[184:185], v195 offset:20480
    v_mfma_f32_16x16x32_bf16 v[88:91], v[116:119], v[144:147], v[88:91]
    ds_read_b64_tr_b16 v[186:187], v195 offset:20992
    v_mfma_f32_16x16x32_bf16 v[92:95], v[116:119], v[148:151], v[92:95]
    ds_read_b64_tr_b16 v[188:189], v197 offset:20480
    v_mfma_f32_16x16x32_bf16 v[24:27], v[128:131], v[120:123], v[24:27]
    ds_read_b64_tr_b16 v[190:191], v197 offset:20992
    v_mfma_f32_16x16x32_bf16 v[40:43], v[132:135], v[120:123], v[40:43]
    ds_read_b128 v[156:159], v193 offset:34816
    v_mfma_f32_16x16x32_bf16 v[64:67], v[120:123], v[136:139], v[64:67]
    ds_read_b128 v[160:163], v193 offset:36864
    v_mfma_f32_16x16x32_bf16 v[68:71], v[120:123], v[140:143], v[68:71]
    s_waitcnt lgkmcnt(14)
    ds_read_b128 v[164:167], v193 offset:38912
    v_mfma_f32_16x16x32_bf16 v[96:99], v[120:123], v[144:147], v[96:99]
    v_mfma_f32_16x16x32_bf16 v[100:103], v[120:123], v[148:151], v[100:103]
    v_mfma_f32_16x16x32_bf16 v[28:31], v[128:131], v[124:127], v[28:31]
    v_mfma_f32_16x16x32_bf16 v[44:47], v[132:135], v[124:127], v[44:47]
    v_mfma_f32_16x16x32_bf16 v[72:75], v[124:127], v[136:139], v[72:75]
    v_mfma_f32_16x16x32_bf16 v[76:79], v[124:127], v[140:143], v[76:79]
    v_mfma_f32_16x16x32_bf16 v[104:107], v[124:127], v[144:147], v[104:107]
    v_mfma_f32_16x16x32_bf16 v[108:111], v[124:127], v[148:151], v[108:111]
L_cpb_37:
    s_cmp_eq_u32 s57, s42
    s_cbranch_scc1 L_cp_38
    s_waitcnt lgkmcnt(0)
    v_mfma_f32_16x16x32_bf16 v[16:19], v[168:171], v[152:155], v[16:19]
    v_mfma_f32_16x16x32_bf16 v[32:35], v[172:175], v[152:155], v[32:35]
    s_barrier
    ds_read_b128 v[112:115], v192 offset:49152
    v_mfma_f32_16x16x32_bf16 v[48:51], v[152:155], v[176:179], v[48:51]
    ds_read_b64_tr_b16 v[128:129], v195 offset:24576
    v_mfma_f32_16x16x32_bf16 v[52:55], v[152:155], v[180:183], v[52:55]
    ds_read_b64_tr_b16 v[130:131], v195 offset:25088
    v_mfma_f32_16x16x32_bf16 v[80:83], v[152:155], v[184:187], v[80:83]
    ds_read_b64_tr_b16 v[132:133], v197 offset:24576
    v_mfma_f32_16x16x32_bf16 v[84:87], v[152:155], v[188:191], v[84:87]
    ds_read_b64_tr_b16 v[134:135], v197 offset:25088
    v_mfma_f32_16x16x32_bf16 v[20:23], v[168:171], v[156:159], v[20:23]
    ds_read_b64_tr_b16 v[136:137], v195 offset:32768
    v_mfma_f32_16x16x32_bf16 v[36:39], v[172:175], v[156:159], v[36:39]
    ds_read_b64_tr_b16 v[138:139], v195 offset:33280
    v_mfma_f32_16x16x32_bf16 v[56:59], v[156:159], v[176:179], v[56:59]
    ds_read_b64_tr_b16 v[140:141], v197 offset:32768
    v_mfma_f32_16x16x32_bf16 v[60:63], v[156:159], v[180:183], v[60:63]
    ds_read_b64_tr_b16 v[142:143], v197 offset:33280
    v_mfma_f32_16x16x32_bf16 v[88:91], v[156:159], v[184:187], v[88:91]
    ds_read_b64_tr_b16 v[144:145], v195 offset:40960
    v_mfma_f32_16x16x32_bf16 v[92:95], v[156:159], v[188:191], v[92:95]
    ds_read_b64_tr_b16 v[146:147], v195 offset:41472
    v_mfma_f32_16x16x32_bf16 v[24:27], v[168:171], v[160:163], v[24:27]
    ds_read_b64_tr_b16 v[148:149], v197 offset:40960
    v_mfma_f32_16x16x32_bf16 v[40:43], v[172:175], v[160:163], v[40:43]
    ds_read_b64_tr_b16 v[150:151], v197 offset:41472
    v_mfma_f32_16x16x32_bf16 v[64:67], v[160:163], v[176:179], v[64:67]
    ds_read_b128 v[116:119], v192 offset:51200
    v_mfma_f32_16x16x32_bf16 v[68:71], v[160:163], v[180:183], v[68:71]
    ds_read_b128 v[120:123], v192 offset:53248
    v_mfma_f32_16x16x32_bf16 v[96:99], v[160:163], v[184:187], v[96:99]
    s_waitcnt lgkmcnt(14)
    ds_read_b128 v[124:127], v192 offset:55296
    v_mfma_f32_16x16x32_bf16 v[100:103], v[160:163], v[188:191], v[100:103]
    v_mfma_f32_16x16x32_bf16 v[28:31], v[168:171], v[164:167], v[28:31]
    v_mfma_f32_16x16x32_bf16 v[44:47], v[172:175], v[164:167], v[44:47]
    v_mfma_f32_16x16x32_bf16 v[72:75], v[164:167], v[176:179], v[72:75]
    v_mfma_f32_16x16x32_bf16 v[76:79], v[164:167], v[180:183], v[76:79]
    v_mfma_f32_16x16x32_bf16 v[104:107], v[164:167], v[184:187], v[104:107]
    v_mfma_f32_16x16x32_bf16 v[108:111], v[164:167], v[188:191], v[108:111]
L_cpb_39:
    s_add_u32 s57, s57, 1
    s_cmp_eq_u32 s57, s42
    s_cbranch_scc1 L_cp_40
    s_waitcnt lgkmcnt(0)
    v_mfma_f32_16x16x32_bf16 v[16:19], v[128:131], v[112:115], v[16:19]
    ds_read_b128 v[152:155], v193 offset:49152
    v_mfma_f32_16x16x32_bf16 v[32:35], v[132:135], v[112:115], v[32:35]
    ds_read_b64_tr_b16 v[168:169], v195 offset:28672
    v_mfma_f32_16x16x32_bf16 v[48:51], v[112:115], v[136:139], v[48:51]
    ds_read_b64_tr_b16 v[170:171], v195 offset:29184
    v_mfma_f32_16x16x32_bf16 v[52:55], v[112:115], v[140:143], v[52:55]
    ds_read_b64_tr_b16 v[172:173], v197 offset:28672
    v_mfma_f32_16x16x32_bf16 v[80:83], v[112:115], v[144:147], v[80:83]
    ds_read_b64_tr_b16 v[174:175], v197 offset:29184
    v_mfma_f32_16x16x32_bf16 v[84:87], v[112:115], v[148:151], v[84:87]
    ds_read_b64_tr_b16 v[176:177], v195 offset:36864
    v_mfma_f32_16x16x32_bf16 v[20:23], v[128:131], v[116:119], v[20:23]
    ds_read_b64_tr_b16 v[178:179], v195 offset:37376
    v_mfma_f32_16x16x32_bf16 v[36:39], v[132:135], v[116:119], v[36:39]
    ds_read_b64_tr_b16 v[180:181], v197 offset:36864
    v_mfma_f32_16x16x32_bf16 v[56:59], v[116:119], v[136:139], v[56:59]
    ds_read_b64_tr_b16 v[182:183], v197 offset:37376
    v_mfma_f32_16x16x32_bf16 v[60:63], v[116:119], v[140:143], v[60:63]
    ds_read_b64_tr_b16 v[184:185], v195 offset:45056
    v_mfma_f32_16x16x32_bf16 v[88:91], v[116:119], v[144:147], v[88:91]
    ds_read_b64_tr_b16 v[186:187], v195 offset:45568
    v_mfma_f32_16x16x32_bf16 v[92:95], v[116:119], v[148:151], v[92:95]
    ds_read_b64_tr_b16 v[188:189], v197 offset:45056
    v_mfma_f32_16x16x32_bf16 v[24:27], v[128:131], v[120:123], v[24:27]
    ds_read_b64_tr_b16 v[190:191], v197 offset:45568
    v_mfma_f32_16x16x32_bf16 v[40:43], v[132:135], v[120:123], v[40:43]
    ds_read_b128 v[156:159], v193 offset:51200
    v_mfma_f32_16x16x32_bf16 v[64:67], v[120:123], v[136:139], v[64:67]
    ds_read_b128 v[160:163], v193 offset:53248
    v_mfma_f32_16x16x32_bf16 v[68:71], v[120:123], v[140:143], v[68:71]
    s_waitcnt lgkmcnt(14)
    ds_read_b128 v[164:167], v193 offset:55296
    v_mfma_f32_16x16x32_bf16 v[96:99], v[120:123], v[144:147], v[96:99]
    v_mfma_f32_16x16x32_bf16 v[100:103], v[120:123], v[148:151], v[100:103]
    v_mfma_f32_16x16x32_bf16 v[28:31], v[128:131], v[124:127], v[28:31]
    v_mfma_f32_16x16x32_bf16 v[44:47], v[132:135], v[124:127], v[44:47]
    v_mfma_f32_16x16x32_bf16 v[72:75], v[124:127], v[136:139], v[72:75]
    v_mfma_f32_16x16x32_bf16 v[76:79], v[124:127], v[140:143], v[76:79]
    v_mfma_f32_16x16x32_bf16 v[104:107], v[124:127], v[144:147], v[104:107]
    v_mfma_f32_16x16x32_bf16 v[108:111], v[124:127], v[148:151], v[108:111]
L_cpb_41:
    s_cmp_eq_u32 s57, s42
    s_cbranch_scc1 L_cp_42
    s_waitcnt lgkmcnt(0)
    v_mfma_f32_16x16x32_bf16 v[16:19], v[168:171], v[152:155], v[16:19]
    v_mfma_f32_16x16x32_bf16 v[32:35], v[172:175], v[152:155], v[32:35]
    v_mfma_f32_16x16x32_bf16 v[48:51], v[152:155], v[176:179], v[48:51]
    v_mfma_f32_16x16x32_bf16 v[52:55], v[152:155], v[180:183], v[52:55]
    v_mfma_f32_16x16x32_bf16 v[80:83], v[152:155], v[184:187], v[80:83]
    v_mfma_f32_16x16x32_bf16 v[84:87], v[152:155], v[188:191], v[84:87]
    v_mfma_f32_16x16x32_bf16 v[20:23], v[168:171], v[156:159], v[20:23]
    v_mfma_f32_16x16x32_bf16 v[36:39], v[172:175], v[156:159], v[36:39]
    v_mfma_f32_16x16x32_bf16 v[56:59], v[156:159], v[176:179], v[56:59]
    v_mfma_f32_16x16x32_bf16 v[60:63], v[156:159], v[180:183], v[60:63]
    v_mfma_f32_16x16x32_bf16 v[88:91], v[156:159], v[184:187], v[88:91]
    v_mfma_f32_16x16x32_bf16 v[92:95], v[156:159], v[188:191], v[92:95]
    v_mfma_f32_16x16x32_bf16 v[24:27], v[168:171], v[160:163], v[24:27]
    v_mfma_f32_16x16x32_bf16 v[40:43], v[172:175], v[160:163], v[40:43]
    v_mfma_f32_16x16x32_bf16 v[64:67], v[160:163], v[176:179], v[64:67]
    v_mfma_f32_16x16x32_bf16 v[68:71], v[160:163], v[180:183], v[68:71]
    v_mfma_f32_16x16x32_bf16 v[96:99], v[160:163], v[184:187], v[96:99]
    v_mfma_f32_16x16x32_bf16 v[100:103], v[160:163], v[188:191], v[100:103]
    v_mfma_f32_16x16x32_bf16 v[28:31], v[168:171], v[164:167], v[28:31]
    v_mfma_f32_16x16x32_bf16 v[44:47], v[172:175], v[164:167], v[44:47]
    v_mfma_f32_16x16x32_bf16 v[72:75], v[164:167], v[176:179], v[72:75]
    v_mfma_f32_16x16x32_bf16 v[76:79], v[164:167], v[180:183], v[76:79]
    v_mfma_f32_16x16x32_bf16 v[104:107], v[164:167], v[184:187], v[104:107]
    v_mfma_f32_16x16x32_bf16 v[108:111], v[164:167], v[188:191], v[108:111]
L_cpb_43:
    s_add_u32 s57, s57, 1
    s_branch L_coldskip_44
L_cp_8:
    s_waitcnt lgkmcnt(0)
    v_mfma_f32_16x16x32_bf16 v[16:19], v[128:131], v[112:115], v[16:19]
    ds_read_b128 v[152:155], v193 offset:0
    v_mfma_f32_16x16x32_bf16 v[32:35], v[132:135], v[112:115], v[32:35]
    ds_read_b64_tr_b16 v[168:169], v194 offset:4096
    v_mfma_f32_16x16x32_bf16 v[48:51], v[112:115], v[136:139], v[48:51]
    ds_read_b64_tr_b16 v[170:171], v194 offset:4608
    v_mfma_f32_16x16x32_bf16 v[52:55], v[112:115], v[140:143], v[52:55]
    ds_read_b64_tr_b16 v[172:173], v196 offset:4096
    s_add_u32 s59, s58, 0
    s_cmp_lg_u32 s48, 0
    s_cbranch_scc1 L_cs1_45
    buffer_store_dwordx4 v[128:131], v198, s[28:31], s59 offen sc1
    s_branch L_cs2_46
L_cs1_45:
    buffer_store_dwordx4 v[132:135], v198, s[28:31], s59 offen offset:1024 sc1
L_cs2_46:
    v_mfma_f32_16x16x32_bf16 v[80:83], v[112:115], v[144:147], v[80:83]
    ds_read_b64_tr_b16 v[174:175], v196 offset:4608
    v_mfma_f32_16x16x32_bf16 v[84:87], v[112:115], v[148:151], v[84:87]
    ds_read_b64_tr_b16 v[176:177], v194 offset:12288
    v_mfma_f32_16x16x32_bf16 v[20:23], v[128:131], v[116:119], v[20:23]
    ds_read_b64_tr_b16 v[178:179], v194 offset:12800
    v_mfma_f32_16x16x32_bf16 v[36:39], v[132:135], v[116:119], v[36:39]
    ds_read_b64_tr_b16 v[180:181], v196 offset:12288
    v_mfma_f32_16x16x32_bf16 v[56:59], v[116:119], v[136:139], v[56:59]
    ds_read_b64_tr_b16 v[182:183], v196 offset:12800
    v_mfma_f32_16x16x32_bf16 v[60:63], v[116:119], v[140:143], v[60:63]
    ds_read_b64_tr_b16 v[184:185], v194 offset:20480
    v_mfma_f32_16x16x32_bf16 v[88:91], v[116:119], v[144:147], v[88:91]
    ds_read_b64_tr_b16 v[186:187], v194 offset:20992
    s_add_u32 s59, s58, 4096
    s_cmp_lg_u32 s48, 0
    s_cbranch_scc1 L_cs1_47
    buffer_store_dwordx4 v[136:139], v198, s[28:31], s59 offen sc1
    s_branch L_cs2_48
L_cs1_47:
    buffer_store_dwordx4 v[140:143], v198, s[28:31], s59 offen offset:1024 sc1
L_cs2_48:
    v_mfma_f32_16x16x32_bf16 v[92:95], v[116:119], v[148:151], v[92:95]
    ds_read_b64_tr_b16 v[188:189], v196 offset:20480
    v_mfma_f32_16x16x32_bf16 v[24:27], v[128:131], v[120:123], v[24:27]
    ds_read_b64_tr_b16 v[190:191], v196 offset:20992
    v_mfma_f32_16x16x32_bf16 v[40:43], v[132:135], v[120:123], v[40:43]
    ds_read_b128 v[156:159], v193 offset:2048
    v_mfma_f32_16x16x32_bf16 v[64:67], v[120:123], v[136:139], v[64:67]
    ds_read_b128 v[160:163], v193 offset:4096
    v_mfma_f32_16x16x32_bf16 v[68:71], v[120:123], v[140:143], v[68:71]
    s_waitcnt lgkmcnt(14)
    ds_read_b128 v[164:167], v193 offset:6144
    v_mfma_f32_16x16x32_bf16 v[96:99], v[120:123], v[144:147], v[96:99]
    v_mfma_f32_16x16x32_bf16 v[100:103], v[120:123], v[148:151], v[100:103]
    s_add_u32 s59, s58, 8192
    s_cmp_lg_u32 s48, 0
    s_cbranch_scc1 L_cs1_49
    buffer_store_dwordx4 v[144:147], v198, s[28:31], s59 offen sc1
    s_branch L_cs2_50
L_cs1_49:
    buffer_store_dwordx4 v[148:151], v198, s[28:31], s59 offen offset:1024 sc1
L_cs2_50:
    v_mfma_f32_16x16x32_bf16 v[28:31], v[128:131], v[124:127], v[28:31]
    v_mfma_f32_16x16x32_bf16 v[44:47], v[132:135], v[124:127], v[44:47]
    v_mfma_f32_16x16x32_bf16 v[72:75], v[124:127], v[136:139], v[72:75]
    v_mfma_f32_16x16x32_bf16 v[76:79], v[124:127], v[140:143], v[76:79]
    v_mfma_f32_16x16x32_bf16 v[104:107], v[124:127], v[144:147], v[104:107]
    v_mfma_f32_16x16x32_bf16 v[108:111], v[124:127], v[148:151], v[108:111]
    s_branch L_cpb_9
L_cp_10:
    s_waitcnt lgkmcnt(0)
    v_mfma_f32_16x16x32_bf16 v[16:19], v[168:171], v[152:155], v[16:19]
    v_mfma_f32_16x16x32_bf16 v[32:35], v[172:175], v[152:155], v[32:35]
    s_barrier
    ds_read_b128 v[112:115], v192 offset:16384
    v_mfma_f32_16x16x32_bf16 v[48:51], v[152:155], v[176:179], v[48:51]
    ds_read_b64_tr_b16 v[128:129], v194 offset:24576
    v_mfma_f32_16x16x32_bf16 v[52:55], v[152:155], v[180:183], v[52:55]
    s_add_u32 s59, s58, 12288
    s_cmp_lg_u32 s48, 0
    s_cbranch_scc1 L_cs1_51
    buffer_store_dwordx4 v[168:171], v198, s[28:31], s59 offen sc1
    s_branch L_cs2_52
L_cs1_51:
    buffer_store_dwordx4 v[172:175], v198, s[28:31], s59 offen offset:1024 sc1
L_cs2_52:
    ds_read_b64_tr_b16 v[130:131], v194 offset:25088
    v_mfma_f32_16x16x32_bf16 v[80:83], v[152:155], v[184:187], v[80:83]
    ds_read_b64_tr_b16 v[132:133], v196 offset:24576
    v_mfma_f32_16x16x32_bf16 v[84:87], v[152:155], v[188:191], v[84:87]
    ds_read_b64_tr_b16 v[134:135], v196 offset:25088
    v_mfma_f32_16x16x32_bf16 v[20:23], v[168:171], v[156:159], v[20:23]
    ds_read_b64_tr_b16 v[136:137], v194 offset:32768
    v_mfma_f32_16x16x32_bf16 v[36:39], v[172:175], v[156:159], v[36:39]
    ds_read_b64_tr_b16 v[138:139], v194 offset:33280
    v_mfma_f32_16x16x32_bf16 v[56:59], v[156:159], v[176:179], v[56:59]
    ds_read_b64_tr_b16 v[140:141], v196 offset:32768
    v_mfma_f32_16x16x32_bf16 v[60:63], v[156:159], v[180:183], v[60:63]
    ds_read_b64_tr_b16 v[142:143], v196 offset:33280
    v_mfma_f32_16x16x32_bf16 v[88:91], v[156:159], v[184:187], v[88:91]
    s_add_u32 s59, s58, 16384
    s_cmp_lg_u32 s48, 0
    s_cbranch_scc1 L_cs1_53
    buffer_store_dwordx4 v[176:179], v198, s[28:31], s59 offen sc1
    s_branch L_cs2_54
L_cs1_53:
    buffer_store_dwordx4 v[180:183], v198, s[28:31], s59 offen offset:1024 sc1
L_cs2_54:
    ds_read_b64_tr_b16 v[144:145], v194 offset:40960
    v_mfma_f32_16x16x32_bf16 v[92:95], v[156:159], v[188:191], v[92:95]
    ds_read_b64_tr_b16 v[146:147], v194 offset:41472
    v_mfma_f32_16x16x32_bf16 v[24:27], v[168:171], v[160:163], v[24:27]
    ds_read_b64_tr_b16 v[148:149], v196 offset:40960
    v_mfma_f32_16x16x32_bf16 v[40:43], v[172:175], v[160:163], v[40:43]
    ds_read_b64_tr_b16 v[150:151], v196 offset:41472
    v_mfma_f32_16x16x32_bf16 v[64:67], v[160:163], v[176:179], v[64:67]
    ds_read_b128 v[116:119], v192 offset:18432
    v_mfma_f32_16x16x32_bf16 v[68:71], v[160:163], v[180:183], v[68:71]
    ds_read_b128 v[120:123], v192 offset:20480
    v_mfma_f32_16x16x32_bf16 v[96:99], v[160:163], v[184:187], v[96:99]
    s_waitcnt lgkmcnt(14)
    ds_read_b128 v[124:127], v192 offset:22528
    v_mfma_f32_16x16x32_bf16 v[100:103], v[160:163], v[188:191], v[100:103]
    s_add_u32 s59, s58, 20480
    s_cmp_lg_u32 s48, 0
    s_cbranch_scc1 L_cs1_55
    buffer_store_dwordx4 v[184:187], v198, s[28:31], s59 offen sc1
    s_branch L_cs2_56
L_cs1_55:
    buffer_store_dwordx4 v[188:191], v198, s[28:31], s59 offen offset:1024 sc1
L_cs2_56:
    v_mfma_f32_16x16x32_bf16 v[28:31], v[168:171], v[164:167], v[28:31]
    v_mfma_f32_16x16x32_bf16 v[44:47], v[172:175], v[164:167], v[44:47]
    v_mfma_f32_16x16x32_bf16 v[72:75], v[164:167], v[176:179], v[72:75]
    v_mfma_f32_16x16x32_bf16 v[76:79], v[164:167], v[180:183], v[76:79]
    v_mfma_f32_16x16x32_bf16 v[104:107], v[164:167], v[184:187], v[104:107]
    v_mfma_f32_16x16x32_bf16 v[108:111], v[164:167], v[188:191], v[108:111]
    s_branch L_cpb_11
L_cp_12:
    s_waitcnt lgkmcnt(0)
    v_mfma_f32_16x16x32_bf16 v[16:19], v[128:131], v[112:115], v[16:19]
    ds_read_b128 v[152:155], v193 offset:16384
    v_mfma_f32_16x16x32_bf16 v[32:35], v[132:135], v[112:115], v[32:35]
    ds_read_b64_tr_b16 v[168:169], v194 offset:28672
    v_mfma_f32_16x16x32_bf16 v[48:51], v[112:115], v[136:139], v[48:51]
    ds_read_b64_tr_b16 v[170:171], v194 offset:29184
    v_mfma_f32_16x16x32_bf16 v[52:55], v[112:115], v[140:143], v[52:55]
    ds_read_b64_tr_b16 v[172:173], v196 offset:28672
    s_add_u32 s59, s58, 0
    s_cmp_lg_u32 s48, 0
    s_cbranch_scc1 L_cs1_57
    buffer_store_dwordx4 v[128:131], v198, s[28:31], s59 offen sc1
    s_branch L_cs2_58
L_cs1_57:
    buffer_store_dwordx4 v[132:135], v198, s[28:31], s59 offen offset:1024 sc1
L_cs2_58:
    v_mfma_f32_16x16x32_bf16 v[80:83], v[112:115], v[144:147], v[80:83]
    ds_read_b64_tr_b16 v[174:175], v196 offset:29184
    v_mfma_f32_16x16x32_bf16 v[84:87], v[112:115], v[148:151], v[84:87]
    ds_read_b64_tr_b16 v[176:177], v194 offset:36864
    v_mfma_f32_16x16x32_bf16 v[20:23], v[128:131], v[116:119], v[20:23]
    ds_read_b64_tr_b16 v[178:179], v194 offset:37376
    v_mfma_f32_16x16x32_bf16 v[36:39], v[132:135], v[116:119], v[36:39]
    ds_read_b64_tr_b16 v[180:181], v196 offset:36864
    v_mfma_f32_16x16x32_bf16 v[56:59], v[116:119], v[136:139], v[56:59]
    ds_read_b64_tr_b16 v[182:183], v196 offset:37376
    v_mfma_f32_16x16x32_bf16 v[60:63], v[116:119], v[140:143], v[60:63]
    ds_read_b64_tr_b16 v[184:185], v194 offset:45056
    v_mfma_f32_16x16x32_bf16 v[88:91], v[116:119], v[144:147], v[88:91]
    ds_read_b64_tr_b16 v[186:187], v194 offset:45568
    s_add_u32 s59, s58, 4096
    s_cmp_lg_u32 s48, 0
    s_cbranch_scc1 L_cs1_59
    buffer_store_dwordx4 v[136:139], v198, s[28:31], s59 offen sc1
    s_branch L_cs2_60
L_cs1_59:
    buffer_store_dwordx4 v[140:143], v198, s[28:31], s59 offen offset:1024 sc1
L_cs2_60:
    v_mfma_f32_16x16x32_bf16 v[92:95], v[116:119], v[148:151], v[92:95]
    ds_read_b64_tr_b16 v[188:189], v196 offset:45056
    v_mfma_f32_16x16x32_bf16 v[24:27], v[128:131], v[120:123], v[24:27]
    ds_read_b64_tr_b16 v[190:191], v196 offset:45568
    v_mfma_f32_16x16x32_bf16 v[40:43], v[132:135], v[120:123], v[40:43]
    ds_read_b128 v[156:159], v193 offset:18432
    v_mfma_f32_16x16x32_bf16 v[64:67], v[120:123], v[136:139], v[64:67]
    ds_read_b128 v[160:163], v193 offset:20480
    v_mfma_f32_16x16x32_bf16 v[68:71], v[120:123], v[140:143], v[68:71]
    s_waitcnt lgkmcnt(14)
    ds_read_b128 v[164:167], v193 offset:22528
    v_mfma_f32_16x16x32_bf16 v[96:99], v[120:123], v[144:147], v[96:99]
    v_mfma_f32_16x16x32_bf16 v[100:103], v[120:123], v[148:151], v[100:103]
    s_add_u32 s59, s58, 8192
    s_cmp_lg_u32 s48, 0
    s_cbranch_scc1 L_cs1_61
    buffer_store_dwordx4 v[144:147], v198, s[28:31], s59 offen sc1
    s_branch L_cs2_62
L_cs1_61:
    buffer_store_dwordx4 v[148:151], v198, s[28:31], s59 offen offset:1024 sc1
L_cs2_62:
    v_mfma_f32_16x16x32_bf16 v[28:31], v[128:131], v[124:127], v[28:31]
    v_mfma_f32_16x16x32_bf16 v[44:47], v[132:135], v[124:127], v[44:47]
    v_mfma_f32_16x16x32_bf16 v[72:75], v[124:127], v[136:139], v[72:75]
    v_mfma_f32_16x16x32_bf16 v[76:79], v[124:127], v[140:143], v[76:79]
    v_mfma_f32_16x16x32_bf16 v[104:107], v[124:127], v[144:147], v[104:107]
    v_mfma_f32_16x16x32_bf16 v[108:111], v[124:127], v[148:151], v[108:111]
    s_branch L_cpb_13
L_cp_14:
    s_waitcnt lgkmcnt(0)
    v_mfma_f32_16x16x32_bf16 v[16:19], v[168:171], v[152:155], v[16:19]
    v_mfma_f32_16x16x32_bf16 v[32:35], v[172:175], v[152:155], v[32:35]
    s_barrier
    ds_read_b128 v[112:115], v192 offset:32768
    v_mfma_f32_16x16x32_bf16 v[48:51], v[152:155], v[176:179], v[48:51]
    ds_read_b64_tr_b16 v[128:129], v195 offset:0
    v_mfma_f32_16x16x32_bf16 v[52:55], v[152:155], v[180:183], v[52:55]
    s_add_u32 s59, s58, 12288
    s_cmp_lg_u32 s48, 0
    s_cbranch_scc1 L_cs1_63
    buffer_store_dwordx4 v[168:171], v198, s[28:31], s59 offen sc1
    s_branch L_cs2_64
L_cs1_63:
    buffer_store_dwordx4 v[172:175], v198, s[28:31], s59 offen offset:1024 sc1
L_cs2_64:
    ds_read_b64_tr_b16 v[130:131], v195 offset:512
    v_mfma_f32_16x16x32_bf16 v[80:83], v[152:155], v[184:187], v[80:83]
    ds_read_b64_tr_b16 v[132:133], v197 offset:0
    v_mfma_f32_16x16x32_bf16 v[84:87], v[152:155], v[188:191], v[84:87]
    ds_read_b64_tr_b16 v[134:135], v197 offset:512
    v_mfma_f32_16x16x32_bf16 v[20:23], v[168:171], v[156:159], v[20:23]
    ds_read_b64_tr_b16 v[136:137], v195 offset:8192
    v_mfma_f32_16x16x32_bf16 v[36:39], v[172:175], v[156:159], v[36:39]
    ds_read_b64_tr_b16 v[138:139], v195 offset:8704
    v_mfma_f32_16x16x32_bf16 v[56:59], v[156:159], v[176:179], v[56:59]
    ds_read_b64_tr_b16 v[140:141], v197 offset:8192
    v_mfma_f32_16x16x32_bf16 v[60:63], v[156:159], v[180:183], v[60:63]
    ds_read_b64_tr_b16 v[142:143], v197 offset:8704
    v_mfma_f32_16x16x32_bf16 v[88:91], v[156:159], v[184:187], v[88:91]
    s_add_u32 s59, s58, 16384
    s_cmp_lg_u32 s48, 0
    s_cbranch_scc1 L_cs1_65
    buffer_store_dwordx4 v[176:179], v198, s[28:31], s59 offen sc1
    s_branch L_cs2_66
L_cs1_65:
    buffer_store_dwordx4 v[180:183], v198, s[28:31], s59 offen offset:1024 sc1
L_cs2_66:
    ds_read_b64_tr_b16 v[144:145], v195 offset:16384
    v_mfma_f32_16x16x32_bf16 v[92:95], v[156:159], v[188:191], v[92:95]
    ds_read_b64_tr_b16 v[146:147], v195 offset:16896
    v_mfma_f32_16x16x32_bf16 v[24:27], v[168:171], v[160:163], v[24:27]
    ds_read_b64_tr_b16 v[148:149], v197 offset:16384
    v_mfma_f32_16x16x32_bf16 v[40:43], v[172:175], v[160:163], v[40:43]
    ds_read_b64_tr_b16 v[150:151], v197 offset:16896
    v_mfma_f32_16x16x32_bf16 v[64:67], v[160:163], v[176:179], v[64:67]
    ds_read_b128 v[116:119], v192 offset:34816
    v_mfma_f32_16x16x32_bf16 v[68:71], v[160:163], v[180:183], v[68:71]
    ds_read_b128 v[120:123], v192 offset:36864
    v_mfma_f32_16x16x32_bf16 v[96:99], v[160:163], v[184:187], v[96:99]
    s_waitcnt lgkmcnt(14)
    ds_read_b128 v[124:127], v192 offset:38912
    v_mfma_f32_16x16x32_bf16 v[100:103], v[160:163], v[188:191], v[100:103]
    s_add_u32 s59, s58, 20480
    s_cmp_lg_u32 s48, 0
    s_cbranch_scc1 L_cs1_67
    buffer_store_dwordx4 v[184:187], v198, s[28:31], s59 offen sc1
    s_branch L_cs2_68
L_cs1_67:
    buffer_store_dwordx4 v[188:191], v198, s[28:31], s59 offen offset:1024 sc1
L_cs2_68:
    v_mfma_f32_16x16x32_bf16 v[28:31], v[168:171], v[164:167], v[28:31]
    v_mfma_f32_16x16x32_bf16 v[44:47], v[172:175], v[164:167], v[44:47]
    v_mfma_f32_16x16x32_bf16 v[72:75], v[164:167], v[176:179], v[72:75]
    v_mfma_f32_16x16x32_bf16 v[76:79], v[164:167], v[180:183], v[76:79]
    v_mfma_f32_16x16x32_bf16 v[104:107], v[164:167], v[184:187], v[104:107]
    v_mfma_f32_16x16x32_bf16 v[108:111], v[164:167], v[188:191], v[108:111]
    s_branch L_cpb_15
L_cp_16:
    s_waitcnt lgkmcnt(0)
    v_mfma_f32_16x16x32_bf16 v[16:19], v[128:131], v[112:115], v[16:19]
    ds_read_b128 v[152:155], v193 offset:32768
    v_mfma_f32_16x16x32_bf16 v[32:35], v[132:135], v[112:115], v[32:35]
    ds_read_b64_tr_b16 v[168:169], v195 offset:4096
    v_mfma_f32_16x16x32_bf16 v[48:51], v[112:115], v[136:139], v[48:51]
    ds_read_b64_tr_b16 v[170:171], v195 offset:4608
    v_mfma_f32_16x16x32_bf16 v[52:55], v[112:115], v[140:143], v[52:55]
    ds_read_b64_tr_b16 v[172:173], v197 offset:4096
    s_add_u32 s59, s58, 0
    s_cmp_lg_u32 s48, 0
    s_cbranch_scc1 L_cs1_69
    buffer_store_dwordx4 v[128:131], v198, s[28:31], s59 offen sc1
    s_branch L_cs2_70
L_cs1_69:
    buffer_store_dwordx4 v[132:135], v198, s[28:31], s59 offen offset:1024 sc1
L_cs2_70:
    v_mfma_f32_16x16x32_bf16 v[80:83], v[112:115], v[144:147], v[80:83]
    ds_read_b64_tr_b16 v[174:175], v197 offset:4608
    v_mfma_f32_16x16x32_bf16 v[84:87], v[112:115], v[148:151], v[84:87]
    ds_read_b64_tr_b16 v[176:177], v195 offset:12288
    v_mfma_f32_16x16x32_bf16 v[20:23], v[128:131], v[116:119], v[20:23]
    ds_read_b64_tr_b16 v[178:179], v195 offset:12800
    v_mfma_f32_16x16x32_bf16 v[36:39], v[132:135], v[116:119], v[36:39]
    ds_read_b64_tr_b16 v[180:181], v197 offset:12288
    v_mfma_f32_16x16x32_bf16 v[56:59], v[116:119], v[136:139], v[56:59]
    ds_read_b64_tr_b16 v[182:183], v197 offset:12800
    v_mfma_f32_16x16x32_bf16 v[60:63], v[116:119], v[140:143], v[60:63]
    ds_read_b64_tr_b16 v[184:185], v195 offset:20480
    v_mfma_f32_16x16x32_bf16 v[88:91], v[116:119], v[144:147], v[88:91]
    ds_read_b64_tr_b16 v[186:187], v195 offset:20992
    s_add_u32 s59, s58, 4096
    s_cmp_lg_u32 s48, 0
    s_cbranch_scc1 L_cs1_71
    buffer_store_dwordx4 v[136:139], v198, s[28:31], s59 offen sc1
    s_branch L_cs2_72
L_cs1_71:
    buffer_store_dwordx4 v[140:143], v198, s[28:31], s59 offen offset:1024 sc1
L_cs2_72:
    v_mfma_f32_16x16x32_bf16 v[92:95], v[116:119], v[148:151], v[92:95]
    ds_read_b64_tr_b16 v[188:189], v197 offset:20480
    v_mfma_f32_16x16x32_bf16 v[24:27], v[128:131], v[120:123], v[24:27]
    ds_read_b64_tr_b16 v[190:191], v197 offset:20992
    v_mfma_f32_16x16x32_bf16 v[40:43], v[132:135], v[120:123], v[40:43]
    ds_read_b128 v[156:159], v193 offset:34816
    v_mfma_f32_16x16x32_bf16 v[64:67], v[120:123], v[136:139], v[64:67]
    ds_read_b128 v[160:163], v193 offset:36864
    v_mfma_f32_16x16x32_bf16 v[68:71], v[120:123], v[140:143], v[68:71]
    s_waitcnt lgkmcnt(14)
    ds_read_b128 v[164:167], v193 offset:38912
    v_mfma_f32_16x16x32_bf16 v[96:99], v[120:123], v[144:147], v[96:99]
    v_mfma_f32_16x16x32_bf16 v[100:103], v[120:123], v[148:151], v[100:103]
    s_add_u32 s59, s58, 8192
    s_cmp_lg_u32 s48, 0
    s_cbranch_scc1 L_cs1_73
    buffer_store_dwordx4 v[144:147], v198, s[28:31], s59 offen sc1
    s_branch L_cs2_74
L_cs1_73:
    buffer_store_dwordx4 v[148:151], v198, s[28:31], s59 offen offset:1024 sc1
L_cs2_74:
    v_mfma_f32_16x16x32_bf16 v[28:31], v[128:131], v[124:127], v[28:31]
    v_mfma_f32_16x16x32_bf16 v[44:47], v[132:135], v[124:127], v[44:47]
    v_mfma_f32_16x16x32_bf16 v[72:75], v[124:127], v[136:139], v[72:75]
    v_mfma_f32_16x16x32_bf16 v[76:79], v[124:127], v[140:143], v[76:79]
    v_mfma_f32_16x16x32_bf16 v[104:107], v[124:127], v[144:147], v[104:107]
    v_mfma_f32_16x16x32_bf16 v[108:111], v[124:127], v[148:151], v[108:111]
    s_branch L_cpb_17
L_cp_18:
    s_waitcnt lgkmcnt(0)
    v_mfma_f32_16x16x32_bf16 v[16:19], v[168:171], v[152:155], v[16:19]
    v_mfma_f32_16x16x32_bf16 v[32:35], v[172:175], v[152:155], v[32:35]
    s_barrier
    ds_read_b128 v[112:115], v192 offset:49152
    v_mfma_f32_16x16x32_bf16 v[48:51], v[152:155], v[176:179], v[48:51]
    ds_read_b64_tr_b16 v[128:129], v195 offset:24576
    v_mfma_f32_16x16x32_bf16 v[52:55], v[152:155], v[180:183], v[52:55]
    s_add_u32 s59, s58, 12288
    s_cmp_lg_u32 s48, 0
    s_cbranch_scc1 L_cs1_75
    buffer_store_dwordx4 v[168:171], v198, s[28:31], s59 offen sc1
    s_branch L_cs2_76
L_cs1_75:
    buffer_store_dwordx4 v[172:175], v198, s[28:31], s59 offen offset:1024 sc1
L_cs2_76:
    ds_read_b64_tr_b16 v[130:131], v195 offset:25088
    v_mfma_f32_16x16x32_bf16 v[80:83], v[152:155], v[184:187], v[80:83]
    ds_read_b64_tr_b16 v[132:133], v197 offset:24576
    v_mfma_f32_16x16x32_bf16 v[84:87], v[152:155], v[188:191], v[84:87]
    ds_read_b64_tr_b16 v[134:135], v197 offset:25088
    v_mfma_f32_16x16x32_bf16 v[20:23], v[168:171], v[156:159], v[20:23]
    ds_read_b64_tr_b16 v[136:137], v195 offset:32768
    v_mfma_f32_16x16x32_bf16 v[36:39], v[172:175], v[156:159], v[36:39]
    ds_read_b64_tr_b16 v[138:139], v195 offset:33280
    v_mfma_f32_16x16x32_bf16 v[56:59], v[156:159], v[176:179], v[56:59]
    ds_read_b64_tr_b16 v[140:141], v197 offset:32768
    v_mfma_f32_16x16x32_bf16 v[60:63], v[156:159], v[180:183], v[60:63]
    ds_read_b64_tr_b16 v[142:143], v197 offset:33280
    v_mfma_f32_16x16x32_bf16 v[88:91], v[156:159], v[184:187], v[88:91]
    s_add_u32 s59, s58, 16384
    s_cmp_lg_u32 s48, 0
    s_cbranch_scc1 L_cs1_77
    buffer_store_dwordx4 v[176:179], v198, s[28:31], s59 offen sc1
    s_branch L_cs2_78
L_cs1_77:
    buffer_store_dwordx4 v[180:183], v198, s[28:31], s59 offen offset:1024 sc1
L_cs2_78:
    ds_read_b64_tr_b16 v[144:145], v195 offset:40960
    v_mfma_f32_16x16x32_bf16 v[92:95], v[156:159], v[188:191], v[92:95]
    ds_read_b64_tr_b16 v[146:147], v195 offset:41472
    v_mfma_f32_16x16x32_bf16 v[24:27], v[168:171], v[160:163], v[24:27]
    ds_read_b64_tr_b16 v[148:149], v197 offset:40960
    v_mfma_f32_16x16x32_bf16 v[40:43], v[172:175], v[160:163], v[40:43]
    ds_read_b64_tr_b16 v[150:151], v197 offset:41472
    v_mfma_f32_16x16x32_bf16 v[64:67], v[160:163], v[176:179], v[64:67]
    ds_read_b128 v[116:119], v192 offset:51200
    v_mfma_f32_16x16x32_bf16 v[68:71], v[160:163], v[180:183], v[68:71]
    ds_read_b128 v[120:123], v192 offset:53248
    v_mfma_f32_16x16x32_bf16 v[96:99], v[160:163], v[184:187], v[96:99]
    s_waitcnt lgkmcnt(14)
    ds_read_b128 v[124:127], v192 offset:55296
    v_mfma_f32_16x16x32_bf16 v[100:103], v[160:163], v[188:191], v[100:103]
    s_add_u32 s59, s58, 20480
    s_cmp_lg_u32 s48, 0
    s_cbranch_scc1 L_cs1_79
    buffer_store_dwordx4 v[184:187], v198, s[28:31], s59 offen sc1
    s_branch L_cs2_80
L_cs1_79:
    buffer_store_dwordx4 v[188:191], v198, s[28:31], s59 offen offset:1024 sc1
L_cs2_80:
    v_mfma_f32_16x16x32_bf16 v[28:31], v[168:171], v[164:167], v[28:31]
    v_mfma_f32_16x16x32_bf16 v[44:47], v[172:175], v[164:167], v[44:47]
    v_mfma_f32_16x16x32_bf16 v[72:75], v[164:167], v[176:179], v[72:75]
    v_mfma_f32_16x16x32_bf16 v[76:79], v[164:167], v[180:183], v[76:79]
    v_mfma_f32_16x16x32_bf16 v[104:107], v[164:167], v[184:187], v[104:107]
    v_mfma_f32_16x16x32_bf16 v[108:111], v[164:167], v[188:191], v[108:111]
    s_branch L_cpb_19
L_cp_20:
    s_waitcnt lgkmcnt(0)
    v_mfma_f32_16x16x32_bf16 v[16:19], v[128:131], v[112:115], v[16:19]
    ds_read_b128 v[152:155], v193 offset:49152
    v_mfma_f32_16x16x32_bf16 v[32:35], v[132:135], v[112:115], v[32:35]
    ds_read_b64_tr_b16 v[168:169], v195 offset:28672
    v_mfma_f32_16x16x32_bf16 v[48:51], v[112:115], v[136:139], v[48:51]
    ds_read_b64_tr_b16 v[170:171], v195 offset:29184
    v_mfma_f32_16x16x32_bf16 v[52:55], v[112:115], v[140:143], v[52:55]
    ds_read_b64_tr_b16 v[172:173], v197 offset:28672
    s_add_u32 s59, s58, 0
    s_cmp_lg_u32 s48, 0
    s_cbranch_scc1 L_cs1_81
    buffer_store_dwordx4 v[128:131], v198, s[28:31], s59 offen sc1
    s_branch L_cs2_82
L_cs1_81:
    buffer_store_dwordx4 v[132:135], v198, s[28:31], s59 offen offset:1024 sc1
L_cs2_82:
    v_mfma_f32_16x16x32_bf16 v[80:83], v[112:115], v[144:147], v[80:83]
    ds_read_b64_tr_b16 v[174:175], v197 offset:29184
    v_mfma_f32_16x16x32_bf16 v[84:87], v[112:115], v[148:151], v[84:87]
    ds_read_b64_tr_b16 v[176:177], v195 offset:36864
    v_mfma_f32_16x16x32_bf16 v[20:23], v[128:131], v[116:119], v[20:23]
    ds_read_b64_tr_b16 v[178:179], v195 offset:37376
    v_mfma_f32_16x16x32_bf16 v[36:39], v[132:135], v[116:119], v[36:39]
    ds_read_b64_tr_b16 v[180:181], v197 offset:36864
    v_mfma_f32_16x16x32_bf16 v[56:59], v[116:119], v[136:139], v[56:59]
    ds_read_b64_tr_b16 v[182:183], v197 offset:37376
    v_mfma_f32_16x16x32_bf16 v[60:63], v[116:119], v[140:143], v[60:63]
    ds_read_b64_tr_b16 v[184:185], v195 offset:45056
    v_mfma_f32_16x16x32_bf16 v[88:91], v[116:119], v[144:147], v[88:91]
    ds_read_b64_tr_b16 v[186:187], v195 offset:45568
    s_add_u32 s59, s58, 4096
    s_cmp_lg_u32 s48, 0
    s_cbranch_scc1 L_cs1_83
    buffer_store_dwordx4 v[136:139], v198, s[28:31], s59 offen sc1
    s_branch L_cs2_84
L_cs1_83:
    buffer_store_dwordx4 v[140:143], v198, s[28:31], s59 offen offset:1024 sc1
L_cs2_84:
    v_mfma_f32_16x16x32_bf16 v[92:95], v[116:119], v[148:151], v[92:95]
    ds_read_b64_tr_b16 v[188:189], v197 offset:45056
    v_mfma_f32_16x16x32_bf16 v[24:27], v[128:131], v[120:123], v[24:27]
    ds_read_b64_tr_b16 v[190:191], v197 offset:45568
    v_mfma_f32_16x16x32_bf16 v[40:43], v[132:135], v[120:123], v[40:43]
    ds_read_b128 v[156:159], v193 offset:51200
    v_mfma_f32_16x16x32_bf16 v[64:67], v[120:123], v[136:139], v[64:67]
    ds_read_b128 v[160:163], v193 offset:53248
    v_mfma_f32_16x16x32_bf16 v[68:71], v[120:123], v[140:143], v[68:71]
    s_waitcnt lgkmcnt(14)
    ds_read_b128 v[164:167], v193 offset:55296
    v_mfma_f32_16x16x32_bf16 v[96:99], v[120:123], v[144:147], v[96:99]
    v_mfma_f32_16x16x32_bf16 v[100:103], v[120:123], v[148:151], v[100:103]
    s_add_u32 s59, s58, 8192
    s_cmp_lg_u32 s48, 0
    s_cbranch_scc1 L_cs1_85
    buffer_store_dwordx4 v[144:147], v198, s[28:31], s59 offen sc1
    s_branch L_cs2_86
L_cs1_85:
    buffer_store_dwordx4 v[148:151], v198, s[28:31], s59 offen offset:1024 sc1
L_cs2_86:
    v_mfma_f32_16x16x32_bf16 v[28:31], v[128:131], v[124:127], v[28:31]
    v_mfma_f32_16x16x32_bf16 v[44:47], v[132:135], v[124:127], v[44:47]
    v_mfma_f32_16x16x32_bf16 v[72:75], v[124:127], v[136:139], v[72:75]
    v_mfma_f32_16x16x32_bf16 v[76:79], v[124:127], v[140:143], v[76:79]
    v_mfma_f32_16x16x32_bf16 v[104:107], v[124:127], v[144:147], v[104:107]
    v_mfma_f32_16x16x32_bf16 v[108:111], v[124:127], v[148:151], v[108:111]
    s_branch L_cpb_21
L_cp_22:
    s_waitcnt lgkmcnt(0)
    v_mfma_f32_16x16x32_bf16 v[16:19], v[168:171], v[152:155], v[16:19]
    v_mfma_f32_16x16x32_bf16 v[32:35], v[172:175], v[152:155], v[32:35]
    s_cmp_eq_u32 s55, 3
    s_cbranch_scc1 L_rare_87
L_back_88:
    s_barrier
    s_cmp_eq_u32 s55, 3
    s_cbranch_scc1 L_rare_89
L_back_90:
    ds_read_b128 v[112:115], v192 offset:0
    v_mfma_f32_16x16x32_bf16 v[48:51], v[152:155], v[176:179], v[48:51]
    ds_read_b64_tr_b16 v[128:129], v194 offset:0
    v_mfma_f32_16x16x32_bf16 v[52:55], v[152:155], v[180:183], v[52:55]
    s_add_u32 s59, s58, 12288
    s_cmp_lg_u32 s48, 0
    s_cbranch_scc1 L_cs1_91
    buffer_store_dwordx4 v[168:171], v198, s[28:31], s59 offen sc1
    s_branch L_cs2_92
L_cs1_91:
    buffer_store_dwordx4 v[172:175], v198, s[28:31], s59 offen offset:1024 sc1
L_cs2_92:
    ds_read_b64_tr_b16 v[130:131], v194 offset:512
    v_mfma_f32_16x16x32_bf16 v[80:83], v[152:155], v[184:187], v[80:83]
    ds_read_b64_tr_b16 v[132:133], v196 offset:0
    v_mfma_f32_16x16x32_bf16 v[84:87], v[152:155], v[188:191], v[84:87]
    ds_read_b64_tr_b16 v[134:135], v196 offset:512
    v_mfma_f32_16x16x32_bf16 v[20:23], v[168:171], v[156:159], v[20:23]
    ds_read_b64_tr_b16 v[136:137], v194 offset:8192
    v_mfma_f32_16x16x32_bf16 v[36:39], v[172:175], v[156:159], v[36:39]
    ds_read_b64_tr_b16 v[138:139], v194 offset:8704
    v_mfma_f32_16x16x32_bf16 v[56:59], v[156:159], v[176:179], v[56:59]
    ds_read_b64_tr_b16 v[140:141], v196 offset:8192
    v_mfma_f32_16x16x32_bf16 v[60:63], v[156:159], v[180:183], v[60:63]
    ds_read_b64_tr_b16 v[142:143], v196 offset:8704
    v_mfma_f32_16x16x32_bf16 v[88:91], v[156:159], v[184:187], v[88:91]
    s_add_u32 s59, s58, 16384
    s_cmp_lg_u32 s48, 0
    s_cbranch_scc1 L_cs1_93
    buffer_store_dwordx4 v[176:179], v198, s[28:31], s59 offen sc1
    s_branch L_cs2_94
L_cs1_93:
    buffer_store_dwordx4 v[180:183], v198, s[28:31], s59 offen offset:1024 sc1
L_cs2_94:
    ds_read_b64_tr_b16 v[144:145], v194 offset:16384
    v_mfma_f32_16x16x32_bf16 v[92:95], v[156:159], v[188:191], v[92:95]
    ds_read_b64_tr_b16 v[146:147], v194 offset:16896
    v_mfma_f32_16x16x32_bf16 v[24:27], v[168:171], v[160:163], v[24:27]
    ds_read_b64_tr_b16 v[148:149], v196 offset:16384
    v_mfma_f32_16x16x32_bf16 v[40:43], v[172:175], v[160:163], v[40:43]
    ds_read_b64_tr_b16 v[150:151], v196 offset:16896
    v_mfma_f32_16x16x32_bf16 v[64:67], v[160:163], v[176:179], v[64:67]
    ds_read_b128 v[116:119], v192 offset:2048
    v_mfma_f32_16x16x32_bf16 v[68:71], v[160:163], v[180:183], v[68:71]
    ds_read_b128 v[120:123], v192 offset:4096
    v_mfma_f32_16x16x32_bf16 v[96:99], v[160:163], v[184:187], v[96:99]
    s_waitcnt lgkmcnt(14)
    ds_read_b128 v[124:127], v192 offset:6144
    v_mfma_f32_16x16x32_bf16 v[100:103], v[160:163], v[188:191], v[100:103]
    s_add_u32 s59, s58, 20480
    s_cmp_lg_u32 s48, 0
    s_cbranch_scc1 L_cs1_95
    buffer_store_dwordx4 v[184:187], v198, s[28:31], s59 offen sc1
    s_branch L_cs2_96
L_cs1_95:
    buffer_store_dwordx4 v[188:191], v198, s[28:31], s59 offen offset:1024 sc1
L_cs2_96:
    v_mfma_f32_16x16x32_bf16 v[28:31], v[168:171], v[164:167], v[28:31]
    v_mfma_f32_16x16x32_bf16 v[44:47], v[172:175], v[164:167], v[44:47]
    v_mfma_f32_16x16x32_bf16 v[72:75], v[164:167], v[176:179], v[72:75]
    v_mfma_f32_16x16x32_bf16 v[76:79], v[164:167], v[180:183], v[76:79]
    v_mfma_f32_16x16x32_bf16 v[104:107], v[164:167], v[184:187], v[104:107]
    v_mfma_f32_16x16x32_bf16 v[108:111], v[164:167], v[188:191], v[108:111]
    s_branch L_cpb_23
L_rare_24:
    s_waitcnt vmcnt(0)
    s_branch L_back_25
L_rare_26:
    s_cmp_lg_u32 s3, 0
    s_cbranch_scc1 L_rih_97
    s_and_b32 s44, s2, 7
    s_lshl_b32 s44, s44, 5
    v_mov_b32 v2, 0
    v_mov_b32 v3, 1
    s_mov_b64 s[46:47], exec
    s_mov_b32 exec_lo, 0x1
    s_mov_b32 exec_hi, 0x0
    buffer_atomic_add v3, v2, s[36:39], s44 offen sc1
    s_mov_b64 exec, s[46:47]
L_rih_97:
    s_branch L_back_27
L_cp_28:
    s_waitcnt lgkmcnt(0)
    v_mfma_f32_16x16x32_bf16 v[16:19], v[128:131], v[112:115], v[16:19]
    ds_read_b128 v[152:155], v193 offset:0
    v_mfma_f32_16x16x32_bf16 v[32:35], v[132:135], v[112:115], v[32:35]
    ds_read_b64_tr_b16 v[168:169], v194 offset:4096
    v_mfma_f32_16x16x32_bf16 v[48:51], v[112:115], v[136:139], v[48:51]
    ds_read_b64_tr_b16 v[170:171], v194 offset:4608
    v_mfma_f32_16x16x32_bf16 v[52:55], v[112:115], v[140:143], v[52:55]
    ds_read_b64_tr_b16 v[172:173], v196 offset:4096
    s_add_u32 s59, s58, 0
    s_cmp_lg_u32 s48, 0
    s_cbranch_scc1 L_cs1_98
    buffer_store_dwordx4 v[128:131], v198, s[28:31], s59 offen sc1
    s_branch L_cs2_99
L_cs1_98:
    buffer_store_dwordx4 v[132:135], v198, s[28:31], s59 offen offset:1024 sc1
L_cs2_99:
    v_mfma_f32_16x16x32_bf16 v[80:83], v[112:115], v[144:147], v[80:83]
    ds_read_b64_tr_b16 v[174:175], v196 offset:4608
    v_mfma_f32_16x16x32_bf16 v[84:87], v[112:115], v[148:151], v[84:87]
    ds_read_b64_tr_b16 v[176:177], v194 offset:12288
    v_mfma_f32_16x16x32_bf16 v[20:23], v[128:131], v[116:119], v[20:23]
    ds_read_b64_tr_b16 v[178:179], v194 offset:12800
    v_mfma_f32_16x16x32_bf16 v[36:39], v[132:135], v[116:119], v[36:39]
    ds_read_b64_tr_b16 v[180:181], v196 offset:12288
    v_mfma_f32_16x16x32_bf16 v[56:59], v[116:119], v[136:139], v[56:59]
    ds_read_b64_tr_b16 v[182:183], v196 offset:12800
    v_mfma_f32_16x16x32_bf16 v[60:63], v[116:119], v[140:143], v[60:63]
    ds_read_b64_tr_b16 v[184:185], v194 offset:20480
    v_mfma_f32_16x16x32_bf16 v[88:91], v[116:119], v[144:147], v[88:91]
    ds_read_b64_tr_b16 v[186:187], v194 offset:20992
    s_add_u32 s59, s58, 4096
    s_cmp_lg_u32 s48, 0
    s_cbranch_scc1 L_cs1_100
    buffer_store_dwordx4 v[136:139], v198, s[28:31], s59 offen sc1
    s_branch L_cs2_101
L_cs1_100:
    buffer_store_dwordx4 v[140:143], v198, s[28:31], s59 offen offset:1024 sc1
L_cs2_101:
    v_mfma_f32_16x16x32_bf16 v[92:95], v[116:119], v[148:151], v[92:95]
    ds_read_b64_tr_b16 v[188:189], v196 offset:20480
    v_mfma_f32_16x16x32_bf16 v[24:27], v[128:131], v[120:123], v[24:27]
    ds_read_b64_tr_b16 v[190:191], v196 offset:20992
    v_mfma_f32_16x16x32_bf16 v[40:43], v[132:135], v[120:123], v[40:43]
    ds_read_b128 v[156:159], v193 offset:2048
    v_mfma_f32_16x16x32_bf16 v[64:67], v[120:123], v[136:139], v[64:67]
    ds_read_b128 v[160:163], v193 offset:4096
    v_mfma_f32_16x16x32_bf16 v[68:71], v[120:123], v[140:143], v[68:71]
    s_waitcnt lgkmcnt(14)
    ds_read_b128 v[164:167], v193 offset:6144
    v_mfma_f32_16x16x32_bf16 v[96:99], v[120:123], v[144:147], v[96:99]
    v_mfma_f32_16x16x32_bf16 v[100:103], v[120:123], v[148:151], v[100:103]
    s_add_u32 s59, s58, 8192
    s_cmp_lg_u32 s48, 0
    s_cbranch_scc1 L_cs1_102
    buffer_store_dwordx4 v[144:147], v198, s[28:31], s59 offen sc1
    s_branch L_cs2_103
L_cs1_102:
    buffer_store_dwordx4 v[148:151], v198, s[28:31], s59 offen offset:1024 sc1
L_cs2_103:
    v_mfma_f32_16x16x32_bf16 v[28:31], v[128:131], v[124:127], v[28:31]
    v_mfma_f32_16x16x32_bf16 v[44:47], v[132:135], v[124:127], v[44:47]
    v_mfma_f32_16x16x32_bf16 v[72:75], v[124:127], v[136:139], v[72:75]
    v_mfma_f32_16x16x32_bf16 v[76:79], v[124:127], v[140:143], v[76:79]
    v_mfma_f32_16x16x32_bf16 v[104:107], v[124:127], v[144:147], v[104:107]
    v_mfma_f32_16x16x32_bf16 v[108:111], v[124:127], v[148:151], v[108:111]
    s_branch L_cpb_29
L_cp_30:
    s_waitcnt lgkmcnt(0)
    v_mfma_f32_16x16x32_bf16 v[16:19], v[168:171], v[152:155], v[16:19]
    v_mfma_f32_16x16x32_bf16 v[32:35], v[172:175], v[152:155], v[32:35]
    s_barrier
    ds_read_b128 v[112:115], v192 offset:16384
    v_mfma_f32_16x16x32_bf16 v[48:51], v[152:155], v[176:179], v[48:51]
    ds_read_b64_tr_b16 v[128:129], v194 offset:24576
    v_mfma_f32_16x16x32_bf16 v[52:55], v[152:155], v[180:183], v[52:55]
    s_add_u32 s59, s58, 12288
    s_cmp_lg_u32 s48, 0
    s_cbranch_scc1 L_cs1_104
    buffer_store_dwordx4 v[168:171], v198, s[28:31], s59 offen sc1
    s_branch L_cs2_105
L_cs1_104:
    buffer_store_dwordx4 v[172:175], v198, s[28:31], s59 offen offset:1024 sc1
L_cs2_105:
    ds_read_b64_tr_b16 v[130:131], v194 offset:25088
    v_mfma_f32_16x16x32_bf16 v[80:83], v[152:155], v[184:187], v[80:83]
    ds_read_b64_tr_b16 v[132:133], v196 offset:24576
    v_mfma_f32_16x16x32_bf16 v[84:87], v[152:155], v[188:191], v[84:87]
    ds_read_b64_tr_b16 v[134:135], v196 offset:25088
    v_mfma_f32_16x16x32_bf16 v[20:23], v[168:171], v[156:159], v[20:23]
    ds_read_b64_tr_b16 v[136:137], v194 offset:32768
    v_mfma_f32_16x16x32_bf16 v[36:39], v[172:175], v[156:159], v[36:39]
    ds_read_b64_tr_b16 v[138:139], v194 offset:33280
    v_mfma_f32_16x16x32_bf16 v[56:59], v[156:159], v[176:179], v[56:59]
    ds_read_b64_tr_b16 v[140:141], v196 offset:32768
    v_mfma_f32_16x16x32_bf16 v[60:63], v[156:159], v[180:183], v[60:63]
    ds_read_b64_tr_b16 v[142:143], v196 offset:33280
    v_mfma_f32_16x16x32_bf16 v[88:91], v[156:159], v[184:187], v[88:91]
    s_add_u32 s59, s58, 16384
    s_cmp_lg_u32 s48, 0
    s_cbranch_scc1 L_cs1_106
    buffer_store_dwordx4 v[176:179], v198, s[28:31], s59 offen sc1
    s_branch L_cs2_107
L_cs1_106:
    buffer_store_dwordx4 v[180:183], v198, s[28:31], s59 offen offset:1024 sc1
L_cs2_107:
    ds_read_b64_tr_b16 v[144:145], v194 offset:40960
    v_mfma_f32_16x16x32_bf16 v[92:95], v[156:159], v[188:191], v[92:95]
    ds_read_b64_tr_b16 v[146:147], v194 offset:41472
    v_mfma_f32_16x16x32_bf16 v[24:27], v[168:171], v[160:163], v[24:27]
    ds_read_b64_tr_b16 v[148:149], v196 offset:40960
    v_mfma_f32_16x16x32_bf16 v[40:43], v[172:175], v[160:163], v[40:43]
    ds_read_b64_tr_b16 v[150:151], v196 offset:41472
    v_mfma_f32_16x16x32_bf16 v[64:67], v[160:163], v[176:179], v[64:67]
    ds_read_b128 v[116:119], v192 offset:18432
    v_mfma_f32_16x16x32_bf16 v[68:71], v[160:163], v[180:183], v[68:71]
    ds_read_b128 v[120:123], v192 offset:20480
    v_mfma_f32_16x16x32_bf16 v[96:99], v[160:163], v[184:187], v[96:99]
    s_waitcnt lgkmcnt(14)
    ds_read_b128 v[124:127], v192 offset:22528
    v_mfma_f32_16x16x32_bf16 v[100:103], v[160:163], v[188:191], v[100:103]
    s_add_u32 s59, s58, 20480
    s_cmp_lg_u32 s48, 0
    s_cbranch_scc1 L_cs1_108
    buffer_store_dwordx4 v[184:187], v198, s[28:31], s59 offen sc1
    s_branch L_cs2_109
L_cs1_108:
    buffer_store_dwordx4 v[188:191], v198, s[28:31], s59 offen offset:1024 sc1
L_cs2_109:
    v_mfma_f32_16x16x32_bf16 v[28:31], v[168:171], v[164:167], v[28:31]
    v_mfma_f32_16x16x32_bf16 v[44:47], v[172:175], v[164:167], v[44:47]
    v_mfma_f32_16x16x32_bf16 v[72:75], v[164:167], v[176:179], v[72:75]
    v_mfma_f32_16x16x32_bf16 v[76:79], v[164:167], v[180:183], v[76:79]
    v_mfma_f32_16x16x32_bf16 v[104:107], v[164:167], v[184:187], v[104:107]
    v_mfma_f32_16x16x32_bf16 v[108:111], v[164:167], v[188:191], v[108:111]
    s_branch L_cpb_31
L_cp_32:
    s_waitcnt lgkmcnt(0)
    v_mfma_f32_16x16x32_bf16 v[16:19], v[128:131], v[112:115], v[16:19]
    ds_read_b128 v[152:155], v193 offset:16384
    v_mfma_f32_16x16x32_bf16 v[32:35], v[132:135], v[112:115], v[32:35]
    ds_read_b64_tr_b16 v[168:169], v194 offset:28672
    v_mfma_f32_16x16x32_bf16 v[48:51], v[112:115], v[136:139], v[48:51]
    ds_read_b64_tr_b16 v[170:171], v194 offset:29184
    v_mfma_f32_16x16x32_bf16 v[52:55], v[112:115], v[140:143], v[52:55]
    ds_read_b64_tr_b16 v[172:173], v196 offset:28672
    s_add_u32 s59, s58, 0
    s_cmp_lg_u32 s48, 0
    s_cbranch_scc1 L_cs1_110
    buffer_store_dwordx4 v[128:131], v198, s[28:31], s59 offen sc1
    s_branch L_cs2_111
L_cs1_110:
    buffer_store_dwordx4 v[132:135], v198, s[28:31], s59 offen offset:1024 sc1
L_cs2_111:
    v_mfma_f32_16x16x32_bf16 v[80:83], v[112:115], v[144:147], v[80:83]
    ds_read_b64_tr_b16 v[174:175], v196 offset:29184
    v_mfma_f32_16x16x32_bf16 v[84:87], v[112:115], v[148:151], v[84:87]
    ds_read_b64_tr_b16 v[176:177], v194 offset:36864
    v_mfma_f32_16x16x32_bf16 v[20:23], v[128:131], v[116:119], v[20:23]
    ds_read_b64_tr_b16 v[178:179], v194 offset:37376
    v_mfma_f32_16x16x32_bf16 v[36:39], v[132:135], v[116:119], v[36:39]
    ds_read_b64_tr_b16 v[180:181], v196 offset:36864
    v_mfma_f32_16x16x32_bf16 v[56:59], v[116:119], v[136:139], v[56:59]
    ds_read_b64_tr_b16 v[182:183], v196 offset:37376
    v_mfma_f32_16x16x32_bf16 v[60:63], v[116:119], v[140:143], v[60:63]
    ds_read_b64_tr_b16 v[184:185], v194 offset:45056
    v_mfma_f32_16x16x32_bf16 v[88:91], v[116:119], v[144:147], v[88:91]
    ds_read_b64_tr_b16 v[186:187], v194 offset:45568
    s_add_u32 s59, s58, 4096
    s_cmp_lg_u32 s48, 0
    s_cbranch_scc1 L_cs1_112
    buffer_store_dwordx4 v[136:139], v198, s[28:31], s59 offen sc1
    s_branch L_cs2_113
L_cs1_112:
    buffer_store_dwordx4 v[140:143], v198, s[28:31], s59 offen offset:1024 sc1
L_cs2_113:
    v_mfma_f32_16x16x32_bf16 v[92:95], v[116:119], v[148:151], v[92:95]
    ds_read_b64_tr_b16 v[188:189], v196 offset:45056
    v_mfma_f32_16x16x32_bf16 v[24:27], v[128:131], v[120:123], v[24:27]
    ds_read_b64_tr_b16 v[190:191], v196 offset:45568
    v_mfma_f32_16x16x32_bf16 v[40:43], v[132:135], v[120:123], v[40:43]
    ds_read_b128 v[156:159], v193 offset:18432
    v_mfma_f32_16x16x32_bf16 v[64:67], v[120:123], v[136:139], v[64:67]
    ds_read_b128 v[160:163], v193 offset:20480
    v_mfma_f32_16x16x32_bf16 v[68:71], v[120:123], v[140:143], v[68:71]
    s_waitcnt lgkmcnt(14)
    ds_read_b128 v[164:167], v193 offset:22528
    v_mfma_f32_16x16x32_bf16 v[96:99], v[120:123], v[144:147], v[96:99]
    v_mfma_f32_16x16x32_bf16 v[100:103], v[120:123], v[148:151], v[100:103]
    s_add_u32 s59, s58, 8192
    s_cmp_lg_u32 s48, 0
    s_cbranch_scc1 L_cs1_114
    buffer_store_dwordx4 v[144:147], v198, s[28:31], s59 offen sc1
    s_branch L_cs2_115
L_cs1_114:
    buffer_store_dwordx4 v[148:151], v198, s[28:31], s59 offen offset:1024 sc1
L_cs2_115:
    v_mfma_f32_16x16x32_bf16 v[28:31], v[128:131], v[124:127], v[28:31]
    v_mfma_f32_16x16x32_bf16 v[44:47], v[132:135], v[124:127], v[44:47]
    v_mfma_f32_16x16x32_bf16 v[72:75], v[124:127], v[136:139], v[72:75]
    v_mfma_f32_16x16x32_bf16 v[76:79], v[124:127], v[140:143], v[76:79]
    v_mfma_f32_16x16x32_bf16 v[104:107], v[124:127], v[144:147], v[104:107]
    v_mfma_f32_16x16x32_bf16 v[108:111], v[124:127], v[148:151], v[108:111]
    s_branch L_cpb_33
L_cp_34:
    s_waitcnt lgkmcnt(0)
    v_mfma_f32_16x16x32_bf16 v[16:19], v[168:171], v[152:155], v[16:19]
    v_mfma_f32_16x16x32_bf16 v[32:35], v[172:175], v[152:155], v[32:35]
    s_barrier
    ds_read_b128 v[112:115], v192 offset:32768
    v_mfma_f32_16x16x32_bf16 v[48:51], v[152:155], v[176:179], v[48:51]
    ds_read_b64_tr_b16 v[128:129], v195 offset:0
    v_mfma_f32_16x16x32_bf16 v[52:55], v[152:155], v[180:183], v[52:55]
    s_add_u32 s59, s58, 12288
    s_cmp_lg_u32 s48, 0
    s_cbranch_scc1 L_cs1_116
    buffer_store_dwordx4 v[168:171], v198, s[28:31], s59 offen sc1
    s_branch L_cs2_117
L_cs1_116:
    buffer_store_dwordx4 v[172:175], v198, s[28:31], s59 offen offset:1024 sc1
L_cs2_117:
    ds_read_b64_tr_b16 v[130:131], v195 offset:512
    v_mfma_f32_16x16x32_bf16 v[80:83], v[152:155], v[184:187], v[80:83]
    ds_read_b64_tr_b16 v[132:133], v197 offset:0
    v_mfma_f32_16x16x32_bf16 v[84:87], v[152:155], v[188:191], v[84:87]
    ds_read_b64_tr_b16 v[134:135], v197 offset:512
    v_mfma_f32_16x16x32_bf16 v[20:23], v[168:171], v[156:159], v[20:23]
    ds_read_b64_tr_b16 v[136:137], v195 offset:8192
    v_mfma_f32_16x16x32_bf16 v[36:39], v[172:175], v[156:159], v[36:39]
    ds_read_b64_tr_b16 v[138:139], v195 offset:8704
    v_mfma_f32_16x16x32_bf16 v[56:59], v[156:159], v[176:179], v[56:59]
    ds_read_b64_tr_b16 v[140:141], v197 offset:8192
    v_mfma_f32_16x16x32_bf16 v[60:63], v[156:159], v[180:183], v[60:63]
    ds_read_b64_tr_b16 v[142:143], v197 offset:8704
    v_mfma_f32_16x16x32_bf16 v[88:91], v[156:159], v[184:187], v[88:91]
    s_add_u32 s59, s58, 16384
    s_cmp_lg_u32 s48, 0
    s_cbranch_scc1 L_cs1_118
    buffer_store_dwordx4 v[176:179], v198, s[28:31], s59 offen sc1
    s_branch L_cs2_119
L_cs1_118:
    buffer_store_dwordx4 v[180:183], v198, s[28:31], s59 offen offset:1024 sc1
L_cs2_119:
    ds_read_b64_tr_b16 v[144:145], v195 offset:16384
    v_mfma_f32_16x16x32_bf16 v[92:95], v[156:159], v[188:191], v[92:95]
    ds_read_b64_tr_b16 v[146:147], v195 offset:16896
    v_mfma_f32_16x16x32_bf16 v[24:27], v[168:171], v[160:163], v[24:27]
    ds_read_b64_tr_b16 v[148:149], v197 offset:16384
    v_mfma_f32_16x16x32_bf16 v[40:43], v[172:175], v[160:163], v[40:43]
    ds_read_b64_tr_b16 v[150:151], v197 offset:16896
    v_mfma_f32_16x16x32_bf16 v[64:67], v[160:163], v[176:179], v[64:67]
    ds_read_b128 v[116:119], v192 offset:34816
    v_mfma_f32_16x16x32_bf16 v[68:71], v[160:163], v[180:183], v[68:71]
    ds_read_b128 v[120:123], v192 offset:36864
    v_mfma_f32_16x16x32_bf16 v[96:99], v[160:163], v[184:187], v[96:99]
    s_waitcnt lgkmcnt(14)
    ds_read_b128 v[124:127], v192 offset:38912
    v_mfma_f32_16x16x32_bf16 v[100:103], v[160:163], v[188:191], v[100:103]
    s_add_u32 s59, s58, 20480
    s_cmp_lg_u32 s48, 0
    s_cbranch_scc1 L_cs1_120
    buffer_store_dwordx4 v[184:187], v198, s[28:31], s59 offen sc1
    s_branch L_cs2_121
L_cs1_120:
    buffer_store_dwordx4 v[188:191], v198, s[28:31], s59 offen offset:1024 sc1
L_cs2_121:
    v_mfma_f32_16x16x32_bf16 v[28:31], v[168:171], v[164:167], v[28:31]
    v_mfma_f32_16x16x32_bf16 v[44:47], v[172:175], v[164:167], v[44:47]
    v_mfma_f32_16x16x32_bf16 v[72:75], v[164:167], v[176:179], v[72:75]
    v_mfma_f32_16x16x32_bf16 v[76:79], v[164:167], v[180:183], v[76:79]
    v_mfma_f32_16x16x32_bf16 v[104:107], v[164:167], v[184:187], v[104:107]
    v_mfma_f32_16x16x32_bf16 v[108:111], v[164:167], v[188:191], v[108:111]
    s_branch L_cpb_35
L_cp_36:
    s_waitcnt lgkmcnt(0)
    v_mfma_f32_16x16x32_bf16 v[16:19], v[128:131], v[112:115], v[16:19]
    ds_read_b128 v[152:155], v193 offset:32768
    v_mfma_f32_16x16x32_bf16 v[32:35], v[132:135], v[112:115], v[32:35]
    ds_read_b64_tr_b16 v[168:169], v195 offset:4096
    v_mfma_f32_16x16x32_bf16 v[48:51], v[112:115], v[136:139], v[48:51]
    ds_read_b64_tr_b16 v[170:171], v195 offset:4608
    v_mfma_f32_16x16x32_bf16 v[52:55], v[112:115], v[140:143], v[52:55]
    ds_read_b64_tr_b16 v[172:173], v197 offset:4096
    s_add_u32 s59, s58, 0
    s_cmp_lg_u32 s48, 0
    s_cbranch_scc1 L_cs1_122
    buffer_store_dwordx4 v[128:131], v198, s[28:31], s59 offen sc1
    s_branch L_cs2_123
L_cs1_122:
    buffer_store_dwordx4 v[132:135], v198, s[28:31], s59 offen offset:1024 sc1
L_cs2_123:
    v_mfma_f32_16x16x32_bf16 v[80:83], v[112:115], v[144:147], v[80:83]
    ds_read_b64_tr_b16 v[174:175], v197 offset:4608
    v_mfma_f32_16x16x32_bf16 v[84:87], v[112:115], v[148:151], v[84:87]
    ds_read_b64_tr_b16 v[176:177], v195 offset:12288
    v_mfma_f32_16x16x32_bf16 v[20:23], v[128:131], v[116:119], v[20:23]
    ds_read_b64_tr_b16 v[178:179], v195 offset:12800
    v_mfma_f32_16x16x32_bf16 v[36:39], v[132:135], v[116:119], v[36:39]
    ds_read_b64_tr_b16 v[180:181], v197 offset:12288
    v_mfma_f32_16x16x32_bf16 v[56:59], v[116:119], v[136:139], v[56:59]
    ds_read_b64_tr_b16 v[182:183], v197 offset:12800
    v_mfma_f32_16x16x32_bf16 v[60:63], v[116:119], v[140:143], v[60:63]
    ds_read_b64_tr_b16 v[184:185], v195 offset:20480
    v_mfma_f32_16x16x32_bf16 v[88:91], v[116:119], v[144:147], v[88:91]
    ds_read_b64_tr_b16 v[186:187], v195 offset:20992
    s_add_u32 s59, s58, 4096
    s_cmp_lg_u32 s48, 0
    s_cbranch_scc1 L_cs1_124
    buffer_store_dwordx4 v[136:139], v198, s[28:31], s59 offen sc1
    s_branch L_cs2_125
L_cs1_124:
    buffer_store_dwordx4 v[140:143], v198, s[28:31], s59 offen offset:1024 sc1
L_cs2_125:
    v_mfma_f32_16x16x32_bf16 v[92:95], v[116:119], v[148:151], v[92:95]
    ds_read_b64_tr_b16 v[188:189], v197 offset:20480
    v_mfma_f32_16x16x32_bf16 v[24:27], v[128:131], v[120:123], v[24:27]
    ds_read_b64_tr_b16 v[190:191], v197 offset:20992
    v_mfma_f32_16x16x32_bf16 v[40:43], v[132:135], v[120:123], v[40:43]
    ds_read_b128 v[156:159], v193 offset:34816
    v_mfma_f32_16x16x32_bf16 v[64:67], v[120:123], v[136:139], v[64:67]
    ds_read_b128 v[160:163], v193 offset:36864
    v_mfma_f32_16x16x32_bf16 v[68:71], v[120:123], v[140:143], v[68:71]
    s_waitcnt lgkmcnt(14)
    ds_read_b128 v[164:167], v193 offset:38912
    v_mfma_f32_16x16x32_bf16 v[96:99], v[120:123], v[144:147], v[96:99]
    v_mfma_f32_16x16x32_bf16 v[100:103], v[120:123], v[148:151], v[100:103]
    s_add_u32 s59, s58, 8192
    s_cmp_lg_u32 s48, 0
    s_cbranch_scc1 L_cs1_126
    buffer_store_dwordx4 v[144:147], v198, s[28:31], s59 offen sc1
    s_branch L_cs2_127
L_cs1_126:
    buffer_store_dwordx4 v[148:151], v198, s[28:31], s59 offen offset:1024 sc1
L_cs2_127:
    v_mfma_f32_16x16x32_bf16 v[28:31], v[128:131], v[124:127], v[28:31]
    v_mfma_f32_16x16x32_bf16 v[44:47], v[132:135], v[124:127], v[44:47]
    v_mfma_f32_16x16x32_bf16 v[72:75], v[124:127], v[136:139], v[72:75]
    v_mfma_f32_16x16x32_bf16 v[76:79], v[124:127], v[140:143], v[76:79]
    v_mfma_f32_16x16x32_bf16 v[104:107], v[124:127], v[144:147], v[104:107]
    v_mfma_f32_16x16x32_bf16 v[108:111], v[124:127], v[148:151], v[108:111]
    s_branch L_cpb_37
L_cp_38:
    s_waitcnt lgkmcnt(0)
    v_mfma_f32_16x16x32_bf16 v[16:19], v[168:171], v[152:155], v[16:19]
    v_mfma_f32_16x16x32_bf16 v[32:35], v[172:175], v[152:155], v[32:35]
    s_barrier
    ds_read_b128 v[112:115], v192 offset:49152
    v_mfma_f32_16x16x32_bf16 v[48:51], v[152:155], v[176:179], v[48:51]
    ds_read_b64_tr_b16 v[128:129], v195 offset:24576
    v_mfma_f32_16x16x32_bf16 v[52:55], v[152:155], v[180:183], v[52:55]
    s_add_u32 s59, s58, 12288
    s_cmp_lg_u32 s48, 0
    s_cbranch_scc1 L_cs1_128
    buffer_store_dwordx4 v[168:171], v198, s[28:31], s59 offen sc1
    s_branch L_cs2_129
L_cs1_128:
    buffer_store_dwordx4 v[172:175], v198, s[28:31], s59 offen offset:1024 sc1
L_cs2_129:
    ds_read_b64_tr_b16 v[130:131], v195 offset:25088
    v_mfma_f32_16x16x32_bf16 v[80:83], v[152:155], v[184:187], v[80:83]
    ds_read_b64_tr_b16 v[132:133], v197 offset:24576
    v_mfma_f32_16x16x32_bf16 v[84:87], v[152:155], v[188:191], v[84:87]
    ds_read_b64_tr_b16 v[134:135], v197 offset:25088
    v_mfma_f32_16x16x32_bf16 v[20:23], v[168:171], v[156:159], v[20:23]
    ds_read_b64_tr_b16 v[136:137], v195 offset:32768
    v_mfma_f32_16x16x32_bf16 v[36:39], v[172:175], v[156:159], v[36:39]
    ds_read_b64_tr_b16 v[138:139], v195 offset:33280
    v_mfma_f32_16x16x32_bf16 v[56:59], v[156:159], v[176:179], v[56:59]
    ds_read_b64_tr_b16 v[140:141], v197 offset:32768
    v_mfma_f32_16x16x32_bf16 v[60:63], v[156:159], v[180:183], v[60:63]
    ds_read_b64_tr_b16 v[142:143], v197 offset:33280
    v_mfma_f32_16x16x32_bf16 v[88:91], v[156:159], v[184:187], v[88:91]
    s_add_u32 s59, s58, 16384
    s_cmp_lg_u32 s48, 0
    s_cbranch_scc1 L_cs1_130
    buffer_store_dwordx4 v[176:179], v198, s[28:31], s59 offen sc1
    s_branch L_cs2_131
L_cs1_130:
    buffer_store_dwordx4 v[180:183], v198, s[28:31], s59 offen offset:1024 sc1
L_cs2_131:
    ds_read_b64_tr_b16 v[144:145], v195 offset:40960
    v_mfma_f32_16x16x32_bf16 v[92:95], v[156:159], v[188:191], v[92:95]
    ds_read_b64_tr_b16 v[146:147], v195 offset:41472
    v_mfma_f32_16x16x32_bf16 v[24:27], v[168:171], v[160:163], v[24:27]
    ds_read_b64_tr_b16 v[148:149], v197 offset:40960
    v_mfma_f32_16x16x32_bf16 v[40:43], v[172:175], v[160:163], v[40:43]
    ds_read_b64_tr_b16 v[150:151], v197 offset:41472
    v_mfma_f32_16x16x32_bf16 v[64:67], v[160:163], v[176:179], v[64:67]
    ds_read_b128 v[116:119], v192 offset:51200
    v_mfma_f32_16x16x32_bf16 v[68:71], v[160:163], v[180:183], v[68:71]
    ds_read_b128 v[120:123], v192 offset:53248
    v_mfma_f32_16x16x32_bf16 v[96:99], v[160:163], v[184:187], v[96:99]
    s_waitcnt lgkmcnt(14)
    ds_read_b128 v[124:127], v192 offset:55296
    v_mfma_f32_16x16x32_bf16 v[100:103], v[160:163], v[188:191], v[100:103]
    s_add_u32 s59, s58, 20480
    s_cmp_lg_u32 s48, 0
    s_cbranch_scc1 L_cs1_132
    buffer_store_dwordx4 v[184:187], v198, s[28:31], s59 offen sc1
    s_branch L_cs2_133
L_cs1_132:
    buffer_store_dwordx4 v[188:191], v198, s[28:31], s59 offen offset:1024 sc1
L_cs2_133:
    v_mfma_f32_16x16x32_bf16 v[28:31], v[168:171], v[164:167], v[28:31]
    v_mfma_f32_16x16x32_bf16 v[44:47], v[172:175], v[164:167], v[44:47]
    v_mfma_f32_16x16x32_bf16 v[72:75], v[164:167], v[176:179], v[72:75]
    v_mfma_f32_16x16x32_bf16 v[76:79], v[164:167], v[180:183], v[76:79]
    v_mfma_f32_16x16x32_bf16 v[104:107], v[164:167], v[184:187], v[104:107]
    v_mfma_f32_16x16x32_bf16 v[108:111], v[164:167], v[188:191], v[108:111]
    s_branch L_cpb_39
L_cp_40:
    s_waitcnt lgkmcnt(0)
    v_mfma_f32_16x16x32_bf16 v[16:19], v[128:131], v[112:115], v[16:19]
    ds_read_b128 v[152:155], v193 offset:49152
    v_mfma_f32_16x16x32_bf16 v[32:35], v[132:135], v[112:115], v[32:35]
    ds_read_b64_tr_b16 v[168:169], v195 offset:28672
    v_mfma_f32_16x16x32_bf16 v[48:51], v[112:115], v[136:139], v[48:51]
    ds_read_b64_tr_b16 v[170:171], v195 offset:29184
    v_mfma_f32_16x16x32_bf16 v[52:55], v[112:115], v[140:143], v[52:55]
    ds_read_b64_tr_b16 v[172:173], v197 offset:28672
    s_add_u32 s59, s58, 0
    s_cmp_lg_u32 s48, 0
    s_cbranch_scc1 L_cs1_134
    buffer_store_dwordx4 v[128:131], v198, s[28:31], s59 offen sc1
    s_branch L_cs2_135
L_cs1_134:
    buffer_store_dwordx4 v[132:135], v198, s[28:31], s59 offen offset:1024 sc1
L_cs2_135:
    v_mfma_f32_16x16x32_bf16 v[80:83], v[112:115], v[144:147], v[80:83]
    ds_read_b64_tr_b16 v[174:175], v197 offset:29184
    v_mfma_f32_16x16x32_bf16 v[84:87], v[112:115], v[148:151], v[84:87]
    ds_read_b64_tr_b16 v[176:177], v195 offset:36864
    v_mfma_f32_16x16x32_bf16 v[20:23], v[128:131], v[116:119], v[20:23]
    ds_read_b64_tr_b16 v[178:179], v195 offset:37376
    v_mfma_f32_16x16x32_bf16 v[36:39], v[132:135], v[116:119], v[36:39]
    ds_read_b64_tr_b16 v[180:181], v197 offset:36864
    v_mfma_f32_16x16x32_bf16 v[56:59], v[116:119], v[136:139], v[56:59]
    ds_read_b64_tr_b16 v[182:183], v197 offset:37376
    v_mfma_f32_16x16x32_bf16 v[60:63], v[116:119], v[140:143], v[60:63]
    ds_read_b64_tr_b16 v[184:185], v195 offset:45056
    v_mfma_f32_16x16x32_bf16 v[88:91], v[116:119], v[144:147], v[88:91]
    ds_read_b64_tr_b16 v[186:187], v195 offset:45568
    s_add_u32 s59, s58, 4096
    s_cmp_lg_u32 s48, 0
    s_cbranch_scc1 L_cs1_136
    buffer_store_dwordx4 v[136:139], v198, s[28:31], s59 offen sc1
    s_branch L_cs2_137
L_cs1_136:
    buffer_store_dwordx4 v[140:143], v198, s[28:31], s59 offen offset:1024 sc1
L_cs2_137:
    v_mfma_f32_16x16x32_bf16 v[92:95], v[116:119], v[148:151], v[92:95]
    ds_read_b64_tr_b16 v[188:189], v197 offset:45056
    v_mfma_f32_16x16x32_bf16 v[24:27], v[128:131], v[120:123], v[24:27]
    ds_read_b64_tr_b16 v[190:191], v197 offset:45568
    v_mfma_f32_16x16x32_bf16 v[40:43], v[132:135], v[120:123], v[40:43]
    ds_read_b128 v[156:159], v193 offset:51200
    v_mfma_f32_16x16x32_bf16 v[64:67], v[120:123], v[136:139], v[64:67]
    ds_read_b128 v[160:163], v193 offset:53248
    v_mfma_f32_16x16x32_bf16 v[68:71], v[120:123], v[140:143], v[68:71]
    s_waitcnt lgkmcnt(14)
    ds_read_b128 v[164:167], v193 offset:55296
    v_mfma_f32_16x16x32_bf16 v[96:99], v[120:123], v[144:147], v[96:99]
    v_mfma_f32_16x16x32_bf16 v[100:103], v[120:123], v[148:151], v[100:103]
    s_add_u32 s59, s58, 8192
    s_cmp_lg_u32 s48, 0
    s_cbranch_scc1 L_cs1_138
    buffer_store_dwordx4 v[144:147], v198, s[28:31], s59 offen sc1
    s_branch L_cs2_139
L_cs1_138:
    buffer_store_dwordx4 v[148:151], v198, s[28:31], s59 offen offset:1024 sc1
L_cs2_139:
    v_mfma_f32_16x16x32_bf16 v[28:31], v[128:131], v[124:127], v[28:31]
    v_mfma_f32_16x16x32_bf16 v[44:47], v[132:135], v[124:127], v[44:47]
    v_mfma_f32_16x16x32_bf16 v[72:75], v[124:127], v[136:139], v[72:75]
    v_mfma_f32_16x16x32_bf16 v[76:79], v[124:127], v[140:143], v[76:79]
    v_mfma_f32_16x16x32_bf16 v[104:107], v[124:127], v[144:147], v[104:107]
    v_mfma_f32_16x16x32_bf16 v[108:111], v[124:127], v[148:151], v[108:111]
    s_branch L_cpb_41
L_cp_42:
    s_waitcnt lgkmcnt(0)
    v_mfma_f32_16x16x32_bf16 v[16:19], v[168:171], v[152:155], v[16:19]
    v_mfma_f32_16x16x32_bf16 v[32:35], v[172:175], v[152:155], v[32:35]
    v_mfma_f32_16x16x32_bf16 v[48:51], v[152:155], v[176:179], v[48:51]
    v_mfma_f32_16x16x32_bf16 v[52:55], v[152:155], v[180:183], v[52:55]
    s_add_u32 s59, s58, 12288
    s_cmp_lg_u32 s48, 0
    s_cbranch_scc1 L_cs1_140
    buffer_store_dwordx4 v[168:171], v198, s[28:31], s59 offen sc1
    s_branch L_cs2_141
L_cs1_140:
    buffer_store_dwordx4 v[172:175], v198, s[28:31], s59 offen offset:1024 sc1
L_cs2_141:
    v_mfma_f32_16x16x32_bf16 v[80:83], v[152:155], v[184:187], v[80:83]
    v_mfma_f32_16x16x32_bf16 v[84:87], v[152:155], v[188:191], v[84:87]
    v_mfma_f32_16x16x32_bf16 v[20:23], v[168:171], v[156:159], v[20:23]
    v_mfma_f32_16x16x32_bf16 v[36:39], v[172:175], v[156:159], v[36:39]
    v_mfma_f32_16x16x32_bf16 v[56:59], v[156:159], v[176:179], v[56:59]
    v_mfma_f32_16x16x32_bf16 v[60:63], v[156:159], v[180:183], v[60:63]
    v_mfma_f32_16x16x32_bf16 v[88:91], v[156:159], v[184:187], v[88:91]
    s_add_u32 s59, s58, 16384
    s_cmp_lg_u32 s48, 0
    s_cbranch_scc1 L_cs1_142
    buffer_store_dwordx4 v[176:179], v198, s[28:31], s59 offen sc1
    s_branch L_cs2_143
L_cs1_142:
    buffer_store_dwordx4 v[180:183], v198, s[28:31], s59 offen offset:1024 sc1
L_cs2_143:
    v_mfma_f32_16x16x32_bf16 v[92:95], v[156:159], v[188:191], v[92:95]
    v_mfma_f32_16x16x32_bf16 v[24:27], v[168:171], v[160:163], v[24:27]
    v_mfma_f32_16x16x32_bf16 v[40:43], v[172:175], v[160:163], v[40:43]
    v_mfma_f32_16x16x32_bf16 v[64:67], v[160:163], v[176:179], v[64:67]
    v_mfma_f32_16x16x32_bf16 v[68:71], v[160:163], v[180:183], v[68:71]
    v_mfma_f32_16x16x32_bf16 v[96:99], v[160:163], v[184:187], v[96:99]
    v_mfma_f32_16x16x32_bf16 v[100:103], v[160:163], v[188:191], v[100:103]
    s_add_u32 s59, s58, 20480
    s_cmp_lg_u32 s48, 0
    s_cbranch_scc1 L_cs1_144
    buffer_store_dwordx4 v[184:187], v198, s[28:31], s59 offen sc1
    s_branch L_cs2_145
L_cs1_144:
    buffer_store_dwordx4 v[188:191], v198, s[28:31], s59 offen offset:1024 sc1
L_cs2_145:
    v_mfma_f32_16x16x32_bf16 v[28:31], v[168:171], v[164:167], v[28:31]
    v_mfma_f32_16x16x32_bf16 v[44:47], v[172:175], v[164:167], v[44:47]
    v_mfma_f32_16x16x32_bf16 v[72:75], v[164:167], v[176:179], v[72:75]
    v_mfma_f32_16x16x32_bf16 v[76:79], v[164:167], v[180:183], v[76:79]
    v_mfma_f32_16x16x32_bf16 v[104:107], v[164:167], v[184:187], v[104:107]
    v_mfma_f32_16x16x32_bf16 v[108:111], v[164:167], v[188:191], v[108:111]
    s_branch L_cpb_43
L_rare_87:
    s_waitcnt vmcnt(0)
    s_branch L_back_88
L_rare_89:
    s_cmp_lg_u32 s3, 0
    s_cbranch_scc1 L_rih_146
    s_and_b32 s44, s2, 7
    s_lshl_b32 s44, s44, 5
    v_mov_b32 v2, 0
    v_mov_b32 v3, 1
    s_mov_b64 s[46:47], exec
    s_mov_b32 exec_lo, 0x1
    s_mov_b32 exec_hi, 0x0
    buffer_atomic_add v3, v2, s[36:39], s44 offen sc1
    s_mov_b64 exec, s[46:47]
L_rih_146:
    s_branch L_back_90
L_coldskip_44:
    v_lshlrev_b32 v14, 4, v1
    s_lshl_b32 s50, s3, 13
    s_add_u32 s50, s50, 65536
    v_add_u32 v9, s50, v14
    s_nop 4
    ds_write_b128 v9, v[16:19] offset:0
    ds_write_b128 v9, v[20:23] offset:1024
    ds_write_b128 v9, v[24:27] offset:2048
    ds_write_b128 v9, v[28:31] offset:3072
    ds_write_b128 v9, v[32:35] offset:4096
    ds_write_b128 v9, v[36:39] offset:5120
    ds_write_b128 v9, v[40:43] offset:6144
    ds_write_b128 v9, v[44:47] offset:7168
    s_waitcnt lgkmcnt(0)
    s_barrier
    v_and_b32 v5, 15, v1
    v_lshrrev_b32 v6, 4, v1
    s_mul_i32 s50, s49, 384
    v_lshlrev_b32 v8, 2, v5
    v_add_u32 v9, s50, v8
    ds_read_b32 v120, v9 offset:1152
    ds_read_b32 v121, v9 offset:1216
    ds_read_b32 v122, v9 offset:1280
    ds_read_b32 v123, v9 offset:1344
    s_lshl_b32 s50, s48, 8
    v_lshlrev_b32 v9, 4, v6
    v_add_u32 v9, s50, v9
    ds_read_b128 v[132:135], v9 offset:0
    ds_read_b128 v[148:151], v9 offset:512
    ds_read_b128 v[136:139], v9 offset:64
    ds_read_b128 v[152:155], v9 offset:576
    ds_read_b128 v[140:143], v9 offset:128
    ds_read_b128 v[156:159], v9 offset:640
    ds_read_b128 v[144:147], v9 offset:192
    ds_read_b128 v[160:163], v9 offset:704
    s_waitcnt lgkmcnt(0)
    v_mov_b32 v164, v120
    v_mov_b32 v165, v120
    v_mov_b32 v166, v121
    v_mov_b32 v167, v121
    v_mov_b32 v168, v122
    v_mov_b32 v169, v122
    v_mov_b32 v170, v123
    v_mov_b32 v171, v123
    v_pk_fma_f32 v[48:49], v[132:133], v[164:165], v[48:49] neg_lo:[1,0,0] neg_hi:[1,0,0]
    v_pk_fma_f32 v[52:53], v[132:133], v[166:167], v[52:53] neg_lo:[1,0,0] neg_hi:[1,0,0]
    v_pk_fma_f32 v[80:81], v[132:133], v[168:169], v[80:81] neg_lo:[1,0,0] neg_hi:[1,0,0]
    v_pk_fma_f32 v[84:85], v[132:133], v[170:171], v[84:85] neg_lo:[1,0,0] neg_hi:[1,0,0]
    v_pk_fma_f32 v[50:51], v[134:135], v[164:165], v[50:51] neg_lo:[1,0,0] neg_hi:[1,0,0]
    v_pk_fma_f32 v[54:55], v[134:135], v[166:167], v[54:55] neg_lo:[1,0,0] neg_hi:[1,0,0]
    v_pk_fma_f32 v[82:83], v[134:135], v[168:169], v[82:83] neg_lo:[1,0,0] neg_hi:[1,0,0]
    v_pk_fma_f32 v[86:87], v[134:135], v[170:171], v[86:87] neg_lo:[1,0,0] neg_hi:[1,0,0]
    v_pk_fma_f32 v[56:57], v[136:137], v[164:165], v[56:57] neg_lo:[1,0,0] neg_hi:[1,0,0]
    v_pk_fma_f32 v[60:61], v[136:137], v[166:167], v[60:61] neg_lo:[1,0,0] neg_hi:[1,0,0]
    v_pk_fma_f32 v[88:89], v[136:137], v[168:169], v[88:89] neg_lo:[1,0,0] neg_hi:[1,0,0]
    v_pk_fma_f32 v[92:93], v[136:137], v[170:171], v[92:93] neg_lo:[1,0,0] neg_hi:[1,0,0]
    v_pk_fma_f32 v[58:59], v[138:139], v[164:165], v[58:59] neg_lo:[1,0,0] neg_hi:[1,0,0]
    v_pk_fma_f32 v[62:63], v[138:139], v[166:167], v[62:63] neg_lo:[1,0,0] neg_hi:[1,0,0]
    v_pk_fma_f32 v[90:91], v[138:139], v[168:169], v[90:91] neg_lo:[1,0,0] neg_hi:[1,0,0]
    v_pk_fma_f32 v[94:95], v[138:139], v[170:171], v[94:95] neg_lo:[1,0,0] neg_hi:[1,0,0]
    v_pk_fma_f32 v[64:65], v[140:141], v[164:165], v[64:65] neg_lo:[1,0,0] neg_hi:[1,0,0]
    v_pk_fma_f32 v[68:69], v[140:141], v[166:167], v[68:69] neg_lo:[1,0,0] neg_hi:[1,0,0]
    v_pk_fma_f32 v[96:97], v[140:141], v[168:169], v[96:97] neg_lo:[1,0,0] neg_hi:[1,0,0]
    v_pk_fma_f32 v[100:101], v[140:141], v[170:171], v[100:101] neg_lo:[1,0,0] neg_hi:[1,0,0]
    v_pk_fma_f32 v[66:67], v[142:143], v[164:165], v[66:67] neg_lo:[1,0,0] neg_hi:[1,0,0]
    v_pk_fma_f32 v[70:71], v[142:143], v[166:167], v[70:71] neg_lo:[1,0,0] neg_hi:[1,0,0]
    v_pk_fma_f32 v[98:99], v[142:143], v[168:169], v[98:99] neg_lo:[1,0,0] neg_hi:[1,0,0]
    v_pk_fma_f32 v[102:103], v[142:143], v[170:171], v[102:103] neg_lo:[1,0,0] neg_hi:[1,0,0]
    v_pk_fma_f32 v[72:73], v[144:145], v[164:165], v[72:73] neg_lo:[1,0,0] neg_hi:[1,0,0]
    v_pk_fma_f32 v[76:77], v[144:145], v[166:167], v[76:77] neg_lo:[1,0,0] neg_hi:[1,0,0]
    v_pk_fma_f32 v[104:105], v[144:145], v[168:169], v[104:105] neg_lo:[1,0,0] neg_hi:[1,0,0]
    v_pk_fma_f32 v[108:109], v[144:145], v[170:171], v[108:109] neg_lo:[1,0,0] neg_hi:[1,0,0]
    v_pk_fma_f32 v[74:75], v[146:147], v[164:165], v[74:75] neg_lo:[1,0,0] neg_hi:[1,0,0]
    v_pk_fma_f32 v[78:79], v[146:147], v[166:167], v[78:79] neg_lo:[1,0,0] neg_hi:[1,0,0]
    v_pk_fma_f32 v[106:107], v[146:147], v[168:169], v[106:107] neg_lo:[1,0,0] neg_hi:[1,0,0]
    v_pk_fma_f32 v[110:111], v[146:147], v[170:171], v[110:111] neg_lo:[1,0,0] neg_hi:[1,0,0]
    v_pk_mul_f32 v[48:49], v[48:49], v[148:149]
    v_pk_mul_f32 v[52:53], v[52:53], v[148:149]
    v_pk_mul_f32 v[80:81], v[80:81], v[148:149]
    v_pk_mul_f32 v[84:85], v[84:85], v[148:149]
    v_pk_mul_f32 v[50:51], v[50:51], v[150:151]
    v_pk_mul_f32 v[54:55], v[54:55], v[150:151]
    v_pk_mul_f32 v[82:83], v[82:83], v[150:151]
    v_pk_mul_f32 v[86:87], v[86:87], v[150:151]
    v_pk_mul_f32 v[56:57], v[56:57], v[152:153]
    v_pk_mul_f32 v[60:61], v[60:61], v[152:153]
    v_pk_mul_f32 v[88:89], v[88:89], v[152:153]
    v_pk_mul_f32 v[92:93], v[92:93], v[152:153]
    v_pk_mul_f32 v[58:59], v[58:59], v[154:155]
    v_pk_mul_f32 v[62:63], v[62:63], v[154:155]
    v_pk_mul_f32 v[90:91], v[90:91], v[154:155]
    v_pk_mul_f32 v[94:95], v[94:95], v[154:155]
    v_pk_mul_f32 v[64:65], v[64:65], v[156:157]
    v_pk_mul_f32 v[68:69], v[68:69], v[156:157]
    v_pk_mul_f32 v[96:97], v[96:97], v[156:157]
    v_pk_mul_f32 v[100:101], v[100:101], v[156:157]
    v_pk_mul_f32 v[66:67], v[66:67], v[158:159]
    v_pk_mul_f32 v[70:71], v[70:71], v[158:159]
    v_pk_mul_f32 v[98:99], v[98:99], v[158:159]
    v_pk_mul_f32 v[102:103], v[102:103], v[158:159]
    v_pk_mul_f32 v[72:73], v[72:73], v[160:161]
    v_pk_mul_f32 v[76:77], v[76:77], v[160:161]
    v_pk_mul_f32 v[104:105], v[104:105], v[160:161]
    v_pk_mul_f32 v[108:109], v[108:109], v[160:161]
    v_pk_mul_f32 v[74:75], v[74:75], v[162:163]
    v_pk_mul_f32 v[78:79], v[78:79], v[162:163]
    v_pk_mul_f32 v[106:107], v[106:107], v[162:163]
    v_pk_mul_f32 v[110:111], v[110:111], v[162:163]
    s_mov_b32 s68, 1069066811
    s_mov_b32 s69, 1069066811
    v_mov_b32 v10, 0x358637bd
    v_mov_b32 v11, 0x358637bd
    v_pk_mul_f32 v[12:13], v[48:49], s[68:69]
    v_pk_add_f32 v[48:49], v[48:49], v[10:11]
    v_exp_f32 v12, v12 clamp
    v_exp_f32 v13, v13 clamp
    v_max_f32 v48, v48, v11
    v_max_f32 v49, v49, v11
    v_pk_add_f32 v[48:49], v[48:49], v[12:13]
    v_cvt_pk_bf16_f32 v112, v48, v49
    v_pk_mul_f32 v[2:3], v[50:51], s[68:69]
    v_pk_add_f32 v[50:51], v[50:51], v[10:11]
    v_exp_f32 v2, v2 clamp
    v_exp_f32 v3, v3 clamp
    v_max_f32 v50, v50, v11
    v_max_f32 v51, v51, v11
    v_pk_add_f32 v[50:51], v[50:51], v[2:3]
    v_cvt_pk_bf16_f32 v113, v50, v51
    v_pk_mul_f32 v[12:13], v[56:57], s[68:69]
    v_pk_add_f32 v[56:57], v[56:57], v[10:11]
    v_exp_f32 v12, v12 clamp
    v_exp_f32 v13, v13 clamp
    v_max_f32 v56, v56, v11
    v_max_f32 v57, v57, v11
    v_pk_add_f32 v[56:57], v[56:57], v[12:13]
    v_cvt_pk_bf16_f32 v114, v56, v57
    v_pk_mul_f32 v[2:3], v[58:59], s[68:69]
    v_pk_add_f32 v[58:59], v[58:59], v[10:11]
    v_exp_f32 v2, v2 clamp
    v_exp_f32 v3, v3 clamp
    v_max_f32 v58, v58, v11
    v_max_f32 v59, v59, v11
    v_pk_add_f32 v[58:59], v[58:59], v[2:3]
    v_cvt_pk_bf16_f32 v115, v58, v59
    v_pk_mul_f32 v[12:13], v[64:65], s[68:69]
    v_pk_add_f32 v[64:65], v[64:65], v[10:11]
    v_exp_f32 v12, v12 clamp
    v_exp_f32 v13, v13 clamp
    v_max_f32 v64, v64, v11
    v_max_f32 v65, v65, v11
    v_pk_add_f32 v[64:65], v[64:65], v[12:13]
    v_cvt_pk_bf16_f32 v116, v64, v65
    v_pk_mul_f32 v[2:3], v[66:67], s[68:69]
    v_pk_add_f32 v[66:67], v[66:67], v[10:11]
    v_exp_f32 v2, v2 clamp
    v_exp_f32 v3, v3 clamp
    v_max_f32 v66, v66, v11
    v_max_f32 v67, v67, v11
    v_pk_add_f32 v[66:67], v[66:67], v[2:3]
    v_cvt_pk_bf16_f32 v117, v66, v67
    v_pk_mul_f32 v[12:13], v[72:73], s[68:69]
    v_pk_add_f32 v[72:73], v[72:73], v[10:11]
    v_exp_f32 v12, v12 clamp
    v_exp_f32 v13, v13 clamp
    v_max_f32 v72, v72, v11
    v_max_f32 v73, v73, v11
    v_pk_add_f32 v[72:73], v[72:73], v[12:13]
    v_cvt_pk_bf16_f32 v118, v72, v73
    v_pk_mul_f32 v[2:3], v[74:75], s[68:69]
    v_pk_add_f32 v[74:75], v[74:75], v[10:11]
    v_exp_f32 v2, v2 clamp
    v_exp_f32 v3, v3 clamp
    v_max_f32 v74, v74, v11
    v_max_f32 v75, v75, v11
    v_pk_add_f32 v[74:75], v[74:75], v[2:3]
    v_cvt_pk_bf16_f32 v119, v74, v75
    v_pk_mul_f32 v[12:13], v[52:53], s[68:69]
    v_pk_add_f32 v[52:53], v[52:53], v[10:11]
    v_exp_f32 v12, v12 clamp
    v_exp_f32 v13, v13 clamp
    v_max_f32 v52, v52, v11
    v_max_f32 v53, v53, v11
    v_pk_add_f32 v[52:53], v[52:53], v[12:13]
    v_cvt_pk_bf16_f32 v120, v52, v53
    v_pk_mul_f32 v[2:3], v[54:55], s[68:69]
    v_pk_add_f32 v[54:55], v[54:55], v[10:11]
    v_exp_f32 v2, v2 clamp
    v_exp_f32 v3, v3 clamp
    v_max_f32 v54, v54, v11
    v_max_f32 v55, v55, v11
    v_pk_add_f32 v[54:55], v[54:55], v[2:3]
    v_cvt_pk_bf16_f32 v121, v54, v55
    v_pk_mul_f32 v[12:13], v[60:61], s[68:69]
    v_pk_add_f32 v[60:61], v[60:61], v[10:11]
    v_exp_f32 v12, v12 clamp
    v_exp_f32 v13, v13 clamp
    v_max_f32 v60, v60, v11
    v_max_f32 v61, v61, v11
    v_pk_add_f32 v[60:61], v[60:61], v[12:13]
    v_cvt_pk_bf16_f32 v122, v60, v61
    v_pk_mul_f32 v[2:3], v[62:63], s[68:69]
    v_pk_add_f32 v[62:63], v[62:63], v[10:11]
    v_exp_f32 v2, v2 clamp
    v_exp_f32 v3, v3 clamp
    v_max_f32 v62, v62, v11
    v_max_f32 v63, v63, v11
    v_pk_add_f32 v[62:63], v[62:63], v[2:3]
    v_cvt_pk_bf16_f32 v123, v62, v63
    v_pk_mul_f32 v[12:13], v[68:69], s[68:69]
    v_pk_add_f32 v[68:69], v[68:69], v[10:11]
    v_exp_f32 v12, v12 clamp
    v_exp_f32 v13, v13 clamp
    v_max_f32 v68, v68, v11
    v_max_f32 v69, v69, v11
    v_pk_add_f32 v[68:69], v[68:69], v[12:13]
    v_cvt_pk_bf16_f32 v124, v68, v69
    v_pk_mul_f32 v[2:3], v[70:71], s[68:69]
    v_pk_add_f32 v[70:71], v[70:71], v[10:11]
    v_exp_f32 v2, v2 clamp
    v_exp_f32 v3, v3 clamp
    v_max_f32 v70, v70, v11
    v_max_f32 v71, v71, v11
    v_pk_add_f32 v[70:71], v[70:71], v[2:3]
    v_cvt_pk_bf16_f32 v125, v70, v71
    v_pk_mul_f32 v[12:13], v[76:77], s[68:69]
    v_pk_add_f32 v[76:77], v[76:77], v[10:11]
    v_exp_f32 v12, v12 clamp
    v_exp_f32 v13, v13 clamp
    v_max_f32 v76, v76, v11
    v_max_f32 v77, v77, v11
    v_pk_add_f32 v[76:77], v[76:77], v[12:13]
    v_cvt_pk_bf16_f32 v126, v76, v77
    v_pk_mul_f32 v[2:3], v[78:79], s[68:69]
    v_pk_add_f32 v[78:79], v[78:79], v[10:11]
    v_exp_f32 v2, v2 clamp
    v_exp_f32 v3, v3 clamp
    v_max_f32 v78, v78, v11
    v_max_f32 v79, v79, v11
    v_pk_add_f32 v[78:79], v[78:79], v[2:3]
    v_cvt_pk_bf16_f32 v127, v78, v79
    v_cvt_pk_bf16_f32 v128, v80, v81
    v_cvt_pk_bf16_f32 v129, v82, v83
    v_cvt_pk_bf16_f32 v130, v88, v89
    v_cvt_pk_bf16_f32 v131, v90, v91
    v_cvt_pk_bf16_f32 v132, v96, v97
    v_cvt_pk_bf16_f32 v133, v98, v99
    v_cvt_pk_bf16_f32 v134, v104, v105
    v_cvt_pk_bf16_f32 v135, v106, v107
    v_cvt_pk_bf16_f32 v136, v84, v85
    v_cvt_pk_bf16_f32 v137, v86, v87
    v_cvt_pk_bf16_f32 v138, v92, v93
    v_cvt_pk_bf16_f32 v139, v94, v95
    v_cvt_pk_bf16_f32 v140, v100, v101
    v_cvt_pk_bf16_f32 v141, v102, v103
    v_cvt_pk_bf16_f32 v142, v108, v109
    v_cvt_pk_bf16_f32 v143, v110, v111
    v_mov_b32 v144, 0x3f803f80
    v_mov_b32 v145, 0x3f803f80
    v_mov_b32 v146, 0x3f803f80
    v_mov_b32 v147, 0x3f803f80
    s_nop 1
    v_mfma_f32_16x16x32_bf16 v[148:151], v[112:115], v[128:131], 0
    v_mfma_f32_16x16x32_bf16 v[152:155], v[112:115], v[136:139], 0
    v_mfma_f32_16x16x32_bf16 v[164:167], v[144:147], v[112:115], 0
    v_mfma_f32_16x16x32_bf16 v[156:159], v[120:123], v[128:131], 0
    v_mfma_f32_16x16x32_bf16 v[160:163], v[120:123], v[136:139], 0
    v_mfma_f32_16x16x32_bf16 v[168:171], v[144:147], v[120:123], 0
    v_mfma_f32_16x16x32_bf16 v[148:151], v[116:119], v[132:135], v[148:151]
    v_mfma_f32_16x16x32_bf16 v[152:155], v[116:119], v[140:143], v[152:155]
    v_mfma_f32_16x16x32_bf16 v[164:167], v[144:147], v[116:119], v[164:167]
    v_mfma_f32_16x16x32_bf16 v[156:159], v[124:127], v[132:135], v[156:159]
    v_mfma_f32_16x16x32_bf16 v[160:163], v[124:127], v[140:143], v[160:163]
    v_mfma_f32_16x16x32_bf16 v[168:171], v[144:147], v[124:127], v[168:171]
    s_lshl_b32 s52, s43, 1
    s_add_u32 s52, s52, s49
    v_lshlrev_b32 v14, 4, v1
    s_mul_i32 s50, s49, 5120
    v_add_u32 v9, s50, v14
    v_lshlrev_b32 v15, 2, v1
    v_add_u32 v10, s50, v15
    v_cmp_gt_u32 vcc, 16, v1
    s_nop 4
    v_cndmask_b32 v164, v168, v164, vcc
    s_cmp_eq_u32 s48, 0
    s_cbranch_scc1 L_kvw_147
    ds_write_b128 v9, v[148:151] offset:4096
    ds_write_b128 v9, v[152:155] offset:5120
    ds_write_b128 v9, v[156:159] offset:6144
    ds_write_b128 v9, v[160:163] offset:7168
    ds_write_b32 v10, v164 offset:8192
    s_waitcnt lgkmcnt(0)
L_kvw_147:
    s_barrier
    s_cmp_lg_u32 s48, 0
    s_cbranch_scc1 L_kvr_148
    ds_read_b128 v[180:183], v9 offset:4096
    ds_read_b128 v[184:187], v9 offset:5120
    ds_read_b128 v[188:191], v9 offset:6144
    ds_read_b128 v[192:195], v9 offset:7168
    ds_read_b32 v196, v10 offset:8192
    s_mul_i32 s53, s40, 65536
    s_add_u32 s53, s53, 32768
    s_lshl_b32 s50, s52, 11
    s_add_u32 s50, s50, s53
    s_waitcnt lgkmcnt(0)
    v_pk_add_f32 v[148:149], v[148:149], v[180:181]
    v_pk_add_f32 v[150:151], v[150:151], v[182:183]
    v_pk_add_f32 v[152:153], v[152:153], v[184:185]
    v_pk_add_f32 v[154:155], v[154:155], v[186:187]
    v_pk_add_f32 v[156:157], v[156:157], v[188:189]
    v_pk_add_f32 v[158:159], v[158:159], v[190:191]
    v_pk_add_f32 v[160:161], v[160:161], v[192:193]
    v_pk_add_f32 v[162:163], v[162:163], v[194:195]
    v_add_f32 v164, v164, v196
    v_cvt_pk_bf16_f32 v180, v148, v149
    v_cvt_pk_bf16_f32 v181, v150, v151
    v_cvt_pk_bf16_f32 v182, v156, v157
    v_cvt_pk_bf16_f32 v183, v158, v159
    v_cvt_pk_bf16_f32 v184, v152, v153
    v_cvt_pk_bf16_f32 v185, v154, v155
    v_cvt_pk_bf16_f32 v186, v160, v161
    v_cvt_pk_bf16_f32 v187, v162, v163
    buffer_atomic_pk_add_bf16 v180, v15, s[28:31], s50 offen offset:0
    buffer_atomic_pk_add_bf16 v181, v15, s[28:31], s50 offen offset:256
    buffer_atomic_pk_add_bf16 v182, v15, s[28:31], s50 offen offset:512
    buffer_atomic_pk_add_bf16 v183, v15, s[28:31], s50 offen offset:768
    buffer_atomic_pk_add_bf16 v184, v15, s[28:31], s50 offen offset:1024
    buffer_atomic_pk_add_bf16 v185, v15, s[28:31], s50 offen offset:1280
    buffer_atomic_pk_add_bf16 v186, v15, s[28:31], s50 offen offset:1536
    buffer_atomic_pk_add_bf16 v187, v15, s[28:31], s50 offen offset:1792
    s_mul_i32 s53, s40, 4096
    s_add_u32 s53, s53, 163840
    s_lshl_b32 s50, s52, 7
    s_add_u32 s50, s50, s53
    s_mov_b64 s[46:47], exec
    s_mov_b32 exec_lo, 0xffffffff
    s_mov_b32 exec_hi, 0x0
    buffer_atomic_add_f32 v164, v15, s[28:31], s50 offen
    s_mov_b64 exec, s[46:47]
L_kvr_148:
    s_branch L_r_done_2
L_r_loader_1:
    s_sub_u32 s48, s3, 4
    v_lshrrev_b32 v8, 3, v1
    v_and_b32 v6, 7, v1
    v_lshrrev_b32 v7, 4, v1
    v_xor_b32 v9, v6, v7
    v_lshlrev_b32 v2, 11, v8
    v_lshl_add_u32 v2, v9, 4, v2
    v_xor_b32 v9, 4, v9
    v_lshlrev_b32 v3, 11, v8
    v_lshl_add_u32 v3, v9, 4, v3
    v_and_b32 v9, 1, v7
    v_lshlrev_b32 v9, 1, v9
    v_xor_b32 v9, v6, v9
    s_movk_i32 s53, 6144
    v_mul_lo_u32 v10, v8, s53
    v_lshl_add_u32 v4, v9, 4, v10
    v_xor_b32 v9, 4, v9
    v_lshl_add_u32 v5, v9, 4, v10
    s_lshl_b32 s49, s42, 18
    s_lshl_b32 s53, s48, 16
    s_add_u32 s49, s49, s53
    s_lshl_b32 s51, s48, 12
    s_mul_i32 s50, s48, 98304
    s_lshl_b32 s53, s43, 7
    s_add_u32 s50, s50, s53
    s_lshl_b32 s52, s48, 11
    s_add_u32 s52, s52, 65536
    s_add_u32 m0, s51, 0
    s_add_u32 s53, s49, 0
    buffer_load_dwordx4 v2, s[16:19], s53 offen lds
    s_add_u32 m0, s51, 1024
    s_add_u32 s53, s49, 16384
    buffer_load_dwordx4 v3, s[16:19], s53 offen lds
    s_add_u32 m0, s51, 2048
    s_add_u32 s53, s49, 32768
    buffer_load_dwordx4 v2, s[16:19], s53 offen lds
    s_add_u32 m0, s51, 3072
    s_add_u32 s53, s49, 49152
    buffer_load_dwordx4 v3, s[16:19], s53 offen lds
    s_add_u32 s49, s49, 128
    s_add_u32 m0, s52, 0
    s_add_u32 s53, s50, 0
    buffer_load_dwordx4 v4, s[20:23], s53 offen lds
    s_add_u32 m0, s52, 1024
    s_add_u32 s53, s50, 49152
    buffer_load_dwordx4 v5, s[20:23], s53 offen lds
    s_add_u32 m0, s52, 8192
    s_add_u32 s53, s50, 2048
    buffer_load_dwordx4 v4, s[20:23], s53 offen lds
    s_add_u32 m0, s52, 9216
    s_add_u32 s53, s50, 51200
    buffer_load_dwordx4 v5, s[20:23], s53 offen lds
    s_add_u32 m0, s52, 16384
    s_add_u32 s53, s50, 4096
    buffer_load_dwordx4 v4, s[20:23], s53 offen lds
    s_add_u32 m0, s52, 17408
    s_add_u32 s53, s50, 53248
    buffer_load_dwordx4 v5, s[20:23], s53 offen lds
    s_add_u32 s50, s50, 393216
    s_lshr_b32 s56, s48, 1
    s_lshl_b32 s57, s2, 1
    s_add_u32 s57, s57, s56
    s_lshr_b32 s58, s57, 4
    s_and_b32 s59, s57, 15
    v_lshlrev_b32 v11, 11, v8
    v_lshl_add_u32 v11, v6, 4, v11
    s_and_b32 s60, s48, 1
    s_lshl_b32 s61, s58, 16
    s_lshl_b32 s62, s60, 15
    s_add_u32 s61, s61, s62
    s_lshl_b32 s62, s59, 7
    s_add_u32 s61, s61, s62
    s_lshl_b32 s62, s56, 12
    s_lshl_b32 s63, s60, 11
    s_add_u32 s62, s62, s63
    s_add_u32 m0, s62, 139264
    s_nop 0
    buffer_load_dwordx4 v11, s[24:27], s61 offen lds
    s_add_u32 m0, s62, 140288
    s_add_u32 s61, s61, 16384
    buffer_load_dwordx4 v11, s[24:27], s61 offen lds
    s_add_u32 m0, s51, 16384
    s_add_u32 s53, s49, 0
    buffer_load_dwordx4 v2, s[16:19], s53 offen lds
    s_add_u32 m0, s51, 17408
    s_add_u32 s53, s49, 16384
    buffer_load_dwordx4 v3, s[16:19], s53 offen lds
    s_add_u32 m0, s51, 18432
    s_add_u32 s53, s49, 32768
    buffer_load_dwordx4 v2, s[16:19], s53 offen lds
    s_add_u32 m0, s51, 19456
    s_add_u32 s53, s49, 49152
    buffer_load_dwordx4 v3, s[16:19], s53 offen lds
    s_add_u32 s49, s49, 128
    s_add_u32 m0, s52, 24576
    s_add_u32 s53, s50, 0
    buffer_load_dwordx4 v4, s[20:23], s53 offen lds
    s_add_u32 m0, s52, 25600
    s_add_u32 s53, s50, 49152
    buffer_load_dwordx4 v5, s[20:23], s53 offen lds
    s_add_u32 m0, s52, 32768
    s_add_u32 s53, s50, 2048
    buffer_load_dwordx4 v4, s[20:23], s53 offen lds
    s_add_u32 m0, s52, 33792
    s_add_u32 s53, s50, 51200
    buffer_load_dwordx4 v5, s[20:23], s53 offen lds
    s_add_u32 m0, s52, 40960
    s_add_u32 s53, s50, 4096
    buffer_load_dwordx4 v4, s[20:23], s53 offen lds
    s_add_u32 m0, s52, 41984
    s_add_u32 s53, s50, 53248
    buffer_load_dwordx4 v5, s[20:23], s53 offen lds
    s_add_u32 s50, s50, 393216
    s_add_u32 m0, s51, 32768
    s_add_u32 s53, s49, 0
    buffer_load_dwordx4 v2, s[16:19], s53 offen lds
    s_add_u32 m0, s51, 33792
    s_add_u32 s53, s49, 16384
    buffer_load_dwordx4 v3, s[16:19], s53 offen lds
    s_add_u32 m0, s51, 34816
    s_add_u32 s53, s49, 32768
    buffer_load_dwordx4 v2, s[16:19], s53 offen lds
    s_add_u32 m0, s51, 35840
    s_add_u32 s53, s49, 49152
    buffer_load_dwordx4 v3, s[16:19], s53 offen lds
    s_add_u32 s49, s49, 128
    s_add_u32 m0, s52, 49152
    s_add_u32 s53, s50, 0
    buffer_load_dwordx4 v4, s[20:23], s53 offen lds
    s_add_u32 m0, s52, 50176
    s_add_u32 s53, s50, 49152
    buffer_load_dwordx4 v5, s[20:23], s53 offen lds
    s_add_u32 m0, s52, 57344
    s_add_u32 s53, s50, 2048
    buffer_load_dwordx4 v4, s[20:23], s53 offen lds
    s_add_u32 m0, s52, 58368
    s_add_u32 s53, s50, 51200
    buffer_load_dwordx4 v5, s[20:23], s53 offen lds
    s_add_u32 m0, s52, 65536
    s_add_u32 s53, s50, 4096
    buffer_load_dwordx4 v4, s[20:23], s53 offen lds
    s_add_u32 m0, s52, 66560
    s_add_u32 s53, s50, 53248
    buffer_load_dwordx4 v5, s[20:23], s53 offen lds
    s_add_u32 s50, s50, 393216
    s_waitcnt vmcnt(20)
    s_barrier
    s_add_u32 m0, s51, 49152
    s_add_u32 s53, s49, 0
    buffer_load_dwordx4 v2, s[16:19], s53 offen lds
    s_add_u32 m0, s51, 50176
    s_add_u32 s53, s49, 16384
    buffer_load_dwordx4 v3, s[16:19], s53 offen lds
    s_add_u32 m0, s51, 51200
    s_add_u32 s53, s49, 32768
    buffer_load_dwordx4 v2, s[16:19], s53 offen lds
    s_add_u32 m0, s51, 52224
    s_add_u32 s53, s49, 49152
    buffer_load_dwordx4 v3, s[16:19], s53 offen lds
    s_add_u32 s49, s49, 128
    s_waitcnt vmcnt(14)
    s_barrier
    s_add_u32 m0, s52, 73728
    s_add_u32 s53, s50, 0
    buffer_load_dwordx4 v4, s[20:23], s53 offen lds
    s_add_u32 m0, s52, 74752
    s_add_u32 s53, s50, 49152
    buffer_load_dwordx4 v5, s[20:23], s53 offen lds
    s_add_u32 m0, s52, 81920
    s_add_u32 s53, s50, 2048
    buffer_load_dwordx4 v4, s[20:23], s53 offen lds
    s_add_u32 m0, s52, 82944
    s_add_u32 s53, s50, 51200
    buffer_load_dwordx4 v5, s[20:23], s53 offen lds
    s_add_u32 m0, s52, 90112
    s_add_u32 s53, s50, 4096
    buffer_load_dwordx4 v4, s[20:23], s53 offen lds
    s_add_u32 m0, s52, 91136
    s_add_u32 s53, s50, 53248
    buffer_load_dwordx4 v5, s[20:23], s53 offen lds
    s_add_u32 s50, s50, 393216
    s_add_u32 m0, s51, 0
    s_add_u32 s53, s49, 0
    buffer_load_dwordx4 v2, s[16:19], s53 offen lds
    s_add_u32 m0, s51, 1024
    s_add_u32 s53, s49, 16384
    buffer_load_dwordx4 v3, s[16:19], s53 offen lds
    s_add_u32 m0, s51, 2048
    s_add_u32 s53, s49, 32768
    buffer_load_dwordx4 v2, s[16:19], s53 offen lds
    s_add_u32 m0, s51, 3072
    s_add_u32 s53, s49, 49152
    buffer_load_dwordx4 v3, s[16:19], s53 offen lds
    s_add_u32 s49, s49, 128
    s_add_u32 m0, s52, 0
    s_add_u32 s53, s50, 0
    buffer_load_dwordx4 v4, s[20:23], s53 offen lds
    s_add_u32 m0, s52, 1024
    s_add_u32 s53, s50, 49152
    buffer_load_dwordx4 v5, s[20:23], s53 offen lds
    s_add_u32 m0, s52, 8192
    s_add_u32 s53, s50, 2048
    buffer_load_dwordx4 v4, s[20:23], s53 offen lds
    s_add_u32 m0, s52, 9216
    s_add_u32 s53, s50, 51200
    buffer_load_dwordx4 v5, s[20:23], s53 offen lds
    s_add_u32 m0, s52, 16384
    s_add_u32 s53, s50, 4096
    buffer_load_dwordx4 v4, s[20:23], s53 offen lds
    s_add_u32 m0, s52, 17408
    s_add_u32 s53, s50, 53248
    buffer_load_dwordx4 v5, s[20:23], s53 offen lds
    s_add_u32 s50, s50, 393216
    s_waitcnt vmcnt(20)
    s_barrier
    s_add_u32 m0, s51, 16384
    s_add_u32 s53, s49, 0
    buffer_load_dwordx4 v2, s[16:19], s53 offen lds
    s_add_u32 m0, s51, 17408
    s_add_u32 s53, s49, 16384
    buffer_load_dwordx4 v3, s[16:19], s53 offen lds
    s_add_u32 m0, s51, 18432
    s_add_u32 s53, s49, 32768
    buffer_load_dwordx4 v2, s[16:19], s53 offen lds
    s_add_u32 m0, s51, 19456
    s_add_u32 s53, s49, 49152
    buffer_load_dwordx4 v3, s[16:19], s53 offen lds
    s_add_u32 s49, s49, 128
    s_add_u32 m0, s52, 24576
    s_add_u32 s53, s50, 0
    buffer_load_dwordx4 v4, s[20:23], s53 offen lds
    s_add_u32 m0, s52, 25600
    s_add_u32 s53, s50, 49152
    buffer_load_dwordx4 v5, s[20:23], s53 offen lds
    s_add_u32 m0, s52, 32768
    s_add_u32 s53, s50, 2048
    buffer_load_dwordx4 v4, s[20:23], s53 offen lds
    s_add_u32 m0, s52, 33792
    s_add_u32 s53, s50, 51200
    buffer_load_dwordx4 v5, s[20:23], s53 offen lds
    s_add_u32 m0, s52, 40960
    s_add_u32 s53, s50, 4096
    buffer_load_dwordx4 v4, s[20:23], s53 offen lds
    s_add_u32 m0, s52, 41984
    s_add_u32 s53, s50, 53248
    buffer_load_dwordx4 v5, s[20:23], s53 offen lds
    s_add_u32 s50, s50, 393216
    s_waitcnt vmcnt(20)
    s_barrier
    s_add_u32 m0, s51, 32768
    s_add_u32 s53, s49, 0
    buffer_load_dwordx4 v2, s[16:19], s53 offen lds
    s_add_u32 m0, s51, 33792
    s_add_u32 s53, s49, 16384
    buffer_load_dwordx4 v3, s[16:19], s53 offen lds
    s_add_u32 m0, s51, 34816
    s_add_u32 s53, s49, 32768
    buffer_load_dwordx4 v2, s[16:19], s53 offen lds
    s_add_u32 m0, s51, 35840
    s_add_u32 s53, s49, 49152
    buffer_load_dwordx4 v3, s[16:19], s53 offen lds
    s_add_u32 s49, s49, 128
    s_add_u32 m0, s52, 49152
    s_add_u32 s53, s50, 0
    buffer_load_dwordx4 v4, s[20:23], s53 offen lds
    s_add_u32 m0, s52, 50176
    s_add_u32 s53, s50, 49152
    buffer_load_dwordx4 v5, s[20:23], s53 offen lds
    s_add_u32 m0, s52, 57344
    s_add_u32 s53, s50, 2048
    buffer_load_dwordx4 v4, s[20:23], s53 offen lds
    s_add_u32 m0, s52, 58368
    s_add_u32 s53, s50, 51200
    buffer_load_dwordx4 v5, s[20:23], s53 offen lds
    s_add_u32 m0, s52, 65536
    s_add_u32 s53, s50, 4096
    buffer_load_dwordx4 v4, s[20:23], s53 offen lds
    s_add_u32 m0, s52, 66560
    s_add_u32 s53, s50, 53248
    buffer_load_dwordx4 v5, s[20:23], s53 offen lds
    s_add_u32 s50, s50, 393216
    s_waitcnt vmcnt(20)
    s_barrier
    s_add_u32 m0, s51, 49152
    s_add_u32 s53, s49, 0
    buffer_load_dwordx4 v2, s[16:19], s53 offen lds
    s_add_u32 m0, s51, 50176
    s_add_u32 s53, s49, 16384
    buffer_load_dwordx4 v3, s[16:19], s53 offen lds
    s_add_u32 m0, s51, 51200
    s_add_u32 s53, s49, 32768
    buffer_load_dwordx4 v2, s[16:19], s53 offen lds
    s_add_u32 m0, s51, 52224
    s_add_u32 s53, s49, 49152
    buffer_load_dwordx4 v3, s[16:19], s53 offen lds
    s_add_u32 s49, s49, 128
    s_add_u32 m0, s52, 73728
    s_add_u32 s53, s50, 0
    buffer_load_dwordx4 v4, s[20:23], s53 offen lds
    s_add_u32 m0, s52, 74752
    s_add_u32 s53, s50, 49152
    buffer_load_dwordx4 v5, s[20:23], s53 offen lds
    s_add_u32 m0, s52, 81920
    s_add_u32 s53, s50, 2048
    buffer_load_dwordx4 v4, s[20:23], s53 offen lds
    s_add_u32 m0, s52, 82944
    s_add_u32 s53, s50, 51200
    buffer_load_dwordx4 v5, s[20:23], s53 offen lds
    s_add_u32 m0, s52, 90112
    s_add_u32 s53, s50, 4096
    buffer_load_dwordx4 v4, s[20:23], s53 offen lds
    s_add_u32 m0, s52, 91136
    s_add_u32 s53, s50, 53248
    buffer_load_dwordx4 v5, s[20:23], s53 offen lds
    s_add_u32 s50, s50, 393216
    s_waitcnt vmcnt(20)
    s_barrier
    s_add_u32 m0, s51, 0
    s_add_u32 s53, s49, 0
    buffer_load_dwordx4 v2, s[16:19], s53 offen lds
    s_add_u32 m0, s51, 1024
    s_add_u32 s53, s49, 16384
    buffer_load_dwordx4 v3, s[16:19], s53 offen lds
    s_add_u32 m0, s51, 2048
    s_add_u32 s53, s49, 32768
    buffer_load_dwordx4 v2, s[16:19], s53 offen lds
    s_add_u32 m0, s51, 3072
    s_add_u32 s53, s49, 49152
    buffer_load_dwordx4 v3, s[16:19], s53 offen lds
    s_add_u32 s49, s49, 128
    s_add_u32 m0, s52, 0
    s_add_u32 s53, s50, 0
    buffer_load_dwordx4 v4, s[20:23], s53 offen lds
    s_add_u32 m0, s52, 1024
    s_add_u32 s53, s50, 49152
    buffer_load_dwordx4 v5, s[20:23], s53 offen lds
    s_add_u32 m0, s52, 8192
    s_add_u32 s53, s50, 2048
    buffer_load_dwordx4 v4, s[20:23], s53 offen lds
    s_add_u32 m0, s52, 9216
    s_add_u32 s53, s50, 51200
    buffer_load_dwordx4 v5, s[20:23], s53 offen lds
    s_add_u32 m0, s52, 16384
    s_add_u32 s53, s50, 4096
    buffer_load_dwordx4 v4, s[20:23], s53 offen lds
    s_add_u32 m0, s52, 17408
    s_add_u32 s53, s50, 53248
    buffer_load_dwordx4 v5, s[20:23], s53 offen lds
    s_add_u32 s50, s50, 393216
    s_waitcnt vmcnt(20)
    s_barrier
    s_add_u32 m0, s51, 16384
    s_add_u32 s53, s49, 0
    buffer_load_dwordx4 v2, s[16:19], s53 offen lds
    s_add_u32 m0, s51, 17408
    s_add_u32 s53, s49, 16384
    buffer_load_dwordx4 v3, s[16:19], s53 offen lds
    s_add_u32 m0, s51, 18432
    s_add_u32 s53, s49, 32768
    buffer_load_dwordx4 v2, s[16:19], s53 offen lds
    s_add_u32 m0, s51, 19456
    s_add_u32 s53, s49, 49152
    buffer_load_dwordx4 v3, s[16:19], s53 offen lds
    s_add_u32 s49, s49, 128
    s_add_u32 m0, s52, 24576
    s_add_u32 s53, s50, 0
    buffer_load_dwordx4 v4, s[20:23], s53 offen lds
    s_add_u32 m0, s52, 25600
    s_add_u32 s53, s50, 49152
    buffer_load_dwordx4 v5, s[20:23], s53 offen lds
    s_add_u32 m0, s52, 32768
    s_add_u32 s53, s50, 2048
    buffer_load_dwordx4 v4, s[20:23], s53 offen lds
    s_add_u32 m0, s52, 33792
    s_add_u32 s53, s50, 51200
    buffer_load_dwordx4 v5, s[20:23], s53 offen lds
    s_add_u32 m0, s52, 40960
    s_add_u32 s53, s50, 4096
    buffer_load_dwordx4 v4, s[20:23], s53 offen lds
    s_add_u32 m0, s52, 41984
    s_add_u32 s53, s50, 53248
    buffer_load_dwordx4 v5, s[20:23], s53 offen lds
    s_add_u32 s50, s50, 393216
    s_waitcnt vmcnt(20)
    s_barrier
    s_add_u32 m0, s51, 32768
    s_add_u32 s53, s49, 0
    buffer_load_dwordx4 v2, s[16:19], s53 offen lds
    s_add_u32 m0, s51, 33792
    s_add_u32 s53, s49, 16384
    buffer_load_dwordx4 v3, s[16:19], s53 offen lds
    s_add_u32 m0, s51, 34816
    s_add_u32 s53, s49, 32768
    buffer_load_dwordx4 v2, s[16:19], s53 offen lds
    s_add_u32 m0, s51, 35840
    s_add_u32 s53, s49, 49152
    buffer_load_dwordx4 v3, s[16:19], s53 offen lds
    s_add_u32 s49, s49, 128
    s_add_u32 m0, s52, 49152
    s_add_u32 s53, s50, 0
    buffer_load_dwordx4 v4, s[20:23], s53 offen lds
    s_add_u32 m0, s52, 50176
    s_add_u32 s53, s50, 49152
    buffer_load_dwordx4 v5, s[20:23], s53 offen lds
    s_add_u32 m0, s52, 57344
    s_add_u32 s53, s50, 2048
    buffer_load_dwordx4 v4, s[20:23], s53 offen lds
    s_add_u32 m0, s52, 58368
    s_add_u32 s53, s50, 51200
    buffer_load_dwordx4 v5, s[20:23], s53 offen lds
    s_add_u32 m0, s52, 65536
    s_add_u32 s53, s50, 4096
    buffer_load_dwordx4 v4, s[20:23], s53 offen lds
    s_add_u32 m0, s52, 66560
    s_add_u32 s53, s50, 53248
    buffer_load_dwordx4 v5, s[20:23], s53 offen lds
    s_add_u32 s50, s50, 393216
    s_waitcnt vmcnt(20)
    s_barrier
    s_add_u32 m0, s51, 49152
    s_add_u32 s53, s49, 0
    buffer_load_dwordx4 v2, s[16:19], s53 offen lds
    s_add_u32 m0, s51, 50176
    s_add_u32 s53, s49, 16384
    buffer_load_dwordx4 v3, s[16:19], s53 offen lds
    s_add_u32 m0, s51, 51200
    s_add_u32 s53, s49, 32768
    buffer_load_dwordx4 v2, s[16:19], s53 offen lds
    s_add_u32 m0, s51, 52224
    s_add_u32 s53, s49, 49152
    buffer_load_dwordx4 v3, s[16:19], s53 offen lds
    s_add_u32 s49, s49, 128
    s_add_u32 m0, s52, 73728
    s_add_u32 s53, s50, 0
    buffer_load_dwordx4 v4, s[20:23], s53 offen lds
    s_add_u32 m0, s52, 74752
    s_add_u32 s53, s50, 49152
    buffer_load_dwordx4 v5, s[20:23], s53 offen lds
    s_add_u32 m0, s52, 81920
    s_add_u32 s53, s50, 2048
    buffer_load_dwordx4 v4, s[20:23], s53 offen lds
    s_add_u32 m0, s52, 82944
    s_add_u32 s53, s50, 51200
    buffer_load_dwordx4 v5, s[20:23], s53 offen lds
    s_add_u32 m0, s52, 90112
    s_add_u32 s53, s50, 4096
    buffer_load_dwordx4 v4, s[20:23], s53 offen lds
    s_add_u32 m0, s52, 91136
    s_add_u32 s53, s50, 53248
    buffer_load_dwordx4 v5, s[20:23], s53 offen lds
    s_add_u32 s50, s50, 393216
    s_waitcnt vmcnt(20)
    s_barrier
    s_add_u32 m0, s51, 0
    s_add_u32 s53, s49, 0
    buffer_load_dwordx4 v2, s[16:19], s53 offen lds
    s_add_u32 m0, s51, 1024
    s_add_u32 s53, s49, 16384
    buffer_load_dwordx4 v3, s[16:19], s53 offen lds
    s_add_u32 m0, s51, 2048
    s_add_u32 s53, s49, 32768
    buffer_load_dwordx4 v2, s[16:19], s53 offen lds
    s_add_u32 m0, s51, 3072
    s_add_u32 s53, s49, 49152
    buffer_load_dwordx4 v3, s[16:19], s53 offen lds
    s_add_u32 s49, s49, 128
    s_add_u32 m0, s52, 0
    s_add_u32 s53, s50, 0
    buffer_load_dwordx4 v4, s[20:23], s53 offen lds
    s_add_u32 m0, s52, 1024
    s_add_u32 s53, s50, 49152
    buffer_load_dwordx4 v5, s[20:23], s53 offen lds
    s_add_u32 m0, s52, 8192
    s_add_u32 s53, s50, 2048
    buffer_load_dwordx4 v4, s[20:23], s53 offen lds
    s_add_u32 m0, s52, 9216
    s_add_u32 s53, s50, 51200
    buffer_load_dwordx4 v5, s[20:23], s53 offen lds
    s_add_u32 m0, s52, 16384
    s_add_u32 s53, s50, 4096
    buffer_load_dwordx4 v4, s[20:23], s53 offen lds
    s_add_u32 m0, s52, 17408
    s_add_u32 s53, s50, 53248
    buffer_load_dwordx4 v5, s[20:23], s53 offen lds
    s_add_u32 s50, s50, 393216
    s_waitcnt vmcnt(20)
    s_barrier
    s_add_u32 m0, s51, 16384
    s_add_u32 s53, s49, 0
    buffer_load_dwordx4 v2, s[16:19], s53 offen lds
    s_add_u32 m0, s51, 17408
    s_add_u32 s53, s49, 16384
    buffer_load_dwordx4 v3, s[16:19], s53 offen lds
    s_add_u32 m0, s51, 18432
    s_add_u32 s53, s49, 32768
    buffer_load_dwordx4 v2, s[16:19], s53 offen lds
    s_add_u32 m0, s51, 19456
    s_add_u32 s53, s49, 49152
    buffer_load_dwordx4 v3, s[16:19], s53 offen lds
    s_add_u32 s49, s49, 128
    s_add_u32 m0, s52, 24576
    s_add_u32 s53, s50, 0
    buffer_load_dwordx4 v4, s[20:23], s53 offen lds
    s_add_u32 m0, s52, 25600
    s_add_u32 s53, s50, 49152
    buffer_load_dwordx4 v5, s[20:23], s53 offen lds
    s_add_u32 m0, s52, 32768
    s_add_u32 s53, s50, 2048
    buffer_load_dwordx4 v4, s[20:23], s53 offen lds
    s_add_u32 m0, s52, 33792
    s_add_u32 s53, s50, 51200
    buffer_load_dwordx4 v5, s[20:23], s53 offen lds
    s_add_u32 m0, s52, 40960
    s_add_u32 s53, s50, 4096
    buffer_load_dwordx4 v4, s[20:23], s53 offen lds
    s_add_u32 m0, s52, 41984
    s_add_u32 s53, s50, 53248
    buffer_load_dwordx4 v5, s[20:23], s53 offen lds
    s_add_u32 s50, s50, 393216
    s_waitcnt vmcnt(20)
    s_barrier
    s_add_u32 m0, s51, 32768
    s_add_u32 s53, s49, 0
    buffer_load_dwordx4 v2, s[16:19], s53 offen lds
    s_add_u32 m0, s51, 33792
    s_add_u32 s53, s49, 16384
    buffer_load_dwordx4 v3, s[16:19], s53 offen lds
    s_add_u32 m0, s51, 34816
    s_add_u32 s53, s49, 32768
    buffer_load_dwordx4 v2, s[16:19], s53 offen lds
    s_add_u32 m0, s51, 35840
    s_add_u32 s53, s49, 49152
    buffer_load_dwordx4 v3, s[16:19], s53 offen lds
    s_add_u32 s49, s49, 128
    s_add_u32 m0, s52, 49152
    s_add_u32 s53, s50, 0
    buffer_load_dwordx4 v4, s[20:23], s53 offen lds
    s_add_u32 m0, s52, 50176
    s_add_u32 s53, s50, 49152
    buffer_load_dwordx4 v5, s[20:23], s53 offen lds
    s_add_u32 m0, s52, 57344
    s_add_u32 s53, s50, 2048
    buffer_load_dwordx4 v4, s[20:23], s53 offen lds
    s_add_u32 m0, s52, 58368
    s_add_u32 s53, s50, 51200
    buffer_load_dwordx4 v5, s[20:23], s53 offen lds
    s_add_u32 m0, s52, 65536
    s_add_u32 s53, s50, 4096
    buffer_load_dwordx4 v4, s[20:23], s53 offen lds
    s_add_u32 m0, s52, 66560
    s_add_u32 s53, s50, 53248
    buffer_load_dwordx4 v5, s[20:23], s53 offen lds
    s_add_u32 s50, s50, 393216
    s_waitcnt vmcnt(20)
    s_barrier
    s_add_u32 m0, s51, 49152
    s_add_u32 s53, s49, 0
    buffer_load_dwordx4 v2, s[16:19], s53 offen lds
    s_add_u32 m0, s51, 50176
    s_add_u32 s53, s49, 16384
    buffer_load_dwordx4 v3, s[16:19], s53 offen lds
    s_add_u32 m0, s51, 51200
    s_add_u32 s53, s49, 32768
    buffer_load_dwordx4 v2, s[16:19], s53 offen lds
    s_add_u32 m0, s51, 52224
    s_add_u32 s53, s49, 49152
    buffer_load_dwordx4 v3, s[16:19], s53 offen lds
    s_add_u32 s49, s49, 128
    s_add_u32 m0, s52, 73728
    s_add_u32 s53, s50, 0
    buffer_load_dwordx4 v4, s[20:23], s53 offen lds
    s_add_u32 m0, s52, 74752
    s_add_u32 s53, s50, 49152
    buffer_load_dwordx4 v5, s[20:23], s53 offen lds
    s_add_u32 m0, s52, 81920
    s_add_u32 s53, s50, 2048
    buffer_load_dwordx4 v4, s[20:23], s53 offen lds
    s_add_u32 m0, s52, 82944
    s_add_u32 s53, s50, 51200
    buffer_load_dwordx4 v5, s[20:23], s53 offen lds
    s_add_u32 m0, s52, 90112
    s_add_u32 s53, s50, 4096
    buffer_load_dwordx4 v4, s[20:23], s53 offen lds
    s_add_u32 m0, s52, 91136
    s_add_u32 s53, s50, 53248
    buffer_load_dwordx4 v5, s[20:23], s53 offen lds
    s_add_u32 s50, s50, 393216
    s_waitcnt vmcnt(20)
    s_barrier
    s_waitcnt vmcnt(10)
    s_barrier
    s_waitcnt vmcnt(0)
    s_barrier
    s_cmp_lg_u32 s3, 4
    s_cbranch_scc1 L_w_149
    v_and_b32 v12, 7, v1
    v_lshlrev_b32 v12, 5, v12
    s_mov_b32 s45, 0x100000
L_ip_150:
    buffer_load_dword v13, v12, s[36:39], 0 offen sc1
    s_sub_u32 s45, s45, 1
    s_cmp_eq_u32 s45, 0
    s_cbranch_scc1 L_ipd_151
    s_waitcnt vmcnt(0)
    v_cmp_gt_u32 vcc, 32, v13
    s_cbranch_vccnz L_ip_150
L_ipd_151:
    v_lshlrev_b32 v12, 4, v1
    s_lshl_b32 s45, s42, 10
    s_add_u32 s45, s45, 360448
    buffer_load_dwordx4 v[24:27], v12, s[28:31], s45 offen
    s_mul_i32 s45, s43, 768
    s_add_u32 s45, s45, 393216
    s_mov_b64 s[46:47], exec
    s_mov_b32 exec_lo, 0xffffffff
    s_mov_b32 exec_hi, 0xffff
    buffer_load_dwordx4 v[40:43], v12, s[28:31], s45 offen
    s_add_u32 s45, s45, 12288
    buffer_load_dwordx4 v[44:47], v12, s[28:31], s45 offen
    s_add_u32 s45, s45, 12288
    buffer_load_dwordx4 v[48:51], v12, s[28:31], s45 offen
    s_add_u32 s45, s45, 12288
    buffer_load_dwordx4 v[52:55], v12, s[28:31], s45 offen
    s_add_u32 s45, s45, 12288
    buffer_load_dwordx4 v[56:59], v12, s[28:31], s45 offen
    s_add_u32 s45, s45, 12288
    buffer_load_dwordx4 v[60:63], v12, s[28:31], s45 offen
    s_add_u32 s45, s45, 12288
    buffer_load_dwordx4 v[64:67], v12, s[28:31], s45 offen
    s_add_u32 s45, s45, 12288
    buffer_load_dwordx4 v[68:71], v12, s[28:31], s45 offen
    s_add_u32 s45, s45, 12288
    buffer_load_dwordx4 v[72:75], v12, s[28:31], s45 offen
    s_add_u32 s45, s45, 12288
    buffer_load_dwordx4 v[76:79], v12, s[28:31], s45 offen
    s_add_u32 s45, s45, 12288
    buffer_load_dwordx4 v[80:83], v12, s[28:31], s45 offen
    s_add_u32 s45, s45, 12288
    buffer_load_dwordx4 v[84:87], v12, s[28:31], s45 offen
    s_add_u32 s45, s45, 12288
    buffer_load_dwordx4 v[88:91], v12, s[28:31], s45 offen
    s_add_u32 s45, s45, 12288
    buffer_load_dwordx4 v[92:95], v12, s[28:31], s45 offen
    s_add_u32 s45, s45, 12288
    buffer_load_dwordx4 v[96:99], v12, s[28:31], s45 offen
    s_add_u32 s45, s45, 12288
    buffer_load_dwordx4 v[100:103], v12, s[28:31], s45 offen
    s_mov_b64 exec, s[46:47]
    s_waitcnt vmcnt(0)
    v_mov_b32 v28, v25
    v_mov_b32 v25, v26
    v_mov_b32 v26, v28
    v_lshlrev_b32 v13, 3, v1
    ds_write_b64 v13, v[24:25] offset:0
    ds_write_b64 v13, v[26:27] offset:512
    s_waitcnt vmcnt(0)
    s_mov_b64 s[46:47], exec
    s_mov_b32 exec_lo, 0xffffffff
    s_mov_b32 exec_hi, 0xffff
    v_add_f32 v40, v40, v72
    v_add_f32 v41, v41, v73
    v_add_f32 v42, v42, v74
    v_add_f32 v43, v43, v75
    v_add_f32 v44, v44, v76
    v_add_f32 v45, v45, v77
    v_add_f32 v46, v46, v78
    v_add_f32 v47, v47, v79
    v_add_f32 v48, v48, v80
    v_add_f32 v49, v49, v81
    v_add_f32 v50, v50, v82
    v_add_f32 v51, v51, v83
    v_add_f32 v52, v52, v84
    v_add_f32 v53, v53, v85
    v_add_f32 v54, v54, v86
    v_add_f32 v55, v55, v87
    v_add_f32 v56, v56, v88
    v_add_f32 v57, v57, v89
    v_add_f32 v58, v58, v90
    v_add_f32 v59, v59, v91
    v_add_f32 v60, v60, v92
    v_add_f32 v61, v61, v93
    v_add_f32 v62, v62, v94
    v_add_f32 v63, v63, v95
    v_add_f32 v64, v64, v96
    v_add_f32 v65, v65, v97
    v_add_f32 v66, v66, v98
    v_add_f32 v67, v67, v99
    v_add_f32 v68, v68, v100
    v_add_f32 v69, v69, v101
    v_add_f32 v70, v70, v102
    v_add_f32 v71, v71, v103
    v_add_f32 v40, v40, v56
    v_add_f32 v41, v41, v57
    v_add_f32 v42, v42, v58
    v_add_f32 v43, v43, v59
    v_add_f32 v44, v44, v60
    v_add_f32 v45, v45, v61
    v_add_f32 v46, v46, v62
    v_add_f32 v47, v47, v63
    v_add_f32 v48, v48, v64
    v_add_f32 v49, v49, v65
    v_add_f32 v50, v50, v66
    v_add_f32 v51, v51, v67
    v_add_f32 v52, v52, v68
    v_add_f32 v53, v53, v69
    v_add_f32 v54, v54, v70
    v_add_f32 v55, v55, v71
    v_add_f32 v40, v40, v48
    v_add_f32 v41, v41, v49
    v_add_f32 v42, v42, v50
    v_add_f32 v43, v43, v51
    v_add_f32 v44, v44, v52
    v_add_f32 v45, v45, v53
    v_add_f32 v46, v46, v54
    v_add_f32 v47, v47, v55
    v_add_f32 v40, v40, v44
    v_add_f32 v41, v41, v45
    v_add_f32 v42, v42, v46
    v_add_f32 v43, v43, v47
    ds_write_b128 v12, v[40:43] offset:1024
    s_mov_b64 exec, s[46:47]
    s_waitcnt lgkmcnt(0)
L_w_149:
    s_barrier
    s_sub_u32 s50, s3, 4
    s_lshr_b32 s48, s50, 1
    s_and_b32 s49, s50, 1
    v_lshlrev_b32 v14, 4, v1
    s_lshl_b32 s51, s50, 13
    s_add_u32 s51, s51, 65536
    v_add_u32 v9, s51, v14
    ds_read_b128 v[16:19], v9 offset:0
    ds_read_b128 v[20:23], v9 offset:1024
    ds_read_b128 v[24:27], v9 offset:2048
    ds_read_b128 v[28:31], v9 offset:3072
    ds_read_b128 v[32:35], v9 offset:4096
    ds_read_b128 v[36:39], v9 offset:5120
    ds_read_b128 v[40:43], v9 offset:6144
    ds_read_b128 v[44:47], v9 offset:7168
    v_and_b32 v5, 15, v1
    v_lshrrev_b32 v6, 4, v1
    s_mul_i32 s51, s49, 384
    v_lshlrev_b32 v7, 4, v6
    v_add_u32 v7, s51, v7
    ds_read_b128 v[112:115], v7 offset:1024
    ds_read_b128 v[116:119], v7 offset:1088
    v_lshlrev_b32 v8, 2, v5
    s_lshl_b32 s51, s48, 8
    v_add_u32 v8, s51, v8
    ds_read_b32 v124, v8 offset:0
    ds_read_b32 v125, v8 offset:512
    ds_read_b32 v126, v8 offset:64
    ds_read_b32 v127, v8 offset:576
    ds_read_b32 v128, v8 offset:128
    s_waitcnt lgkmcnt(14)
    ds_read_b32 v129, v8 offset:640
    s_waitcnt lgkmcnt(14)
    ds_read_b32 v130, v8 offset:192
    s_waitcnt lgkmcnt(14)
    ds_read_b32 v131, v8 offset:704
    s_mov_b32 s68, 1069066811
    s_mov_b32 s69, 1069066811
    v_mov_b32 v10, 0x358637bd
    v_mov_b32 v11, 0x358637bd
    s_lshl_b32 s52, s43, 1
    s_add_u32 s52, s52, s49
    s_lshl_b32 s50, s42, 1
    s_add_u32 s50, s50, s48
    s_lshl_b32 s50, s50, 5
    s_add_u32 s50, s50, s52
    s_lshl_b32 s50, s50, 12
    s_mul_i32 s53, s40, 4194304
    s_add_u32 s53, s53, 1048576
    s_add_u32 s50, s50, s53
    s_waitcnt lgkmcnt(0)
    v_mov_b32 v132, v124
    v_mov_b32 v133, v124
    v_mov_b32 v134, v125
    v_mov_b32 v135, v125
    v_mov_b32 v136, v126
    v_mov_b32 v137, v126
    v_mov_b32 v138, v127
    v_mov_b32 v139, v127
    v_mov_b32 v140, v128
    v_mov_b32 v141, v128
    v_mov_b32 v142, v129
    v_mov_b32 v143, v129
    v_mov_b32 v144, v130
    v_mov_b32 v145, v130
    v_mov_b32 v146, v131
    v_mov_b32 v147, v131
    v_pk_fma_f32 v[16:17], v[132:133], v[112:113], v[16:17] neg_lo:[1,0,0] neg_hi:[1,0,0]
    v_pk_fma_f32 v[18:19], v[132:133], v[114:115], v[18:19] neg_lo:[1,0,0] neg_hi:[1,0,0]
    v_pk_fma_f32 v[32:33], v[132:133], v[116:117], v[32:33] neg_lo:[1,0,0] neg_hi:[1,0,0]
    v_pk_fma_f32 v[34:35], v[132:133], v[118:119], v[34:35] neg_lo:[1,0,0] neg_hi:[1,0,0]
    v_pk_fma_f32 v[20:21], v[136:137], v[112:113], v[20:21] neg_lo:[1,0,0] neg_hi:[1,0,0]
    v_pk_fma_f32 v[22:23], v[136:137], v[114:115], v[22:23] neg_lo:[1,0,0] neg_hi:[1,0,0]
    v_pk_fma_f32 v[36:37], v[136:137], v[116:117], v[36:37] neg_lo:[1,0,0] neg_hi:[1,0,0]
    v_pk_fma_f32 v[38:39], v[136:137], v[118:119], v[38:39] neg_lo:[1,0,0] neg_hi:[1,0,0]
    v_pk_fma_f32 v[24:25], v[140:141], v[112:113], v[24:25] neg_lo:[1,0,0] neg_hi:[1,0,0]
    v_pk_fma_f32 v[26:27], v[140:141], v[114:115], v[26:27] neg_lo:[1,0,0] neg_hi:[1,0,0]
    v_pk_fma_f32 v[40:41], v[140:141], v[116:117], v[40:41] neg_lo:[1,0,0] neg_hi:[1,0,0]
    v_pk_fma_f32 v[42:43], v[140:141], v[118:119], v[42:43] neg_lo:[1,0,0] neg_hi:[1,0,0]
    v_pk_fma_f32 v[28:29], v[144:145], v[112:113], v[28:29] neg_lo:[1,0,0] neg_hi:[1,0,0]
    v_pk_fma_f32 v[30:31], v[144:145], v[114:115], v[30:31] neg_lo:[1,0,0] neg_hi:[1,0,0]
    v_pk_fma_f32 v[44:45], v[144:145], v[116:117], v[44:45] neg_lo:[1,0,0] neg_hi:[1,0,0]
    v_pk_fma_f32 v[46:47], v[144:145], v[118:119], v[46:47] neg_lo:[1,0,0] neg_hi:[1,0,0]
    v_pk_mul_f32 v[16:17], v[16:17], v[134:135]
    v_pk_mul_f32 v[18:19], v[18:19], v[134:135]
    v_pk_mul_f32 v[32:33], v[32:33], v[134:135]
    v_pk_mul_f32 v[34:35], v[34:35], v[134:135]
    v_pk_mul_f32 v[20:21], v[20:21], v[138:139]
    v_pk_mul_f32 v[22:23], v[22:23], v[138:139]
    v_pk_mul_f32 v[36:37], v[36:37], v[138:139]
    v_pk_mul_f32 v[38:39], v[38:39], v[138:139]
    v_pk_mul_f32 v[24:25], v[24:25], v[142:143]
    v_pk_mul_f32 v[26:27], v[26:27], v[142:143]
    v_pk_mul_f32 v[40:41], v[40:41], v[142:143]
    v_pk_mul_f32 v[42:43], v[42:43], v[142:143]
    v_pk_mul_f32 v[28:29], v[28:29], v[146:147]
    v_pk_mul_f32 v[30:31], v[30:31], v[146:147]
    v_pk_mul_f32 v[44:45], v[44:45], v[146:147]
    v_pk_mul_f32 v[46:47], v[46:47], v[146:147]
    v_pk_mul_f32 v[12:13], v[16:17], s[68:69]
    v_pk_add_f32 v[16:17], v[16:17], v[10:11]
    v_exp_f32 v12, v12 clamp
    v_exp_f32 v13, v13 clamp
    v_max_f32 v16, v16, v11
    v_max_f32 v17, v17, v11
    v_pk_add_f32 v[16:17], v[16:17], v[12:13]
    v_cvt_pk_bf16_f32 v64, v16, v17
    v_pk_mul_f32 v[2:3], v[18:19], s[68:69]
    v_pk_add_f32 v[18:19], v[18:19], v[10:11]
    v_exp_f32 v2, v2 clamp
    v_exp_f32 v3, v3 clamp
    v_max_f32 v18, v18, v11
    v_max_f32 v19, v19, v11
    v_pk_add_f32 v[18:19], v[18:19], v[2:3]
    v_cvt_pk_bf16_f32 v65, v18, v19
    v_pk_mul_f32 v[12:13], v[32:33], s[68:69]
    v_pk_add_f32 v[32:33], v[32:33], v[10:11]
    v_exp_f32 v12, v12 clamp
    v_exp_f32 v13, v13 clamp
    v_max_f32 v32, v32, v11
    v_max_f32 v33, v33, v11
    v_pk_add_f32 v[32:33], v[32:33], v[12:13]
    v_cvt_pk_bf16_f32 v66, v32, v33
    v_pk_mul_f32 v[2:3], v[34:35], s[68:69]
    v_pk_add_f32 v[34:35], v[34:35], v[10:11]
    v_exp_f32 v2, v2 clamp
    v_exp_f32 v3, v3 clamp
    v_max_f32 v34, v34, v11
    v_max_f32 v35, v35, v11
    v_pk_add_f32 v[34:35], v[34:35], v[2:3]
    v_cvt_pk_bf16_f32 v67, v34, v35
    buffer_store_dwordx4 v[64:67], v14, s[28:31], s50 offen offset:0 sc1
    v_pk_mul_f32 v[12:13], v[20:21], s[68:69]
    v_pk_add_f32 v[20:21], v[20:21], v[10:11]
    v_exp_f32 v12, v12 clamp
    v_exp_f32 v13, v13 clamp
    v_max_f32 v20, v20, v11
    v_max_f32 v21, v21, v11
    v_pk_add_f32 v[20:21], v[20:21], v[12:13]
    v_cvt_pk_bf16_f32 v68, v20, v21
    v_pk_mul_f32 v[2:3], v[22:23], s[68:69]
    v_pk_add_f32 v[22:23], v[22:23], v[10:11]
    v_exp_f32 v2, v2 clamp
    v_exp_f32 v3, v3 clamp
    v_max_f32 v22, v22, v11
    v_max_f32 v23, v23, v11
    v_pk_add_f32 v[22:23], v[22:23], v[2:3]
    v_cvt_pk_bf16_f32 v69, v22, v23
    v_pk_mul_f32 v[12:13], v[36:37], s[68:69]
    v_pk_add_f32 v[36:37], v[36:37], v[10:11]
    v_exp_f32 v12, v12 clamp
    v_exp_f32 v13, v13 clamp
    v_max_f32 v36, v36, v11
    v_max_f32 v37, v37, v11
    v_pk_add_f32 v[36:37], v[36:37], v[12:13]
    v_cvt_pk_bf16_f32 v70, v36, v37
    v_pk_mul_f32 v[2:3], v[38:39], s[68:69]
    v_pk_add_f32 v[38:39], v[38:39], v[10:11]
    v_exp_f32 v2, v2 clamp
    v_exp_f32 v3, v3 clamp
    v_max_f32 v38, v38, v11
    v_max_f32 v39, v39, v11
    v_pk_add_f32 v[38:39], v[38:39], v[2:3]
    v_cvt_pk_bf16_f32 v71, v38, v39
    buffer_store_dwordx4 v[68:71], v14, s[28:31], s50 offen offset:1024 sc1
    v_pk_mul_f32 v[12:13], v[24:25], s[68:69]
    v_pk_add_f32 v[24:25], v[24:25], v[10:11]
    v_exp_f32 v12, v12 clamp
    v_exp_f32 v13, v13 clamp
    v_max_f32 v24, v24, v11
    v_max_f32 v25, v25, v11
    v_pk_add_f32 v[24:25], v[24:25], v[12:13]
    v_cvt_pk_bf16_f32 v72, v24, v25
    v_pk_mul_f32 v[2:3], v[26:27], s[68:69]
    v_pk_add_f32 v[26:27], v[26:27], v[10:11]
    v_exp_f32 v2, v2 clamp
    v_exp_f32 v3, v3 clamp
    v_max_f32 v26, v26, v11
    v_max_f32 v27, v27, v11
    v_pk_add_f32 v[26:27], v[26:27], v[2:3]
    v_cvt_pk_bf16_f32 v73, v26, v27
    v_pk_mul_f32 v[12:13], v[40:41], s[68:69]
    v_pk_add_f32 v[40:41], v[40:41], v[10:11]
    v_exp_f32 v12, v12 clamp
    v_exp_f32 v13, v13 clamp
    v_max_f32 v40, v40, v11
    v_max_f32 v41, v41, v11
    v_pk_add_f32 v[40:41], v[40:41], v[12:13]
    v_cvt_pk_bf16_f32 v74, v40, v41
    v_pk_mul_f32 v[2:3], v[42:43], s[68:69]
    v_pk_add_f32 v[42:43], v[42:43], v[10:11]
    v_exp_f32 v2, v2 clamp
    v_exp_f32 v3, v3 clamp
    v_max_f32 v42, v42, v11
    v_max_f32 v43, v43, v11
    v_pk_add_f32 v[42:43], v[42:43], v[2:3]
    v_cvt_pk_bf16_f32 v75, v42, v43
    buffer_store_dwordx4 v[72:75], v14, s[28:31], s50 offen offset:2048 sc1
    s_barrier
    v_pk_mul_f32 v[12:13], v[28:29], s[68:69]
    v_pk_add_f32 v[28:29], v[28:29], v[10:11]
    v_exp_f32 v12, v12 clamp
    v_exp_f32 v13, v13 clamp
    v_max_f32 v28, v28, v11
    v_max_f32 v29, v29, v11
    v_pk_add_f32 v[28:29], v[28:29], v[12:13]
    v_cvt_pk_bf16_f32 v76, v28, v29
    v_pk_mul_f32 v[2:3], v[30:31], s[68:69]
    v_pk_add_f32 v[30:31], v[30:31], v[10:11]
    v_exp_f32 v2, v2 clamp
    v_exp_f32 v3, v3 clamp
    v_max_f32 v30, v30, v11
    v_max_f32 v31, v31, v11
    v_pk_add_f32 v[30:31], v[30:31], v[2:3]
    v_cvt_pk_bf16_f32 v77, v30, v31
    v_pk_mul_f32 v[12:13], v[44:45], s[68:69]
    v_pk_add_f32 v[44:45], v[44:45], v[10:11]
    v_exp_f32 v12, v12 clamp
    v_exp_f32 v13, v13 clamp
    v_max_f32 v44, v44, v11
    v_max_f32 v45, v45, v11
    v_pk_add_f32 v[44:45], v[44:45], v[12:13]
    v_cvt_pk_bf16_f32 v78, v44, v45
    v_pk_mul_f32 v[2:3], v[46:47], s[68:69]
    v_pk_add_f32 v[46:47], v[46:47], v[10:11]
    v_exp_f32 v2, v2 clamp
    v_exp_f32 v3, v3 clamp
    v_max_f32 v46, v46, v11
    v_max_f32 v47, v47, v11
    v_pk_add_f32 v[46:47], v[46:47], v[2:3]
    v_cvt_pk_bf16_f32 v79, v46, v47
    buffer_store_dwordx4 v[76:79], v14, s[28:31], s50 offen offset:3072 sc1
L_r_done_2:
L_after_k1:
    s_add_u32 s41, s41, 16
    s_cmp_lg_u32 s3, 0
    s_waitcnt vmcnt(0) lgkmcnt(0)
    s_barrier
    s_cbranch_scc1 L_arr_152
    s_mov_b32 exec_lo, 0xff
    s_mov_b32 exec_hi, 0
    buffer_atomic_add v252, v250, s[28:31], s74 offen sc1
    s_mov_b64 exec, -1
L_arr_152:
    s_and_b32 s44, s2, 7
    s_lshr_b32 s45, s2, 3
    s_and_b32 s46, s44, 3
    s_lshl_b32 s46, s46, 3
    s_and_b32 s47, s45, 7
    s_add_u32 s42, s46, s47
    s_lshr_b32 s46, s44, 2
    s_lshl_b32 s46, s46, 2
    s_lshr_b32 s47, s45, 3
    s_add_u32 s43, s46, s47
    s_mul_i32 s76, s40, 4096
    s_add_u32 s76, s76, 163840
    v_add_u32 v8, 0, v0
    v_lshrrev_b32 v2, 4, v8
    v_bfe_u32 v3, v8, 2, 2
    v_and_b32 v4, 3, v8
    v_lshlrev_b32 v5, 7, v2
    v_lshl_add_u32 v5, v3, 4, v5
    v_and_b32 v6, 1, v4
    v_lshl_add_u32 v5, v6, 3, v5
    v_lshrrev_b32 v6, 1, v4
    v_lshl_add_u32 v248, v6, 6, v5
    v_add_u32 v8, 256, v0
    v_lshrrev_b32 v2, 4, v8
    v_bfe_u32 v3, v8, 2, 2
    v_and_b32 v4, 3, v8
    v_lshlrev_b32 v5, 7, v2
    v_lshl_add_u32 v5, v3, 4, v5
    v_and_b32 v6, 1, v4
    v_lshl_add_u32 v5, v6, 3, v5
    v_lshrrev_b32 v6, 1, v4
    v_lshl_add_u32 v249, v6, 6, v5
    v_lshlrev_b32 v247, 2, v0
    v_add_u32 v247, 143360, v247
    s_cmp_ge_u32 s3, 4
    s_cbranch_scc1 L_k2pl_153
    s_and_b32 s48, s3, 1
    s_lshr_b32 s49, s3, 1
    v_and_b32 v8, 15, v1
    v_lshrrev_b32 v9, 4, v1
    s_lshl_b32 s50, s42, 6
    s_lshl_b32 s54, s48, 5
    s_add_u32 s61, s50, s54
    v_add_u32 v10, s61, v8
    v_lshlrev_b32 v10, 11, v10
    v_lshl_add_u32 v10, v9, 3, v10
    s_lshl_b32 s50, s43, 7
    s_lshl_b32 s54, s49, 6
    s_add_u32 s50, s50, s54
    s_cmp_eq_u32 s40, 0
    s_cbranch_scc1 L_k2x0_155
    s_add_u32 s50, s50, 28311552
    s_add_u32 s54, s50, 0
    buffer_load_dwordx2 v[224:225], v10, s[28:31], s54 offen offset:0
    buffer_load_dwordx2 v[226:227], v10, s[28:31], s54 offen offset:1024
    buffer_load_dwordx2 v[228:229], v10, s[28:31], s54 offen offset:32
    buffer_load_dwordx2 v[230:231], v10, s[28:31], s54 offen offset:1056
    s_add_u32 s54, s50, 32768
    buffer_load_dwordx2 v[232:233], v10, s[28:31], s54 offen offset:0
    buffer_load_dwordx2 v[234:235], v10, s[28:31], s54 offen offset:1024
    buffer_load_dwordx2 v[236:237], v10, s[28:31], s54 offen offset:32
    buffer_load_dwordx2 v[238:239], v10, s[28:31], s54 offen offset:1056
    s_branch L_k2x1_156
L_k2x0_155:
    s_add_u32 s54, s50, 0
    buffer_load_dwordx2 v[224:225], v10, s[16:19], s54 offen offset:0
    buffer_load_dwordx2 v[226:227], v10, s[16:19], s54 offen offset:1024
    buffer_load_dwordx2 v[228:229], v10, s[16:19], s54 offen offset:32
    buffer_load_dwordx2 v[230:231], v10, s[16:19], s54 offen offset:1056
    s_add_u32 s54, s50, 32768
    buffer_load_dwordx2 v[232:233], v10, s[16:19], s54 offen offset:0
    buffer_load_dwordx2 v[234:235], v10, s[16:19], s54 offen offset:1024
    buffer_load_dwordx2 v[236:237], v10, s[16:19], s54 offen offset:32
    buffer_load_dwordx2 v[238:239], v10, s[16:19], s54 offen offset:1056
L_k2x1_156:
    v_lshlrev_b32 v13, 4, v1
    s_lshl_b32 s50, s49, 13
    v_add_u32 v240, s50, v13
    s_lshl_b32 s50, s49, 12
    s_lshl_b32 s54, s48, 11
    s_add_u32 s50, s50, s54
    s_add_u32 s50, s50, 16384
    v_add_u32 v241, s50, v13
    v_lshlrev_b32 v13, 2, v1
    s_lshl_b32 s50, s49, 11
    s_add_u32 s50, s50, 24576
    v_add_u32 v242, s50, v13
    v_lshlrev_b32 v13, 4, v9
    s_lshl_b32 s50, s49, 10
    s_add_u32 s50, s50, 143360
    v_add_u32 v243, s50, v13
    v_mov_b32 v16, 0
    v_mov_b32 v17, 0
    v_mov_b32 v18, 0
    v_mov_b32 v19, 0
    v_mov_b32 v20, 0
    v_mov_b32 v21, 0
    v_mov_b32 v22, 0
    v_mov_b32 v23, 0
    v_mov_b32 v24, 0
    v_mov_b32 v25, 0
    v_mov_b32 v26, 0
    v_mov_b32 v27, 0
    v_mov_b32 v28, 0
    v_mov_b32 v29, 0
    v_mov_b32 v30, 0
    v_mov_b32 v31, 0
    v_mov_b32 v32, 0
    v_mov_b32 v33, 0
    v_mov_b32 v34, 0
    v_mov_b32 v35, 0
    v_mov_b32 v36, 0
    v_mov_b32 v37, 0
    v_mov_b32 v38, 0
    v_mov_b32 v39, 0
    v_mov_b32 v40, 0
    v_mov_b32 v41, 0
    v_mov_b32 v42, 0
    v_mov_b32 v43, 0
    v_mov_b32 v44, 0
    v_mov_b32 v45, 0
    v_mov_b32 v46, 0
    v_mov_b32 v47, 0
    v_mov_b32 v48, 0
    v_mov_b32 v49, 0
    v_mov_b32 v50, 0
    v_mov_b32 v51, 0
    v_mov_b32 v52, 0
    v_mov_b32 v53, 0
    v_mov_b32 v54, 0
    v_mov_b32 v55, 0
    v_mov_b32 v56, 0
    v_mov_b32 v57, 0
    v_mov_b32 v58, 0
    v_mov_b32 v59, 0
    v_mov_b32 v60, 0
    v_mov_b32 v61, 0
    v_mov_b32 v62, 0
    v_mov_b32 v63, 0
    v_mov_b32 v64, 0
    v_mov_b32 v65, 0
    v_mov_b32 v66, 0
    v_mov_b32 v67, 0
    v_mov_b32 v68, 0
    v_mov_b32 v69, 0
    v_mov_b32 v70, 0
    v_mov_b32 v71, 0
    v_mov_b32 v72, 0
    v_mov_b32 v73, 0
    v_mov_b32 v74, 0
    v_mov_b32 v75, 0
    v_mov_b32 v76, 0
    v_mov_b32 v77, 0
    v_mov_b32 v78, 0
    v_mov_b32 v79, 0
    s_mov_b32 s52, 0
    v_mov_b32 v15, 0x358637bd
    s_branch L_k2pd_154
L_k2pl_153:
    s_sub_u32 s48, s3, 4
    s_lshr_b32 s54, s48, 1
    s_and_b32 s56, s48, 1
    v_lshlrev_b32 v10, 4, v1
    s_lshl_b32 s49, s43, 18
    s_lshl_b32 s53, s54, 17
    s_add_u32 s49, s49, s53
    s_lshl_b32 s53, s56, 12
    s_add_u32 s49, s49, s53
    s_add_u32 s49, s49, 47185920
    s_mul_i32 s50, s40, 4194304
    s_add_u32 s50, s50, 1048576
    s_lshl_b32 s53, s42, 17
    s_add_u32 s50, s50, s53
    s_lshl_b32 s53, s54, 16
    s_add_u32 s50, s50, s53
    s_lshl_b32 s53, s56, 11
    s_add_u32 s50, s50, s53
    s_mul_i32 s51, s40, 65536
    s_add_u32 s51, s51, 32768
    s_lshl_b32 s53, s54, 15
    s_add_u32 s51, s51, s53
    s_lshl_b32 s53, s56, 10
    s_add_u32 s51, s51, s53
    s_lshl_b32 s57, s54, 13
    s_lshl_b32 s53, s56, 12
    s_add_u32 s57, s57, s53
    s_lshl_b32 s58, s54, 12
    s_lshl_b32 s53, s56, 11
    s_add_u32 s58, s58, s53
    s_add_u32 s58, s58, 16384
    s_lshl_b32 s59, s54, 11
    s_lshl_b32 s53, s56, 10
    s_add_u32 s59, s59, s53
    s_add_u32 s59, s59, 24576
    s_mov_b32 s52, 0
    s_mov_b32 s61, 0
    s_add_u32 m0, s52, s57
    s_add_u32 s52, s52, 28672
    s_cmp_eq_u32 s52, 143360
    s_cselect_b32 s52, 0, s52
    buffer_load_dwordx4 v10, s[28:31], s49 offen offset:0 lds
    buffer_load_dwordx4 v10, s[28:31], s49 offen offset:1024 lds
    buffer_load_dwordx4 v10, s[28:31], s49 offen offset:2048 lds
    buffer_load_dwordx4 v10, s[28:31], s49 offen offset:3072 lds
    s_add_u32 s49, s49, 8192
    s_add_u32 m0, s52, s57
    s_add_u32 s52, s52, 28672
    s_cmp_eq_u32 s52, 143360
    s_cselect_b32 s52, 0, s52
    buffer_load_dwordx4 v10, s[28:31], s49 offen offset:0 lds
    buffer_load_dwordx4 v10, s[28:31], s49 offen offset:1024 lds
    buffer_load_dwordx4 v10, s[28:31], s49 offen offset:2048 lds
    buffer_load_dwordx4 v10, s[28:31], s49 offen offset:3072 lds
    s_add_u32 s49, s49, 8192
    s_add_u32 m0, s52, s57
    s_add_u32 s52, s52, 28672
    s_cmp_eq_u32 s52, 143360
    s_cselect_b32 s52, 0, s52
    buffer_load_dwordx4 v10, s[28:31], s49 offen offset:0 lds
    buffer_load_dwordx4 v10, s[28:31], s49 offen offset:1024 lds
    buffer_load_dwordx4 v10, s[28:31], s49 offen offset:2048 lds
    buffer_load_dwordx4 v10, s[28:31], s49 offen offset:3072 lds
    s_add_u32 s49, s49, 8192
    s_add_u32 m0, s52, s57
    s_add_u32 s52, s52, 28672
    s_cmp_eq_u32 s52, 143360
    s_cselect_b32 s52, 0, s52
    buffer_load_dwordx4 v10, s[28:31], s49 offen offset:0 lds
    buffer_load_dwordx4 v10, s[28:31], s49 offen offset:1024 lds
    buffer_load_dwordx4 v10, s[28:31], s49 offen offset:2048 lds
    buffer_load_dwordx4 v10, s[28:31], s49 offen offset:3072 lds
    s_add_u32 s49, s49, 8192
    s_add_u32 m0, s52, s57
    s_add_u32 s52, s52, 28672
    s_cmp_eq_u32 s52, 143360
    s_cselect_b32 s52, 0, s52
    buffer_load_dwordx4 v10, s[28:31], s49 offen offset:0 lds
    buffer_load_dwordx4 v10, s[28:31], s49 offen offset:1024 lds
    buffer_load_dwordx4 v10, s[28:31], s49 offen offset:2048 lds
    buffer_load_dwordx4 v10, s[28:31], s49 offen offset:3072 lds
    s_add_u32 s49, s49, 8192
L_k2pd_154:
    s_cmp_lg_u32 s3, 0
    s_cbranch_scc1 L_w_157
    s_mov_b32 s45, 0x100000
L_poll_158:
    buffer_load_dword v3, v251, s[28:31], s75 offen sc1
    s_sub_u32 s45, s45, 1
    s_cmp_eq_u32 s45, 0
    s_cbranch_scc1 L_pdone_159
    s_waitcnt vmcnt(0)
    v_cmp_gt_u32 vcc, s41, v3
    s_cbranch_vccnz L_poll_158
L_pdone_159:
L_w_157:
    s_barrier
    s_cmp_ge_u32 s3, 4
    s_cbranch_scc1 L_k2_loader_160
    buffer_load_dwordx2 v[10:11], v248, s[28:31], s76 offen
    buffer_load_dwordx2 v[12:13], v249, s[28:31], s76 offen
    s_waitcnt vmcnt(0)
    v_cvt_pk_bf16_f32 v10, v10, v11
    v_cvt_pk_bf16_f32 v12, v12, v13
    ds_write_b32 v247, v10
    ds_write_b32 v247, v12 offset:1024
    s_waitcnt lgkmcnt(0)
    s_barrier
    v_add_u32 v245, s52, v241
    v_add_u32 v246, s52, v242
    v_add_u32 v244, s52, v240
    ds_read_b128 v[144:147], v245 offset:0
    ds_read_b128 v[148:151], v245 offset:1024
    ds_read2st64_b32 v[160:161], v246 offset0:0 offset1:1
    ds_read2st64_b32 v[162:163], v246 offset0:2 offset1:3
    ds_read2st64_b32 v[164:165], v246 offset0:4 offset1:5
    ds_read2st64_b32 v[166:167], v246 offset0:6 offset1:7
    ds_read_b128 v[176:179], v243
    v_add_u32 v243, 64, v243
    s_waitcnt lgkmcnt(0)
    v_mfma_f32_16x16x32_bf16 v[184:187], v[160:163], v[144:147], 0
    ds_read_b128 v[80:83], v244 offset:0
    ds_read_b128 v[84:87], v244 offset:1024
    v_mfma_f32_16x16x32_bf16 v[188:191], v[164:167], v[144:147], 0
    ds_read_b128 v[88:91], v244 offset:2048
    ds_read_b128 v[92:95], v244 offset:3072
    v_mfma_f32_16x16x32_bf16 v[200:203], v[176:179], v[144:147], 0
    ds_read_b128 v[96:99], v244 offset:4096
    v_mfma_f32_16x16x32_bf16 v[192:195], v[160:163], v[148:151], 0
    ds_read_b128 v[100:103], v244 offset:5120
    v_mfma_f32_16x16x32_bf16 v[196:199], v[164:167], v[148:151], 0
    ds_read_b128 v[104:107], v244 offset:6144
    v_mfma_f32_16x16x32_bf16 v[204:207], v[176:179], v[148:151], 0
    ds_read_b128 v[108:111], v244 offset:7168
    s_nop 7
    v_add_f32 v200, v15, v200
    v_rcp_f32 v200, v200
    s_nop 0
    v_mul_f32 v184, v184, v200
    v_mul_f32 v185, v185, v200
    v_mul_f32 v186, v186, v200
    v_mul_f32 v187, v187, v200
    v_cvt_pk_bf16_f32 v208, v184, v185
    v_cvt_pk_bf16_f32 v209, v186, v187
    v_mul_f32 v188, v188, v200
    v_mul_f32 v189, v189, v200
    v_mul_f32 v190, v190, v200
    v_mul_f32 v191, v191, v200
    v_cvt_pk_bf16_f32 v210, v188, v189
    v_cvt_pk_bf16_f32 v211, v190, v191
    v_add_f32 v204, v15, v204
    v_rcp_f32 v204, v204
    s_nop 0
    v_mul_f32 v192, v192, v204
    v_mul_f32 v193, v193, v204
    v_mul_f32 v194, v194, v204
    v_mul_f32 v195, v195, v204
    v_cvt_pk_bf16_f32 v212, v192, v193
    v_cvt_pk_bf16_f32 v213, v194, v195
    v_mul_f32 v196, v196, v204
    v_mul_f32 v197, v197, v204
    v_mul_f32 v198, v198, v204
    v_mul_f32 v199, v199, v204
    v_cvt_pk_bf16_f32 v214, v196, v197
    v_cvt_pk_bf16_f32 v215, v198, v199
    s_waitcnt lgkmcnt(0)
    s_barrier
    s_add_u32 s52, s52, 28672
    s_cmp_eq_u32 s52, 143360
    s_cselect_b32 s52, 0, s52
    v_add_u32 v245, s52, v241
    v_add_u32 v246, s52, v242
    v_add_u32 v244, s52, v240
    ds_read_b128 v[152:155], v245 offset:0
    ds_read_b128 v[156:159], v245 offset:1024
    ds_read2st64_b32 v[168:169], v246 offset0:0 offset1:1
    ds_read2st64_b32 v[170:171], v246 offset0:2 offset1:3
    ds_read2st64_b32 v[172:173], v246 offset0:4 offset1:5
    ds_read2st64_b32 v[174:175], v246 offset0:6 offset1:7
    ds_read_b128 v[180:183], v243
    v_add_u32 v243, 64, v243
    s_mov_b32 s55, 7
L_k2c_162:
    s_waitcnt lgkmcnt(0)
    v_mfma_f32_16x16x32_bf16 v[184:187], v[168:171], v[152:155], 0
    ds_read_b128 v[112:115], v244 offset:0
    ds_read_b128 v[116:119], v244 offset:1024
    v_mfma_f32_16x16x32_bf16 v[188:191], v[172:175], v[152:155], 0
    ds_read_b128 v[120:123], v244 offset:2048
    ds_read_b128 v[124:127], v244 offset:3072
    v_mfma_f32_16x16x32_bf16 v[200:203], v[180:183], v[152:155], 0
    ds_read_b128 v[128:131], v244 offset:4096
    v_mfma_f32_16x16x32_bf16 v[192:195], v[168:171], v[156:159], 0
    ds_read_b128 v[132:135], v244 offset:5120
    v_mfma_f32_16x16x32_bf16 v[196:199], v[172:175], v[156:159], 0
    ds_read_b128 v[136:139], v244 offset:6144
    v_mfma_f32_16x16x32_bf16 v[204:207], v[180:183], v[156:159], 0
    ds_read_b128 v[140:143], v244 offset:7168
    v_mfma_f32_16x16x32_bf16 v[16:19], v[80:83], v[208:211], v[16:19]
    v_add_f32 v200, v15, v200
    v_mfma_f32_16x16x32_bf16 v[20:23], v[80:83], v[212:215], v[20:23]
    v_rcp_f32 v200, v200
    s_nop 0
    v_mfma_f32_16x16x32_bf16 v[24:27], v[84:87], v[208:211], v[24:27]
    v_mul_f32 v184, v184, v200
    v_mul_f32 v185, v185, v200
    v_mul_f32 v186, v186, v200
    v_mfma_f32_16x16x32_bf16 v[28:31], v[84:87], v[212:215], v[28:31]
    v_mul_f32 v187, v187, v200
    v_cvt_pk_bf16_f32 v216, v184, v185
    v_cvt_pk_bf16_f32 v217, v186, v187
    v_mfma_f32_16x16x32_bf16 v[32:35], v[88:91], v[208:211], v[32:35]
    v_mul_f32 v188, v188, v200
    v_mul_f32 v189, v189, v200
    s_waitcnt lgkmcnt(0)
    s_barrier
    s_add_u32 s52, s52, 28672
    s_cmp_eq_u32 s52, 143360
    s_cselect_b32 s52, 0, s52
    v_mfma_f32_16x16x32_bf16 v[36:39], v[88:91], v[212:215], v[36:39]
    v_add_u32 v245, s52, v241
    v_add_u32 v246, s52, v242
    v_add_u32 v244, s52, v240
    v_mfma_f32_16x16x32_bf16 v[40:43], v[92:95], v[208:211], v[40:43]
    ds_read_b128 v[144:147], v245 offset:0
    ds_read_b128 v[148:151], v245 offset:1024
    ds_read2st64_b32 v[160:161], v246 offset0:0 offset1:1
    v_mfma_f32_16x16x32_bf16 v[44:47], v[92:95], v[212:215], v[44:47]
    ds_read2st64_b32 v[162:163], v246 offset0:2 offset1:3
    ds_read2st64_b32 v[164:165], v246 offset0:4 offset1:5
    ds_read2st64_b32 v[166:167], v246 offset0:6 offset1:7
    v_mfma_f32_16x16x32_bf16 v[48:51], v[96:99], v[208:211], v[48:51]
    ds_read_b128 v[176:179], v243
    v_add_u32 v243, 64, v243
    v_mul_f32 v190, v190, v200
    v_mfma_f32_16x16x32_bf16 v[52:55], v[96:99], v[212:215], v[52:55]
    v_mul_f32 v191, v191, v200
    v_cvt_pk_bf16_f32 v218, v188, v189
    v_cvt_pk_bf16_f32 v219, v190, v191
    v_mfma_f32_16x16x32_bf16 v[56:59], v[100:103], v[208:211], v[56:59]
    v_add_f32 v204, v15, v204
    v_rcp_f32 v204, v204
    s_nop 0
    v_mfma_f32_16x16x32_bf16 v[60:63], v[100:103], v[212:215], v[60:63]
    v_mul_f32 v192, v192, v204
    v_mul_f32 v193, v193, v204
    v_mul_f32 v194, v194, v204
    v_mfma_f32_16x16x32_bf16 v[64:67], v[104:107], v[208:211], v[64:67]
    v_mul_f32 v195, v195, v204
    v_cvt_pk_bf16_f32 v220, v192, v193
    v_cvt_pk_bf16_f32 v221, v194, v195
    v_mfma_f32_16x16x32_bf16 v[68:71], v[104:107], v[212:215], v[68:71]
    v_mul_f32 v196, v196, v204
    v_mul_f32 v197, v197, v204
    v_mul_f32 v198, v198, v204
    v_mfma_f32_16x16x32_bf16 v[72:75], v[108:111], v[208:211], v[72:75]
    v_mul_f32 v199, v199, v204
    v_cvt_pk_bf16_f32 v222, v196, v197
    v_mfma_f32_16x16x32_bf16 v[76:79], v[108:111], v[212:215], v[76:79]
    v_cvt_pk_bf16_f32 v223, v198, v199
    s_waitcnt lgkmcnt(0)
    v_mfma_f32_16x16x32_bf16 v[184:187], v[160:163], v[144:147], 0
    ds_read_b128 v[80:83], v244 offset:0
    ds_read_b128 v[84:87], v244 offset:1024
    v_mfma_f32_16x16x32_bf16 v[188:191], v[164:167], v[144:147], 0
    ds_read_b128 v[88:91], v244 offset:2048
    ds_read_b128 v[92:95], v244 offset:3072
    v_mfma_f32_16x16x32_bf16 v[200:203], v[176:179], v[144:147], 0
    ds_read_b128 v[96:99], v244 offset:4096
    v_mfma_f32_16x16x32_bf16 v[192:195], v[160:163], v[148:151], 0
    ds_read_b128 v[100:103], v244 offset:5120
    v_mfma_f32_16x16x32_bf16 v[196:199], v[164:167], v[148:151], 0
    ds_read_b128 v[104:107], v244 offset:6144
    v_mfma_f32_16x16x32_bf16 v[204:207], v[176:179], v[148:151], 0
    ds_read_b128 v[108:111], v244 offset:7168
    v_mfma_f32_16x16x32_bf16 v[16:19], v[112:115], v[216:219], v[16:19]
    v_add_f32 v200, v15, v200
    v_mfma_f32_16x16x32_bf16 v[20:23], v[112:115], v[220:223], v[20:23]
    v_rcp_f32 v200, v200
    s_nop 0
    v_mfma_f32_16x16x32_bf16 v[24:27], v[116:119], v[216:219], v[24:27]
    v_mul_f32 v184, v184, v200
    v_mul_f32 v185, v185, v200
    v_mul_f32 v186, v186, v200
    v_mfma_f32_16x16x32_bf16 v[28:31], v[116:119], v[220:223], v[28:31]
    v_mul_f32 v187, v187, v200
    v_cvt_pk_bf16_f32 v208, v184, v185
    v_cvt_pk_bf16_f32 v209, v186, v187
    v_mfma_f32_16x16x32_bf16 v[32:35], v[120:123], v[216:219], v[32:35]
    v_mul_f32 v188, v188, v200
    v_mul_f32 v189, v189, v200
    s_waitcnt lgkmcnt(0)
    s_barrier
    s_add_u32 s52, s52, 28672
    s_cmp_eq_u32 s52, 143360
    s_cselect_b32 s52, 0, s52
    v_mfma_f32_16x16x32_bf16 v[36:39], v[120:123], v[220:223], v[36:39]
    v_add_u32 v245, s52, v241
    v_add_u32 v246, s52, v242
    v_add_u32 v244, s52, v240
    v_mfma_f32_16x16x32_bf16 v[40:43], v[124:127], v[216:219], v[40:43]
    ds_read_b128 v[152:155], v245 offset:0
    ds_read_b128 v[156:159], v245 offset:1024
    ds_read2st64_b32 v[168:169], v246 offset0:0 offset1:1
    v_mfma_f32_16x16x32_bf16 v[44:47], v[124:127], v[220:223], v[44:47]
    ds_read2st64_b32 v[170:171], v246 offset0:2 offset1:3
    ds_read2st64_b32 v[172:173], v246 offset0:4 offset1:5
    ds_read2st64_b32 v[174:175], v246 offset0:6 offset1:7
    v_mfma_f32_16x16x32_bf16 v[48:51], v[128:131], v[216:219], v[48:51]
    ds_read_b128 v[180:183], v243
    v_add_u32 v243, 64, v243
    v_mul_f32 v190, v190, v200
    v_mfma_f32_16x16x32_bf16 v[52:55], v[128:131], v[220:223], v[52:55]
    v_mul_f32 v191, v191, v200
    v_cvt_pk_bf16_f32 v210, v188, v189
    v_cvt_pk_bf16_f32 v211, v190, v191
    v_mfma_f32_16x16x32_bf16 v[56:59], v[132:135], v[216:219], v[56:59]
    v_add_f32 v204, v15, v204
    v_rcp_f32 v204, v204
    s_nop 0
    v_mfma_f32_16x16x32_bf16 v[60:63], v[132:135], v[220:223], v[60:63]
    v_mul_f32 v192, v192, v204
    v_mul_f32 v193, v193, v204
    v_mul_f32 v194, v194, v204
    v_mfma_f32_16x16x32_bf16 v[64:67], v[136:139], v[216:219], v[64:67]
    v_mul_f32 v195, v195, v204
    v_cvt_pk_bf16_f32 v212, v192, v193
    v_cvt_pk_bf16_f32 v213, v194, v195
    v_mfma_f32_16x16x32_bf16 v[68:71], v[136:139], v[220:223], v[68:71]
    v_mul_f32 v196, v196, v204
    v_mul_f32 v197, v197, v204
    v_mul_f32 v198, v198, v204
    v_mfma_f32_16x16x32_bf16 v[72:75], v[140:143], v[216:219], v[72:75]
    v_mul_f32 v199, v199, v204
    v_cvt_pk_bf16_f32 v214, v196, v197
    v_mfma_f32_16x16x32_bf16 v[76:79], v[140:143], v[220:223], v[76:79]
    v_cvt_pk_bf16_f32 v215, v198, v199
    s_sub_u32 s55, s55, 1
    s_cmp_lg_u32 s55, 0
    s_cbranch_scc1 L_k2c_162
    s_waitcnt lgkmcnt(0)
    v_mfma_f32_16x16x32_bf16 v[184:187], v[168:171], v[152:155], 0
    ds_read_b128 v[112:115], v244 offset:0
    ds_read_b128 v[116:119], v244 offset:1024
    v_mfma_f32_16x16x32_bf16 v[188:191], v[172:175], v[152:155], 0
    ds_read_b128 v[120:123], v244 offset:2048
    ds_read_b128 v[124:127], v244 offset:3072
    v_mfma_f32_16x16x32_bf16 v[200:203], v[180:183], v[152:155], 0
    ds_read_b128 v[128:131], v244 offset:4096
    v_mfma_f32_16x16x32_bf16 v[192:195], v[168:171], v[156:159], 0
    ds_read_b128 v[132:135], v244 offset:5120
    v_mfma_f32_16x16x32_bf16 v[196:199], v[172:175], v[156:159], 0
    ds_read_b128 v[136:139], v244 offset:6144
    v_mfma_f32_16x16x32_bf16 v[204:207], v[180:183], v[156:159], 0
    ds_read_b128 v[140:143], v244 offset:7168
    v_mfma_f32_16x16x32_bf16 v[16:19], v[80:83], v[208:211], v[16:19]
    v_add_f32 v200, v15, v200
    v_mfma_f32_16x16x32_bf16 v[20:23], v[80:83], v[212:215], v[20:23]
    v_rcp_f32 v200, v200
    s_nop 0
    v_mfma_f32_16x16x32_bf16 v[24:27], v[84:87], v[208:211], v[24:27]
    v_mul_f32 v184, v184, v200
    v_mul_f32 v185, v185, v200
    v_mul_f32 v186, v186, v200
    v_mfma_f32_16x16x32_bf16 v[28:31], v[84:87], v[212:215], v[28:31]
    v_mul_f32 v187, v187, v200
    v_cvt_pk_bf16_f32 v216, v184, v185
    v_cvt_pk_bf16_f32 v217, v186, v187
    v_mfma_f32_16x16x32_bf16 v[32:35], v[88:91], v[208:211], v[32:35]
    v_mul_f32 v188, v188, v200
    v_mul_f32 v189, v189, v200
    v_mfma_f32_16x16x32_bf16 v[36:39], v[88:91], v[212:215], v[36:39]
    v_mul_f32 v190, v190, v200
    v_mul_f32 v191, v191, v200
    v_mfma_f32_16x16x32_bf16 v[40:43], v[92:95], v[208:211], v[40:43]
    v_cvt_pk_bf16_f32 v218, v188, v189
    v_cvt_pk_bf16_f32 v219, v190, v191
    v_mfma_f32_16x16x32_bf16 v[44:47], v[92:95], v[212:215], v[44:47]
    v_add_f32 v204, v15, v204
    v_rcp_f32 v204, v204
    v_mfma_f32_16x16x32_bf16 v[48:51], v[96:99], v[208:211], v[48:51]
    s_nop 0
    v_mul_f32 v192, v192, v204
    v_mfma_f32_16x16x32_bf16 v[52:55], v[96:99], v[212:215], v[52:55]
    v_mul_f32 v193, v193, v204
    v_mul_f32 v194, v194, v204
    v_mfma_f32_16x16x32_bf16 v[56:59], v[100:103], v[208:211], v[56:59]
    v_mul_f32 v195, v195, v204
    v_cvt_pk_bf16_f32 v220, v192, v193
    v_mfma_f32_16x16x32_bf16 v[60:63], v[100:103], v[212:215], v[60:63]
    v_cvt_pk_bf16_f32 v221, v194, v195
    v_mul_f32 v196, v196, v204
    v_mfma_f32_16x16x32_bf16 v[64:67], v[104:107], v[208:211], v[64:67]
    v_mul_f32 v197, v197, v204
    v_mul_f32 v198, v198, v204
    v_mfma_f32_16x16x32_bf16 v[68:71], v[104:107], v[212:215], v[68:71]
    v_mul_f32 v199, v199, v204
    v_cvt_pk_bf16_f32 v222, v196, v197
    v_mfma_f32_16x16x32_bf16 v[72:75], v[108:111], v[208:211], v[72:75]
    v_cvt_pk_bf16_f32 v223, v198, v199
    v_mfma_f32_16x16x32_bf16 v[76:79], v[108:111], v[212:215], v[76:79]
    s_waitcnt lgkmcnt(0)
    s_nop 1
    v_mfma_f32_16x16x32_bf16 v[16:19], v[112:115], v[216:219], v[16:19]
    v_mfma_f32_16x16x32_bf16 v[20:23], v[112:115], v[220:223], v[20:23]
    v_mfma_f32_16x16x32_bf16 v[24:27], v[116:119], v[216:219], v[24:27]
    v_mfma_f32_16x16x32_bf16 v[28:31], v[116:119], v[220:223], v[28:31]
    v_mfma_f32_16x16x32_bf16 v[32:35], v[120:123], v[216:219], v[32:35]
    v_mfma_f32_16x16x32_bf16 v[36:39], v[120:123], v[220:223], v[36:39]
    v_mfma_f32_16x16x32_bf16 v[40:43], v[124:127], v[216:219], v[40:43]
    v_mfma_f32_16x16x32_bf16 v[44:47], v[124:127], v[220:223], v[44:47]
    v_mfma_f32_16x16x32_bf16 v[48:51], v[128:131], v[216:219], v[48:51]
    v_mfma_f32_16x16x32_bf16 v[52:55], v[128:131], v[220:223], v[52:55]
    v_mfma_f32_16x16x32_bf16 v[56:59], v[132:135], v[216:219], v[56:59]
    v_mfma_f32_16x16x32_bf16 v[60:63], v[132:135], v[220:223], v[60:63]
    v_mfma_f32_16x16x32_bf16 v[64:67], v[136:139], v[216:219], v[64:67]
    v_mfma_f32_16x16x32_bf16 v[68:71], v[136:139], v[220:223], v[68:71]
    v_mfma_f32_16x16x32_bf16 v[72:75], v[140:143], v[216:219], v[72:75]
    v_mfma_f32_16x16x32_bf16 v[76:79], v[140:143], v[220:223], v[76:79]
    v_lshlrev_b32 v8, 4, v1
    s_lshl_b32 s50, s3, 13
    s_add_u32 s50, s50, 28672
    v_add_u32 v9, s50, v8
    s_xor_b32 s54, s3, 2
    s_lshl_b32 s54, s54, 13
    s_add_u32 s54, s54, 28672
    v_add_u32 v10, s54, v8
    s_nop 3
    s_cmp_eq_u32 s49, 0
    s_cbranch_scc0 L_k2k1_163
    ds_write_b128 v9, v[32:35] offset:0
    ds_write_b128 v9, v[36:39] offset:1024
    ds_write_b128 v9, v[40:43] offset:2048
    ds_write_b128 v9, v[44:47] offset:3072
    ds_write_b128 v9, v[64:67] offset:4096
    ds_write_b128 v9, v[68:71] offset:5120
    ds_write_b128 v9, v[72:75] offset:6144
    ds_write_b128 v9, v[76:79] offset:7168
    s_waitcnt lgkmcnt(0)
    s_barrier
    ds_read_b128 v[80:83], v10 offset:0
    ds_read_b128 v[84:87], v10 offset:1024
    ds_read_b128 v[88:91], v10 offset:2048
    ds_read_b128 v[92:95], v10 offset:3072
    ds_read_b128 v[96:99], v10 offset:4096
    ds_read_b128 v[100:103], v10 offset:5120
    ds_read_b128 v[104:107], v10 offset:6144
    ds_read_b128 v[108:111], v10 offset:7168
    v_lshlrev_b32 v144, 16, v224
    v_and_b32 v145, 0xffff0000, v224
    v_lshlrev_b32 v146, 16, v225
    v_and_b32 v147, 0xffff0000, v225
    v_lshlrev_b32 v148, 16, v232
    v_and_b32 v149, 0xffff0000, v232
    v_lshlrev_b32 v150, 16, v233
    v_and_b32 v151, 0xffff0000, v233
    v_lshlrev_b32 v152, 16, v228
    v_and_b32 v153, 0xffff0000, v228
    v_lshlrev_b32 v154, 16, v229
    v_and_b32 v155, 0xffff0000, v229
    v_lshlrev_b32 v156, 16, v236
    v_and_b32 v157, 0xffff0000, v236
    v_lshlrev_b32 v158, 16, v237
    v_and_b32 v159, 0xffff0000, v237
    v_lshlrev_b32 v160, 16, v226
    v_and_b32 v161, 0xffff0000, v226
    v_lshlrev_b32 v162, 16, v227
    v_and_b32 v163, 0xffff0000, v227
    v_lshlrev_b32 v164, 16, v234
    v_and_b32 v165, 0xffff0000, v234
    v_lshlrev_b32 v166, 16, v235
    v_and_b32 v167, 0xffff0000, v235
    v_lshlrev_b32 v168, 16, v230
    v_and_b32 v169, 0xffff0000, v230
    v_lshlrev_b32 v170, 16, v231
    v_and_b32 v171, 0xffff0000, v231
    v_lshlrev_b32 v172, 16, v238
    v_and_b32 v173, 0xffff0000, v238
    v_lshlrev_b32 v174, 16, v239
    v_and_b32 v175, 0xffff0000, v239
    v_pk_add_f32 v[144:145], v[144:145], v[16:17]
    v_pk_add_f32 v[146:147], v[146:147], v[18:19]
    v_pk_add_f32 v[148:149], v[148:149], v[20:21]
    v_pk_add_f32 v[150:151], v[150:151], v[22:23]
    v_pk_add_f32 v[152:153], v[152:153], v[24:25]
    v_pk_add_f32 v[154:155], v[154:155], v[26:27]
    v_pk_add_f32 v[156:157], v[156:157], v[28:29]
    v_pk_add_f32 v[158:159], v[158:159], v[30:31]
    v_pk_add_f32 v[160:161], v[160:161], v[48:49]
    v_pk_add_f32 v[162:163], v[162:163], v[50:51]
    v_pk_add_f32 v[164:165], v[164:165], v[52:53]
    v_pk_add_f32 v[166:167], v[166:167], v[54:55]
    v_pk_add_f32 v[168:169], v[168:169], v[56:57]
    v_pk_add_f32 v[170:171], v[170:171], v[58:59]
    v_pk_add_f32 v[172:173], v[172:173], v[60:61]
    v_pk_add_f32 v[174:175], v[174:175], v[62:63]
    s_waitcnt lgkmcnt(0)
    s_branch L_k2k2_164
L_k2k1_163:
    ds_write_b128 v9, v[16:19] offset:0
    ds_write_b128 v9, v[20:23] offset:1024
    ds_write_b128 v9, v[24:27] offset:2048
    ds_write_b128 v9, v[28:31] offset:3072
    ds_write_b128 v9, v[48:51] offset:4096
    ds_write_b128 v9, v[52:55] offset:5120
    ds_write_b128 v9, v[56:59] offset:6144
    ds_write_b128 v9, v[60:63] offset:7168
    s_waitcnt lgkmcnt(0)
    s_barrier
    ds_read_b128 v[80:83], v10 offset:0
    ds_read_b128 v[84:87], v10 offset:1024
    ds_read_b128 v[88:91], v10 offset:2048
    ds_read_b128 v[92:95], v10 offset:3072
    ds_read_b128 v[96:99], v10 offset:4096
    ds_read_b128 v[100:103], v10 offset:5120
    ds_read_b128 v[104:107], v10 offset:6144
    ds_read_b128 v[108:111], v10 offset:7168
    v_lshlrev_b32 v144, 16, v224
    v_and_b32 v145, 0xffff0000, v224
    v_lshlrev_b32 v146, 16, v225
    v_and_b32 v147, 0xffff0000, v225
    v_lshlrev_b32 v148, 16, v232
    v_and_b32 v149, 0xffff0000, v232
    v_lshlrev_b32 v150, 16, v233
    v_and_b32 v151, 0xffff0000, v233
    v_lshlrev_b32 v152, 16, v228
    v_and_b32 v153, 0xffff0000, v228
    v_lshlrev_b32 v154, 16, v229
    v_and_b32 v155, 0xffff0000, v229
    v_lshlrev_b32 v156, 16, v236
    v_and_b32 v157, 0xffff0000, v236
    v_lshlrev_b32 v158, 16, v237
    v_and_b32 v159, 0xffff0000, v237
    v_lshlrev_b32 v160, 16, v226
    v_and_b32 v161, 0xffff0000, v226
    v_lshlrev_b32 v162, 16, v227
    v_and_b32 v163, 0xffff0000, v227
    v_lshlrev_b32 v164, 16, v234
    v_and_b32 v165, 0xffff0000, v234
    v_lshlrev_b32 v166, 16, v235
    v_and_b32 v167, 0xffff0000, v235
    v_lshlrev_b32 v168, 16, v230
    v_and_b32 v169, 0xffff0000, v230
    v_lshlrev_b32 v170, 16, v231
    v_and_b32 v171, 0xffff0000, v231
    v_lshlrev_b32 v172, 16, v238
    v_and_b32 v173, 0xffff0000, v238
    v_lshlrev_b32 v174, 16, v239
    v_and_b32 v175, 0xffff0000, v239
    v_pk_add_f32 v[144:145], v[144:145], v[32:33]
    v_pk_add_f32 v[146:147], v[146:147], v[34:35]
    v_pk_add_f32 v[148:149], v[148:149], v[36:37]
    v_pk_add_f32 v[150:151], v[150:151], v[38:39]
    v_pk_add_f32 v[152:153], v[152:153], v[40:41]
    v_pk_add_f32 v[154:155], v[154:155], v[42:43]
    v_pk_add_f32 v[156:157], v[156:157], v[44:45]
    v_pk_add_f32 v[158:159], v[158:159], v[46:47]
    v_pk_add_f32 v[160:161], v[160:161], v[64:65]
    v_pk_add_f32 v[162:163], v[162:163], v[66:67]
    v_pk_add_f32 v[164:165], v[164:165], v[68:69]
    v_pk_add_f32 v[166:167], v[166:167], v[70:71]
    v_pk_add_f32 v[168:169], v[168:169], v[72:73]
    v_pk_add_f32 v[170:171], v[170:171], v[74:75]
    v_pk_add_f32 v[172:173], v[172:173], v[76:77]
    v_pk_add_f32 v[174:175], v[174:175], v[78:79]
    s_waitcnt lgkmcnt(0)
L_k2k2_164:
    v_pk_add_f32 v[144:145], v[144:145], v[80:81]
    v_pk_add_f32 v[146:147], v[146:147], v[82:83]
    v_cvt_pk_bf16_f32 v32, v144, v145
    v_cvt_pk_bf16_f32 v33, v146, v147
    v_pk_add_f32 v[160:161], v[160:161], v[96:97]
    v_pk_add_f32 v[162:163], v[162:163], v[98:99]
    v_cvt_pk_bf16_f32 v34, v160, v161
    v_cvt_pk_bf16_f32 v35, v162, v163
    v_pk_add_f32 v[152:153], v[152:153], v[88:89]
    v_pk_add_f32 v[154:155], v[154:155], v[90:91]
    v_cvt_pk_bf16_f32 v36, v152, v153
    v_cvt_pk_bf16_f32 v37, v154, v155
    v_pk_add_f32 v[168:169], v[168:169], v[104:105]
    v_pk_add_f32 v[170:171], v[170:171], v[106:107]
    v_cvt_pk_bf16_f32 v38, v168, v169
    v_cvt_pk_bf16_f32 v39, v170, v171
    v_pk_add_f32 v[148:149], v[148:149], v[84:85]
    v_pk_add_f32 v[150:151], v[150:151], v[86:87]
    v_cvt_pk_bf16_f32 v40, v148, v149
    v_cvt_pk_bf16_f32 v41, v150, v151
    v_pk_add_f32 v[164:165], v[164:165], v[100:101]
    v_pk_add_f32 v[166:167], v[166:167], v[102:103]
    v_cvt_pk_bf16_f32 v42, v164, v165
    v_cvt_pk_bf16_f32 v43, v166, v167
    v_pk_add_f32 v[156:157], v[156:157], v[92:93]
    v_pk_add_f32 v[158:159], v[158:159], v[94:95]
    v_cvt_pk_bf16_f32 v44, v156, v157
    v_cvt_pk_bf16_f32 v45, v158, v159
    v_pk_add_f32 v[172:173], v[172:173], v[108:109]
    v_pk_add_f32 v[174:175], v[174:175], v[110:111]
    v_cvt_pk_bf16_f32 v46, v172, v173
    v_cvt_pk_bf16_f32 v47, v174, v175
    v_and_b32 v8, 15, v1
    v_lshrrev_b32 v9, 4, v1
    s_mov_b32 s54, 32768
    v_mul_lo_u32 v10, v9, s54
    v_lshl_add_u32 v10, v8, 4, v10
    s_mul_i32 s50, s40, 4718592
    s_add_u32 s50, s50, 9437184
    s_mul_i32 s54, s43, 524288
    s_add_u32 s50, s50, s54
    s_mul_i32 s54, s49, 262144
    s_add_u32 s50, s50, s54
    s_lshl_b32 s54, s61, 4
    s_add_u32 s50, s50, s54
    s_add_u32 s54, s50, 0
    buffer_store_dwordx4 v[32:35], v10, s[28:31], s54 offen sc1
    s_add_u32 s54, s50, 131072
    buffer_store_dwordx4 v[36:39], v10, s[28:31], s54 offen sc1
    s_add_u32 s54, s50, 256
    buffer_store_dwordx4 v[40:43], v10, s[28:31], s54 offen sc1
    s_add_u32 s54, s50, 131328
    buffer_store_dwordx4 v[44:47], v10, s[28:31], s54 offen sc1
    v_pk_mul_f32 v[54:55], v[144:145], v[144:145]
    v_pk_add_f32 v[52:53], v[144:145], v[146:147]
    v_pk_fma_f32 v[54:55], v[146:147], v[146:147], v[54:55]
    v_pk_fma_f32 v[54:55], v[152:153], v[152:153], v[54:55]
    v_pk_add_f32 v[52:53], v[52:53], v[152:153]
    v_pk_fma_f32 v[54:55], v[154:155], v[154:155], v[54:55]
    v_pk_add_f32 v[52:53], v[52:53], v[154:155]
    v_pk_fma_f32 v[54:55], v[160:161], v[160:161], v[54:55]
    v_pk_add_f32 v[52:53], v[52:53], v[160:161]
    v_pk_fma_f32 v[54:55], v[162:163], v[162:163], v[54:55]
    v_pk_add_f32 v[52:53], v[52:53], v[162:163]
    v_pk_fma_f32 v[54:55], v[168:169], v[168:169], v[54:55]
    v_pk_add_f32 v[52:53], v[52:53], v[168:169]
    v_pk_fma_f32 v[54:55], v[170:171], v[170:171], v[54:55]
    v_pk_add_f32 v[52:53], v[52:53], v[170:171]
    v_add_f32 v16, v52, v53
    v_add_f32 v18, v54, v55
    v_pk_mul_f32 v[58:59], v[148:149], v[148:149]
    v_pk_add_f32 v[56:57], v[148:149], v[150:151]
    v_pk_fma_f32 v[58:59], v[150:151], v[150:151], v[58:59]
    v_pk_fma_f32 v[58:59], v[156:157], v[156:157], v[58:59]
    v_pk_add_f32 v[56:57], v[56:57], v[156:157]
    v_pk_fma_f32 v[58:59], v[158:159], v[158:159], v[58:59]
    v_pk_add_f32 v[56:57], v[56:57], v[158:159]
    v_pk_fma_f32 v[58:59], v[164:165], v[164:165], v[58:59]
    v_pk_add_f32 v[56:57], v[56:57], v[164:165]
    v_pk_fma_f32 v[58:59], v[166:167], v[166:167], v[58:59]
    v_pk_add_f32 v[56:57], v[56:57], v[166:167]
    v_pk_fma_f32 v[58:59], v[172:173], v[172:173], v[58:59]
    v_pk_add_f32 v[56:57], v[56:57], v[172:173]
    v_pk_fma_f32 v[58:59], v[174:175], v[174:175], v[58:59]
    v_pk_add_f32 v[56:57], v[56:57], v[174:175]
    v_add_f32 v17, v56, v57
    v_add_f32 v19, v58, v59
    v_mov_b32 v20, v16
    v_mov_b32 v21, v17
    v_mov_b32 v22, v18
    v_mov_b32 v23, v19
    s_nop 1
    v_permlane16_swap_b32 v16, v20
    v_permlane16_swap_b32 v17, v21
    v_permlane16_swap_b32 v18, v22
    v_permlane16_swap_b32 v19, v23
    s_nop 1
    v_add_f32 v16, v16, v20
    v_add_f32 v17, v17, v21
    v_add_f32 v18, v18, v22
    v_add_f32 v19, v19, v23
    v_mov_b32 v20, v16
    v_mov_b32 v21, v17
    v_mov_b32 v22, v18
    v_mov_b32 v23, v19
    s_nop 1
    v_permlane32_swap_b32 v16, v20
    v_permlane32_swap_b32 v17, v21
    v_permlane32_swap_b32 v18, v22
    v_permlane32_swap_b32 v19, v23
    s_nop 1
    v_add_f32 v16, v16, v20
    v_add_f32 v17, v17, v21
    v_add_f32 v18, v18, v22
    v_add_f32 v19, v19, v23
    v_cmp_eq_u32 vcc, 1, v9
    s_nop 1
    v_cndmask_b32 v16, v16, v17, vcc
    v_cmp_eq_u32 vcc, 2, v9
    s_nop 1
    v_cndmask_b32 v16, v16, v18, vcc
    v_cmp_eq_u32 vcc, 3, v9
    s_nop 1
    v_cndmask_b32 v16, v16, v19, vcc
    v_and_b32 v10, 31, v1
    v_lshlrev_b32 v10, 2, v10
    v_lshrrev_b32 v11, 5, v1
    v_lshl_add_u32 v10, v11, 13, v10
    s_mul_i32 s50, s40, 16384
    s_add_u32 s50, s50, 172032
    s_lshl_b32 s54, s61, 2
    s_add_u32 s50, s50, s54
    buffer_atomic_add_f32 v16, v10, s[28:31], s50 offen
    s_branch L_k2_done_161
L_k2_loader_160:
    s_add_u32 m0, s61, s58
    s_nop 0
    buffer_load_dwordx4 v10, s[28:31], s50 offen offset:0 lds
    buffer_load_dwordx4 v10, s[28:31], s50 offen offset:1024 lds
    s_add_u32 m0, s61, s59
    s_add_u32 s50, s50, 4096
    buffer_load_dwordx4 v10, s[28:31], s51 offen lds
    s_add_u32 s51, s51, 2048
    s_add_u32 s61, s61, 28672
    s_cmp_eq_u32 s61, 143360
    s_cselect_b32 s61, 0, s61
    s_add_u32 m0, s61, s58
    s_nop 0
    buffer_load_dwordx4 v10, s[28:31], s50 offen offset:0 lds
    buffer_load_dwordx4 v10, s[28:31], s50 offen offset:1024 lds
    s_add_u32 m0, s61, s59
    s_add_u32 s50, s50, 4096
    buffer_load_dwordx4 v10, s[28:31], s51 offen lds
    s_add_u32 s51, s51, 2048
    s_add_u32 s61, s61, 28672
    s_cmp_eq_u32 s61, 143360
    s_cselect_b32 s61, 0, s61
    s_waitcnt vmcnt(3)
    s_barrier
    s_add_u32 m0, s61, s58
    s_nop 0
    buffer_load_dwordx4 v10, s[28:31], s50 offen offset:0 lds
    buffer_load_dwordx4 v10, s[28:31], s50 offen offset:1024 lds
    s_add_u32 m0, s61, s59
    s_add_u32 s50, s50, 4096
    buffer_load_dwordx4 v10, s[28:31], s51 offen lds
    s_add_u32 s51, s51, 2048
    s_add_u32 s61, s61, 28672
    s_cmp_eq_u32 s61, 143360
    s_cselect_b32 s61, 0, s61
    s_add_u32 m0, s61, s58
    s_nop 0
    buffer_load_dwordx4 v10, s[28:31], s50 offen offset:0 lds
    buffer_load_dwordx4 v10, s[28:31], s50 offen offset:1024 lds
    s_add_u32 m0, s61, s59
    s_add_u32 s50, s50, 4096
    buffer_load_dwordx4 v10, s[28:31], s51 offen lds
    s_add_u32 s51, s51, 2048
    s_add_u32 s61, s61, 28672
    s_cmp_eq_u32 s61, 143360
    s_cselect_b32 s61, 0, s61
    s_add_u32 m0, s61, s58
    s_nop 0
    buffer_load_dwordx4 v10, s[28:31], s50 offen offset:0 lds
    buffer_load_dwordx4 v10, s[28:31], s50 offen offset:1024 lds
    s_add_u32 m0, s61, s59
    s_add_u32 s50, s50, 4096
    buffer_load_dwordx4 v10, s[28:31], s51 offen lds
    s_add_u32 s51, s51, 2048
    s_add_u32 s61, s61, 28672
    s_cmp_eq_u32 s61, 143360
    s_cselect_b32 s61, 0, s61
    s_waitcnt vmcnt(9)
    s_barrier
    s_add_u32 m0, s52, s57
    s_add_u32 s52, s52, 28672
    s_cmp_eq_u32 s52, 143360
    s_cselect_b32 s52, 0, s52
    buffer_load_dwordx4 v10, s[28:31], s49 offen offset:0 lds
    buffer_load_dwordx4 v10, s[28:31], s49 offen offset:1024 lds
    buffer_load_dwordx4 v10, s[28:31], s49 offen offset:2048 lds
    buffer_load_dwordx4 v10, s[28:31], s49 offen offset:3072 lds
    s_add_u32 s49, s49, 8192
    s_add_u32 m0, s61, s58
    s_nop 0
    buffer_load_dwordx4 v10, s[28:31], s50 offen offset:0 lds
    buffer_load_dwordx4 v10, s[28:31], s50 offen offset:1024 lds
    s_add_u32 m0, s61, s59
    s_add_u32 s50, s50, 4096
    buffer_load_dwordx4 v10, s[28:31], s51 offen lds
    s_add_u32 s51, s51, 2048
    s_add_u32 s61, s61, 28672
    s_cmp_eq_u32 s61, 143360
    s_cselect_b32 s61, 0, s61
    s_waitcnt vmcnt(13)
    s_barrier
    s_add_u32 m0, s52, s57
    s_add_u32 s52, s52, 28672
    s_cmp_eq_u32 s52, 143360
    s_cselect_b32 s52, 0, s52
    buffer_load_dwordx4 v10, s[28:31], s49 offen offset:0 lds
    buffer_load_dwordx4 v10, s[28:31], s49 offen offset:1024 lds
    buffer_load_dwordx4 v10, s[28:31], s49 offen offset:2048 lds
    buffer_load_dwordx4 v10, s[28:31], s49 offen offset:3072 lds
    s_add_u32 s49, s49, 8192
    s_add_u32 m0, s61, s58
    s_nop 0
    buffer_load_dwordx4 v10, s[28:31], s50 offen offset:0 lds
    buffer_load_dwordx4 v10, s[28:31], s50 offen offset:1024 lds
    s_add_u32 m0, s61, s59
    s_add_u32 s50, s50, 4096
    buffer_load_dwordx4 v10, s[28:31], s51 offen lds
    s_add_u32 s51, s51, 2048
    s_add_u32 s61, s61, 28672
    s_cmp_eq_u32 s61, 143360
    s_cselect_b32 s61, 0, s61
    s_waitcnt vmcnt(17)
    s_barrier
    s_add_u32 m0, s52, s57
    s_add_u32 s52, s52, 28672
    s_cmp_eq_u32 s52, 143360
    s_cselect_b32 s52, 0, s52
    buffer_load_dwordx4 v10, s[28:31], s49 offen offset:0 lds
    buffer_load_dwordx4 v10, s[28:31], s49 offen offset:1024 lds
    buffer_load_dwordx4 v10, s[28:31], s49 offen offset:2048 lds
    buffer_load_dwordx4 v10, s[28:31], s49 offen offset:3072 lds
    s_add_u32 s49, s49, 8192
    s_add_u32 m0, s61, s58
    s_nop 0
    buffer_load_dwordx4 v10, s[28:31], s50 offen offset:0 lds
    buffer_load_dwordx4 v10, s[28:31], s50 offen offset:1024 lds
    s_add_u32 m0, s61, s59
    s_add_u32 s50, s50, 4096
    buffer_load_dwordx4 v10, s[28:31], s51 offen lds
    s_add_u32 s51, s51, 2048
    s_add_u32 s61, s61, 28672
    s_cmp_eq_u32 s61, 143360
    s_cselect_b32 s61, 0, s61
    s_waitcnt vmcnt(21)
    s_barrier
    s_add_u32 m0, s52, s57
    s_add_u32 s52, s52, 28672
    s_cmp_eq_u32 s52, 143360
    s_cselect_b32 s52, 0, s52
    buffer_load_dwordx4 v10, s[28:31], s49 offen offset:0 lds
    buffer_load_dwordx4 v10, s[28:31], s49 offen offset:1024 lds
    buffer_load_dwordx4 v10, s[28:31], s49 offen offset:2048 lds
    buffer_load_dwordx4 v10, s[28:31], s49 offen offset:3072 lds
    s_add_u32 s49, s49, 8192
    s_add_u32 m0, s61, s58
    s_nop 0
    buffer_load_dwordx4 v10, s[28:31], s50 offen offset:0 lds
    buffer_load_dwordx4 v10, s[28:31], s50 offen offset:1024 lds
    s_add_u32 m0, s61, s59
    s_add_u32 s50, s50, 4096
    buffer_load_dwordx4 v10, s[28:31], s51 offen lds
    s_add_u32 s51, s51, 2048
    s_add_u32 s61, s61, 28672
    s_cmp_eq_u32 s61, 143360
    s_cselect_b32 s61, 0, s61
    s_mov_b32 s55, 7
L_k2l_165:
    s_waitcnt vmcnt(21)
    s_barrier
    s_add_u32 m0, s52, s57
    s_add_u32 s52, s52, 28672
    s_cmp_eq_u32 s52, 143360
    s_cselect_b32 s52, 0, s52
    buffer_load_dwordx4 v10, s[28:31], s49 offen offset:0 lds
    buffer_load_dwordx4 v10, s[28:31], s49 offen offset:1024 lds
    buffer_load_dwordx4 v10, s[28:31], s49 offen offset:2048 lds
    buffer_load_dwordx4 v10, s[28:31], s49 offen offset:3072 lds
    s_add_u32 s49, s49, 8192
    s_add_u32 m0, s61, s58
    s_nop 0
    buffer_load_dwordx4 v10, s[28:31], s50 offen offset:0 lds
    buffer_load_dwordx4 v10, s[28:31], s50 offen offset:1024 lds
    s_add_u32 m0, s61, s59
    s_add_u32 s50, s50, 4096
    buffer_load_dwordx4 v10, s[28:31], s51 offen lds
    s_add_u32 s51, s51, 2048
    s_add_u32 s61, s61, 28672
    s_cmp_eq_u32 s61, 143360
    s_cselect_b32 s61, 0, s61
    s_sub_u32 s55, s55, 1
    s_cmp_lg_u32 s55, 0
    s_cbranch_scc1 L_k2l_165
    s_waitcnt vmcnt(21)
    s_barrier
    s_waitcnt vmcnt(14)
    s_barrier
    s_waitcnt vmcnt(7)
    s_barrier
    s_waitcnt vmcnt(0)
    s_barrier
    s_barrier
L_k2_done_161:
    s_add_u32 s41, s41, 16
    s_cmp_lg_u32 s3, 0
    s_waitcnt vmcnt(0) lgkmcnt(0)
    s_barrier
    s_cbranch_scc1 L_arr_166
    s_mov_b32 exec_lo, 0xff
    s_mov_b32 exec_hi, 0
    buffer_atomic_add v252, v250, s[28:31], s74 offen sc1
    s_mov_b64 exec, -1
L_arr_166:
    s_lshr_b32 s48, s2, 7
    s_lshl_b32 s48, s48, 1
    s_lshr_b32 s49, s3, 2
    s_add_u32 s48, s48, s49
    s_lshl_b32 s48, s48, 14
    s_add_u32 s48, s48, 262144
    v_lshlrev_b32 v2, 4, v1
    buffer_load_dwordx4 v[160:163], v2, s[28:31], s48 offen offset:0
    buffer_load_dwordx4 v[164:167], v2, s[28:31], s48 offen offset:1024
    buffer_load_dwordx4 v[168:171], v2, s[28:31], s48 offen offset:2048
    buffer_load_dwordx4 v[172:175], v2, s[28:31], s48 offen offset:3072
    s_add_u32 s48, s48, 4096
    buffer_load_dwordx4 v[176:179], v2, s[28:31], s48 offen offset:0
    buffer_load_dwordx4 v[180:183], v2, s[28:31], s48 offen offset:1024
    buffer_load_dwordx4 v[184:187], v2, s[28:31], s48 offen offset:2048
    buffer_load_dwordx4 v[188:191], v2, s[28:31], s48 offen offset:3072
    s_add_u32 s48, s48, 4096
    buffer_load_dwordx4 v[192:195], v2, s[28:31], s48 offen offset:0
    buffer_load_dwordx4 v[196:199], v2, s[28:31], s48 offen offset:1024
    buffer_load_dwordx4 v[200:203], v2, s[28:31], s48 offen offset:2048
    buffer_load_dwordx4 v[204:207], v2, s[28:31], s48 offen offset:3072
    s_add_u32 s48, s48, 4096
    buffer_load_dwordx4 v[208:211], v2, s[28:31], s48 offen offset:0
    buffer_load_dwordx4 v[212:215], v2, s[28:31], s48 offen offset:1024
    buffer_load_dwordx4 v[216:219], v2, s[28:31], s48 offen offset:2048
    buffer_load_dwordx4 v[220:223], v2, s[28:31], s48 offen offset:3072
    v_and_b32 v2, 31, v1
    v_lshrrev_b32 v3, 5, v1
    s_lshl_b32 s44, s3, 1
    v_add_u32 v3, s44, v3
    v_lshlrev_b32 v4, 7, v3
    v_add_u32 v4, v4, v2
    v_lshlrev_b32 v240, 4, v4
    s_mul_i32 s76, s40, 4718592
    s_add_u32 s76, s76, 9437184
    s_and_b32 s50, s2, 127
    s_mul_i32 s46, s50, 32768
    s_add_u32 s76, s76, s46
    v_lshlrev_b32 v241, 2, v4
    s_mul_i32 s77, s40, 16384
    s_add_u32 s77, s77, 172032
    s_add_u32 s78, s77, 8192
    v_bfe_u32 v7, v2, 1, 3
    v_lshrrev_b32 v8, 1, v3
    v_xor_b32 v7, v7, v8
    v_lshlrev_b32 v7, 4, v7
    v_lshl_add_u32 v7, v2, 7, v7
    v_and_b32 v8, 1, v3
    v_lshl_add_u32 v7, v8, 3, v7
    v_and_b32 v12, 15, v1
    v_lshrrev_b32 v13, 4, v1
    v_bfe_u32 v14, v1, 1, 3
    s_and_b32 s51, s3, 3
    s_lshl_b32 s52, s51, 13
    v_add_u32 v15, 0, v13
    v_xor_b32 v15, v15, v14
    v_lshlrev_b32 v15, 4, v15
    v_lshl_add_u32 v48, v12, 7, v15
    v_add_u32 v48, s52, v48
    v_add_u32 v15, 4, v13
    v_xor_b32 v15, v15, v14
    v_lshlrev_b32 v15, 4, v15
    v_lshl_add_u32 v49, v12, 7, v15
    v_add_u32 v49, s52, v49
    s_cmp_lg_u32 s3, 0
    s_cbranch_scc1 L_w_167
    s_mov_b32 s45, 0x100000
L_poll_168:
    buffer_load_dword v3, v251, s[28:31], s75 offen sc1
    s_sub_u32 s45, s45, 1
    s_cmp_eq_u32 s45, 0
    s_cbranch_scc1 L_pdone_169
    s_waitcnt vmcnt(0)
    v_cmp_gt_u32 vcc, s41, v3
    s_cbranch_vccnz L_poll_168
L_pdone_169:
L_w_167:
    s_barrier
    buffer_load_dwordx4 v[16:19], v240, s[28:31], s76 offen offset:0
    buffer_load_dwordx4 v[20:23], v240, s[28:31], s76 offen offset:512
    buffer_load_dwordx4 v[24:27], v240, s[28:31], s76 offen offset:1024
    buffer_load_dwordx4 v[28:31], v240, s[28:31], s76 offen offset:1536
    buffer_load_dword v32, v241, s[28:31], s77 offen offset:0
    buffer_load_dword v36, v241, s[28:31], s78 offen offset:0
    buffer_load_dword v33, v241, s[28:31], s77 offen offset:128
    buffer_load_dword v37, v241, s[28:31], s78 offen offset:128
    buffer_load_dword v34, v241, s[28:31], s77 offen offset:256
    buffer_load_dword v38, v241, s[28:31], s78 offen offset:256
    buffer_load_dword v35, v241, s[28:31], s77 offen offset:384
    buffer_load_dword v39, v241, s[28:31], s78 offen offset:384
    s_waitcnt vmcnt(8)
    v_lshlrev_b32 v64, 16, v16
    v_and_b32 v65, 0xffff0000, v16
    v_lshlrev_b32 v66, 16, v17
    v_and_b32 v67, 0xffff0000, v17
    v_lshlrev_b32 v68, 16, v18
    v_and_b32 v69, 0xffff0000, v18
    v_lshlrev_b32 v70, 16, v19
    v_and_b32 v71, 0xffff0000, v19
    v_lshlrev_b32 v72, 16, v20
    v_and_b32 v73, 0xffff0000, v20
    v_lshlrev_b32 v74, 16, v21
    v_and_b32 v75, 0xffff0000, v21
    v_lshlrev_b32 v76, 16, v22
    v_and_b32 v77, 0xffff0000, v22
    v_lshlrev_b32 v78, 16, v23
    v_and_b32 v79, 0xffff0000, v23
    v_lshlrev_b32 v80, 16, v24
    v_and_b32 v81, 0xffff0000, v24
    v_lshlrev_b32 v82, 16, v25
    v_and_b32 v83, 0xffff0000, v25
    v_lshlrev_b32 v84, 16, v26
    v_and_b32 v85, 0xffff0000, v26
    v_lshlrev_b32 v86, 16, v27
    v_and_b32 v87, 0xffff0000, v27
    v_lshlrev_b32 v88, 16, v28
    v_and_b32 v89, 0xffff0000, v28
    v_lshlrev_b32 v90, 16, v29
    v_and_b32 v91, 0xffff0000, v29
    v_lshlrev_b32 v92, 16, v30
    v_and_b32 v93, 0xffff0000, v30
    v_lshlrev_b32 v94, 16, v31
    v_and_b32 v95, 0xffff0000, v31
    s_waitcnt vmcnt(0)
    v_mul_f32 v32, 0x3a800000, v32
    v_mul_f32 v36, 0x3a800000, v36
    v_mul_f32 v33, 0x3a800000, v33
    v_mul_f32 v37, 0x3a800000, v37
    v_mul_f32 v34, 0x3a800000, v34
    v_mul_f32 v38, 0x3a800000, v38
    v_mul_f32 v35, 0x3a800000, v35
    v_mul_f32 v39, 0x3a800000, v39
    v_fma_f32 v36, -v32, v32, v36
    v_max_f32 v36, 0, v36
    v_add_f32 v36, 0x3727c5ac, v36
    v_rsq_f32 v36, v36
    v_fma_f32 v37, -v33, v33, v37
    v_max_f32 v37, 0, v37
    v_add_f32 v37, 0x3727c5ac, v37
    v_rsq_f32 v37, v37
    v_fma_f32 v38, -v34, v34, v38
    v_max_f32 v38, 0, v38
    v_add_f32 v38, 0x3727c5ac, v38
    v_rsq_f32 v38, v38
    v_fma_f32 v39, -v35, v35, v39
    v_max_f32 v39, 0, v39
    v_add_f32 v39, 0x3727c5ac, v39
    v_rsq_f32 v39, v39
    s_nop 0
    v_mov_b32 v96, v36
    v_mov_b32 v97, v36
    v_mul_f32 v98, v32, v36
    v_mul_f32 v99, v32, v36
    v_mov_b32 v100, v37
    v_mov_b32 v101, v37
    v_mul_f32 v102, v33, v37
    v_mul_f32 v103, v33, v37
    v_mov_b32 v104, v38
    v_mov_b32 v105, v38
    v_mul_f32 v106, v34, v38
    v_mul_f32 v107, v34, v38
    v_mov_b32 v108, v39
    v_mov_b32 v109, v39
    v_mul_f32 v110, v35, v39
    v_mul_f32 v111, v35, v39
    v_pk_fma_f32 v[64:65], v[64:65], v[96:97], v[98:99] neg_lo:[0,0,1] neg_hi:[0,0,1]
    v_pk_fma_f32 v[72:73], v[72:73], v[100:101], v[102:103] neg_lo:[0,0,1] neg_hi:[0,0,1]
    v_pk_fma_f32 v[80:81], v[80:81], v[104:105], v[106:107] neg_lo:[0,0,1] neg_hi:[0,0,1]
    v_pk_fma_f32 v[88:89], v[88:89], v[108:109], v[110:111] neg_lo:[0,0,1] neg_hi:[0,0,1]
    v_cvt_pk_f16_f32 v40, v64, v72
    v_cvt_pk_f16_f32 v41, v80, v88
    ds_write_b64 v7, v[40:41] offset:0
    v_cvt_pk_f16_f32 v42, v65, v73
    v_cvt_pk_f16_f32 v43, v81, v89
    ds_write_b64 v7, v[42:43] offset:8192
    v_pk_fma_f32 v[66:67], v[66:67], v[96:97], v[98:99] neg_lo:[0,0,1] neg_hi:[0,0,1]
    v_pk_fma_f32 v[74:75], v[74:75], v[100:101], v[102:103] neg_lo:[0,0,1] neg_hi:[0,0,1]
    v_pk_fma_f32 v[82:83], v[82:83], v[104:105], v[106:107] neg_lo:[0,0,1] neg_hi:[0,0,1]
    v_pk_fma_f32 v[90:91], v[90:91], v[108:109], v[110:111] neg_lo:[0,0,1] neg_hi:[0,0,1]
    v_cvt_pk_f16_f32 v44, v66, v74
    v_cvt_pk_f16_f32 v45, v82, v90
    ds_write_b64 v7, v[44:45] offset:16384
    v_cvt_pk_f16_f32 v46, v67, v75
    v_cvt_pk_f16_f32 v47, v83, v91
    ds_write_b64 v7, v[46:47] offset:24576
    v_pk_fma_f32 v[68:69], v[68:69], v[96:97], v[98:99] neg_lo:[0,0,1] neg_hi:[0,0,1]
    v_pk_fma_f32 v[76:77], v[76:77], v[100:101], v[102:103] neg_lo:[0,0,1] neg_hi:[0,0,1]
    v_pk_fma_f32 v[84:85], v[84:85], v[104:105], v[106:107] neg_lo:[0,0,1] neg_hi:[0,0,1]
    v_pk_fma_f32 v[92:93], v[92:93], v[108:109], v[110:111] neg_lo:[0,0,1] neg_hi:[0,0,1]
    v_cvt_pk_f16_f32 v40, v68, v76
    v_cvt_pk_f16_f32 v41, v84, v92
    ds_write_b64 v7, v[40:41] offset:4096
    v_cvt_pk_f16_f32 v42, v69, v77
    v_cvt_pk_f16_f32 v43, v85, v93
    ds_write_b64 v7, v[42:43] offset:12288
    v_pk_fma_f32 v[70:71], v[70:71], v[96:97], v[98:99] neg_lo:[0,0,1] neg_hi:[0,0,1]
    v_pk_fma_f32 v[78:79], v[78:79], v[100:101], v[102:103] neg_lo:[0,0,1] neg_hi:[0,0,1]
    v_pk_fma_f32 v[86:87], v[86:87], v[104:105], v[106:107] neg_lo:[0,0,1] neg_hi:[0,0,1]
    v_pk_fma_f32 v[94:95], v[94:95], v[108:109], v[110:111] neg_lo:[0,0,1] neg_hi:[0,0,1]
    v_cvt_pk_f16_f32 v44, v70, v78
    v_cvt_pk_f16_f32 v45, v86, v94
    ds_write_b64 v7, v[44:45] offset:20480
    v_cvt_pk_f16_f32 v46, v71, v79
    v_cvt_pk_f16_f32 v47, v87, v95
    ds_write_b64 v7, v[46:47] offset:28672
    s_waitcnt lgkmcnt(0)
    s_barrier
    ds_read_b128 v[112:115], v48 offset:0
    ds_read_b128 v[116:119], v49 offset:0
    ds_read_b128 v[120:123], v48 offset:2048
    ds_read_b128 v[124:127], v49 offset:2048
    ds_read_b128 v[128:131], v48 offset:4096
    ds_read_b128 v[132:135], v49 offset:4096
    ds_read_b128 v[136:139], v48 offset:6144
    ds_read_b128 v[140:143], v49 offset:6144
    s_waitcnt lgkmcnt(0)
    v_mfma_f32_16x16x32_f16 v[80:83], v[112:115], v[160:163], 0
    v_mfma_f32_16x16x32_f16 v[88:91], v[128:131], v[160:163], 0
    v_mfma_f32_16x16x32_f16 v[80:83], v[116:119], v[164:167], v[80:83]
    v_mfma_f32_16x16x32_f16 v[88:91], v[132:135], v[164:167], v[88:91]
    v_mfma_f32_16x16x32_f16 v[80:83], v[128:131], v[168:171], v[80:83]
    v_mfma_f32_16x16x32_f16 v[88:91], v[112:115], v[176:179], v[88:91]
    v_mfma_f32_16x16x32_f16 v[80:83], v[132:135], v[172:175], v[80:83]
    v_mfma_f32_16x16x32_f16 v[88:91], v[116:119], v[180:183], v[88:91]
    v_mfma_f32_16x16x32_f16 v[84:87], v[120:123], v[160:163], 0
    v_mfma_f32_16x16x32_f16 v[92:95], v[136:139], v[160:163], 0
    v_mfma_f32_16x16x32_f16 v[84:87], v[124:127], v[164:167], v[84:87]
    v_mfma_f32_16x16x32_f16 v[92:95], v[140:143], v[164:167], v[92:95]
    v_mfma_f32_16x16x32_f16 v[84:87], v[136:139], v[168:171], v[84:87]
    v_mfma_f32_16x16x32_f16 v[92:95], v[120:123], v[176:179], v[92:95]
    v_mfma_f32_16x16x32_f16 v[84:87], v[140:143], v[172:175], v[84:87]
    v_mfma_f32_16x16x32_f16 v[92:95], v[124:127], v[180:183], v[92:95]
    s_lshr_b32 s53, s3, 2
    s_lshl_b32 s53, s53, 8
    s_lshl_b32 s54, s51, 1
    s_add_u32 s53, s53, s54
    s_add_u32 s53, s53, 32768
    v_lshlrev_b32 v5, 4, v12
    v_lshl_add_u32 v5, v13, 11, v5
    v_add_u32 v5, s53, v5
    v_pk_mul_f32 v[40:41], v[80:81], v[184:185]
    v_pk_mul_f32 v[42:43], v[88:89], v[184:185]
    v_pk_fma_f32 v[40:41], v[88:89], v[192:193], v[40:41]
    v_pk_fma_f32 v[42:43], v[80:81], v[192:193], v[42:43] neg_lo:[1,0,0] neg_hi:[1,0,0]
    v_cvt_pk_f16_f32 v96, v40, v41
    v_cvt_pk_f16_f32 v100, v42, v43
    v_pk_mul_f32 v[44:45], v[82:83], v[186:187]
    v_pk_mul_f32 v[46:47], v[90:91], v[186:187]
    v_pk_fma_f32 v[44:45], v[90:91], v[194:195], v[44:45]
    v_pk_fma_f32 v[46:47], v[82:83], v[194:195], v[46:47] neg_lo:[1,0,0] neg_hi:[1,0,0]
    v_cvt_pk_f16_f32 v97, v44, v45
    v_cvt_pk_f16_f32 v101, v46, v47
    v_pk_mul_f32 v[40:41], v[84:85], v[188:189]
    v_pk_mul_f32 v[42:43], v[92:93], v[188:189]
    v_pk_fma_f32 v[40:41], v[92:93], v[196:197], v[40:41]
    v_pk_fma_f32 v[42:43], v[84:85], v[196:197], v[42:43] neg_lo:[1,0,0] neg_hi:[1,0,0]
    v_cvt_pk_f16_f32 v98, v40, v41
    v_cvt_pk_f16_f32 v102, v42, v43
    v_pk_mul_f32 v[44:45], v[86:87], v[190:191]
    v_pk_mul_f32 v[46:47], v[94:95], v[190:191]
    v_pk_fma_f32 v[44:45], v[94:95], v[198:199], v[44:45]
    v_pk_fma_f32 v[46:47], v[86:87], v[198:199], v[46:47] neg_lo:[1,0,0] neg_hi:[1,0,0]
    v_cvt_pk_f16_f32 v99, v44, v45
    v_cvt_pk_f16_f32 v103, v46, v47
    s_nop 1
    v_mfma_f32_16x16x32_f16 v[104:107], v[200:203], v[96:99], 0
    v_mfma_f32_16x16x32_f16 v[112:115], v[200:203], v[100:103], 0
    v_mfma_f32_16x16x32_f16 v[104:107], v[208:211], v[100:103], v[104:107]
    v_mfma_f32_16x16x32_f16 v[112:115], v[216:219], v[96:99], v[112:115]
    v_mfma_f32_16x16x32_f16 v[108:111], v[204:207], v[96:99], 0
    v_mfma_f32_16x16x32_f16 v[116:119], v[204:207], v[100:103], 0
    v_mfma_f32_16x16x32_f16 v[108:111], v[212:215], v[100:103], v[108:111]
    v_mfma_f32_16x16x32_f16 v[116:119], v[220:223], v[96:99], v[116:119]
    v_lshlrev_b32 v6, 4, v0
    v_add_u32 v7, 32768, v6
    v_and_b32 v8, 31, v0
    v_lshrrev_b32 v9, 5, v0
    s_lshr_b32 s54, s2, 7
    s_lshl_b32 s54, s54, 5
    v_add_u32 v8, s54, v8
    v_lshl_add_u32 v8, v9, 6, v8
    v_lshlrev_b32 v8, 4, v8
    s_mul_i32 s45, s40, 4718592
    s_add_u32 s45, s45, 18874368
    s_mul_i32 s46, s50, 32768
    s_add_u32 s45, s45, s46
    v_cvt_pk_f16_f32 v16, v104, v112
    v_cvt_pk_f16_f32 v17, v105, v113
    v_cvt_pk_f16_f32 v18, v106, v114
    v_cvt_pk_f16_f32 v19, v107, v115
    v_cvt_pk_f16_f32 v20, v108, v116
    v_cvt_pk_f16_f32 v21, v109, v117
    v_cvt_pk_f16_f32 v22, v110, v118
    v_cvt_pk_f16_f32 v23, v111, v119
    ds_write_b16 v5, v16 offset:0
    ds_write_b16_d16_hi v5, v16 offset:8
    ds_write_b16 v5, v17 offset:512
    ds_write_b16_d16_hi v5, v17 offset:520
    ds_write_b16 v5, v18 offset:1024
    ds_write_b16_d16_hi v5, v18 offset:1032
    ds_write_b16 v5, v19 offset:1536
    ds_write_b16_d16_hi v5, v19 offset:1544
    ds_write_b16 v5, v20 offset:8192
    ds_write_b16_d16_hi v5, v20 offset:8200
    ds_write_b16 v5, v21 offset:8704
    ds_write_b16_d16_hi v5, v21 offset:8712
    ds_write_b16 v5, v22 offset:9216
    ds_write_b16_d16_hi v5, v22 offset:9224
    ds_write_b16 v5, v23 offset:9728
    s_waitcnt lgkmcnt(14)
    ds_write_b16_d16_hi v5, v23 offset:9736
    s_waitcnt lgkmcnt(0)
    s_barrier
    ds_read_b128 v[24:27], v7
    ds_read_b128 v[28:31], v7 offset:8192
    s_add_u32 s46, s45, 16384
    s_waitcnt lgkmcnt(1)
    buffer_store_dwordx4 v[24:27], v8, s[28:31], s45 offen sc1
    s_waitcnt lgkmcnt(0)
    buffer_store_dwordx4 v[28:31], v8, s[28:31], s46 offen sc1
    s_add_u32 s41, s41, 16
    s_cmp_lg_u32 s3, 0
    s_waitcnt vmcnt(0) lgkmcnt(0)
    s_barrier
    s_cbranch_scc1 L_arr_170
    s_mov_b32 exec_lo, 0xff
    s_mov_b32 exec_hi, 0
    buffer_atomic_add v252, v250, s[28:31], s74 offen sc1
    s_mov_b64 exec, -1
L_arr_170:
    s_and_b32 s48, s2, 7
    s_lshl_b32 s48, s48, 4
    s_bfe_u32 s49, s2, 0x40003
    s_add_u32 s48, s48, s49
    s_sub_u32 s49, 255, s48
    s_cmp_ge_u32 s2, 128
    s_cselect_b32 s66, s49, s48
    s_mov_b32 s48, 327680
    v_lshlrev_b32 v2, 4, v1
    buffer_load_dwordx4 v[160:163], v2, s[28:31], s48 offen offset:0
    buffer_load_dwordx4 v[164:167], v2, s[28:31], s48 offen offset:1024
    buffer_load_dwordx4 v[168:171], v2, s[28:31], s48 offen offset:2048
    buffer_load_dwordx4 v[172:175], v2, s[28:31], s48 offen offset:3072
    s_add_u32 s48, s48, 4096
    buffer_load_dwordx4 v[176:179], v2, s[28:31], s48 offen offset:0
    buffer_load_dwordx4 v[180:183], v2, s[28:31], s48 offen offset:1024
    buffer_load_dwordx4 v[184:187], v2, s[28:31], s48 offen offset:2048
    buffer_load_dwordx4 v[188:191], v2, s[28:31], s48 offen offset:3072
    s_add_u32 s48, s48, 4096
    buffer_load_dwordx4 v[192:195], v2, s[28:31], s48 offen offset:0
    buffer_load_dwordx4 v[196:199], v2, s[28:31], s48 offen offset:1024
    buffer_load_dwordx4 v[200:203], v2, s[28:31], s48 offen offset:2048
    buffer_load_dwordx4 v[204:207], v2, s[28:31], s48 offen offset:3072
    s_add_u32 s48, s48, 4096
    buffer_load_dwordx4 v[208:211], v2, s[28:31], s48 offen offset:0
    buffer_load_dwordx4 v[212:215], v2, s[28:31], s48 offen offset:1024
    buffer_load_dwordx4 v[216:219], v2, s[28:31], s48 offen offset:2048
    buffer_load_dwordx4 v[220:223], v2, s[28:31], s48 offen offset:3072
    s_add_u32 s48, s48, 4096
    buffer_load_dwordx4 v[224:227], v2, s[28:31], s48 offen offset:0
    buffer_load_dwordx4 v[228:231], v2, s[28:31], s48 offen offset:1024
    v_lshrrev_b32 v4, 3, v1
    v_and_b32 v5, 7, v1
    s_lshl_b32 s48, s66, 3
    s_mul_i32 s49, s40, 4718592
    s_add_u32 s49, s49, 9437184
    s_mov_b32 s50, 32768
    v_mul_lo_u32 v8, v4, s50
    s_lshl_b32 s50, s3, 1
    s_add_u32 s50, s50, 0
    s_and_b32 s51, s50, 7
    v_xor_b32 v6, s51, v5
    v_add_u32 v6, s48, v6
    v_lshl_add_u32 v9, v6, 4, v8
    s_mul_i32 s52, s50, 262144
    s_add_u32 s52, s52, s49
    s_lshl_b32 s53, s50, 10
    s_add_u32 m0, s53, 32768
    s_nop 0
    buffer_load_dwordx4 v9, s[28:31], s52 offen lds
    s_lshl_b32 s50, s3, 1
    s_add_u32 s50, s50, 1
    s_and_b32 s51, s50, 7
    v_xor_b32 v6, s51, v5
    v_add_u32 v6, s48, v6
    v_lshl_add_u32 v9, v6, 4, v8
    s_mul_i32 s52, s50, 262144
    s_add_u32 s52, s52, s49
    s_lshl_b32 s53, s50, 10
    s_add_u32 m0, s53, 32768
    s_nop 0
    buffer_load_dwordx4 v9, s[28:31], s52 offen lds
    v_lshrrev_b32 v2, 3, v1
    v_and_b32 v3, 7, v1
    v_lshrrev_b32 v4, 4, v1
    s_lshl_b32 s44, s66, 3
    s_mul_i32 s45, s40, 4718592
    s_add_u32 s45, s45, 18874368
    s_mov_b32 s51, 32768
    v_mul_lo_u32 v8, v2, s51
    v_xor_b32 v5, v3, v4
    v_add_u32 v6, s44, v5
    v_sub_u32 v7, 0x800, v6
    v_and_b32 v7, 0x7ff, v7
    v_lshl_add_u32 v240, v6, 4, v8
    v_lshl_add_u32 v241, v7, 4, v8
    s_lshl_b32 s47, s3, 1
    s_add_u32 s47, s47, 0
    s_mul_i32 s48, s47, 262144
    s_add_u32 s76, s45, s48
    s_lshl_b32 s78, s47, 10
    v_xor_b32 v5, v3, v4
    v_xor_b32 v5, 4, v5
    v_add_u32 v6, s44, v5
    v_sub_u32 v7, 0x800, v6
    v_and_b32 v7, 0x7ff, v7
    v_lshl_add_u32 v242, v6, 4, v8
    v_lshl_add_u32 v243, v7, 4, v8
    s_lshl_b32 s47, s3, 1
    s_add_u32 s47, s47, 1
    s_mul_i32 s48, s47, 262144
    s_add_u32 s77, s45, s48
    s_lshl_b32 s79, s47, 10
    s_cmp_lg_u32 s3, 0
    s_cbranch_scc1 L_w_171
    s_mov_b32 s45, 0x100000
L_poll_172:
    buffer_load_dword v3, v251, s[28:31], s75 offen sc1
    s_sub_u32 s45, s45, 1
    s_cmp_eq_u32 s45, 0
    s_cbranch_scc1 L_pdone_173
    s_waitcnt vmcnt(0)
    v_cmp_gt_u32 vcc, s41, v3
    s_cbranch_vccnz L_poll_172
L_pdone_173:
L_w_171:
    s_barrier
    s_add_u32 m0, s78, 0
    s_nop 0
    buffer_load_dwordx4 v240, s[28:31], s76 offen lds
    s_add_u32 m0, s78, 16384
    s_nop 0
    buffer_load_dwordx4 v241, s[28:31], s76 offen lds
    s_add_u32 m0, s79, 0
    s_nop 0
    buffer_load_dwordx4 v242, s[28:31], s77 offen lds
    s_add_u32 m0, s79, 16384
    s_nop 0
    buffer_load_dwordx4 v243, s[28:31], s77 offen lds
    v_lshrrev_b32 v3, 5, v1
    v_bfe_u32 v4, v1, 2, 2
    v_bfe_u32 v5, v1, 4, 1
    v_and_b32 v6, 3, v1
    v_lshlrev_b32 v7, 13, v3
    v_lshl_add_u32 v7, v4, 10, v7
    v_lshl_add_u32 v7, v5, 9, v7
    v_lshl_add_u32 v7, v6, 7, v7
    v_lshrrev_b32 v8, 1, v6
    v_lshl_add_u32 v8, v5, 1, v8
    v_and_b32 v9, 1, v4
    v_lshl_add_u32 v8, v9, 2, v8
    v_xor_b32 v8, s3, v8
    v_lshl_add_u32 v7, v8, 4, v7
    v_and_b32 v8, 31, v1
    v_and_b32 v9, 15, v8
    v_lshlrev_b32 v9, 10, v9
    v_lshl_add_u32 v9, v3, 7, v9
    v_and_b32 v10, 7, v8
    v_xor_b32 v10, s3, v10
    v_lshl_add_u32 v9, v10, 4, v9
    v_lshrrev_b32 v10, 4, v8
    v_lshl_add_u32 v9, v10, 3, v9
    s_waitcnt vmcnt(0)
    s_barrier
    ds_read_b64_tr_b16 v[16:17], v7 offset:0
    ds_read_b64_tr_b16 v[18:19], v7 offset:4096
    ds_read_b64_tr_b16 v[20:21], v7 offset:8
    ds_read_b64_tr_b16 v[22:23], v7 offset:4104
    ds_read_b64_tr_b16 v[24:25], v7 offset:16384
    ds_read_b64_tr_b16 v[26:27], v7 offset:20480
    ds_read_b64_tr_b16 v[28:29], v7 offset:16392
    ds_read_b64_tr_b16 v[30:31], v7 offset:20488
    ds_read_b64 v[32:33], v9 offset:32768
    ds_read_b64 v[34:35], v9 offset:33024
    ds_read_b64 v[36:37], v9 offset:33280
    ds_read_b64 v[38:39], v9 offset:33536
    s_waitcnt lgkmcnt(4)
    v_mfma_f32_32x32x16_f16 v[48:63], v[16:19], v[160:163], 0
    v_mfma_f32_32x32x16_f16 v[64:79], v[16:19], v[164:167], 0
    v_mfma_f32_32x32x16_f16 v[48:63], v[20:23], v[168:171], v[48:63]
    v_mfma_f32_32x32x16_f16 v[64:79], v[20:23], v[160:163], v[64:79]
    v_mfma_f32_32x32x16_f16 v[48:63], v[24:27], v[172:175], v[48:63]
    v_mfma_f32_32x32x16_f16 v[64:79], v[24:27], v[176:179], v[64:79]
    v_mfma_f32_32x32x16_f16 v[48:63], v[28:31], v[176:179], v[48:63]
    v_mfma_f32_32x32x16_f16 v[64:79], v[28:31], v[180:183], v[64:79]
    s_nop 11
    v_pk_mul_f32 v[10:11], v[48:49], v[184:185]
    v_pk_mul_f32 v[12:13], v[64:65], v[184:185]
    v_pk_fma_f32 v[10:11], v[64:65], v[200:201], v[10:11]
    v_pk_fma_f32 v[12:13], v[48:49], v[200:201], v[12:13] neg_lo:[1,0,0] neg_hi:[1,0,0]
    v_cvt_pk_f16_f32 v80, v10, v11
    v_cvt_pk_f16_f32 v88, v12, v13
    v_pk_mul_f32 v[14:15], v[50:51], v[186:187]
    v_pk_mul_f32 v[16:17], v[66:67], v[186:187]
    v_pk_fma_f32 v[14:15], v[66:67], v[202:203], v[14:15]
    v_pk_fma_f32 v[16:17], v[50:51], v[202:203], v[16:17] neg_lo:[1,0,0] neg_hi:[1,0,0]
    v_cvt_pk_f16_f32 v81, v14, v15
    v_cvt_pk_f16_f32 v89, v16, v17
    v_pk_mul_f32 v[10:11], v[52:53], v[188:189]
    v_pk_mul_f32 v[12:13], v[68:69], v[188:189]
    v_pk_fma_f32 v[10:11], v[68:69], v[204:205], v[10:11]
    v_pk_fma_f32 v[12:13], v[52:53], v[204:205], v[12:13] neg_lo:[1,0,0] neg_hi:[1,0,0]
    v_cvt_pk_f16_f32 v82, v10, v11
    v_cvt_pk_f16_f32 v90, v12, v13
    v_pk_mul_f32 v[14:15], v[54:55], v[190:191]
    v_pk_mul_f32 v[16:17], v[70:71], v[190:191]
    v_pk_fma_f32 v[14:15], v[70:71], v[206:207], v[14:15]
    v_pk_fma_f32 v[16:17], v[54:55], v[206:207], v[16:17] neg_lo:[1,0,0] neg_hi:[1,0,0]
    v_cvt_pk_f16_f32 v83, v14, v15
    v_cvt_pk_f16_f32 v91, v16, v17
    v_pk_mul_f32 v[10:11], v[56:57], v[192:193]
    v_pk_mul_f32 v[12:13], v[72:73], v[192:193]
    v_pk_fma_f32 v[10:11], v[72:73], v[208:209], v[10:11]
    v_pk_fma_f32 v[12:13], v[56:57], v[208:209], v[12:13] neg_lo:[1,0,0] neg_hi:[1,0,0]
    v_cvt_pk_f16_f32 v84, v10, v11
    v_cvt_pk_f16_f32 v92, v12, v13
    v_pk_mul_f32 v[14:15], v[58:59], v[194:195]
    v_pk_mul_f32 v[16:17], v[74:75], v[194:195]
    v_pk_fma_f32 v[14:15], v[74:75], v[210:211], v[14:15]
    v_pk_fma_f32 v[16:17], v[58:59], v[210:211], v[16:17] neg_lo:[1,0,0] neg_hi:[1,0,0]
    v_cvt_pk_f16_f32 v85, v14, v15
    v_cvt_pk_f16_f32 v93, v16, v17
    v_pk_mul_f32 v[10:11], v[60:61], v[196:197]
    v_pk_mul_f32 v[12:13], v[76:77], v[196:197]
    v_pk_fma_f32 v[10:11], v[76:77], v[212:213], v[10:11]
    v_pk_fma_f32 v[12:13], v[60:61], v[212:213], v[12:13] neg_lo:[1,0,0] neg_hi:[1,0,0]
    v_cvt_pk_f16_f32 v86, v10, v11
    v_cvt_pk_f16_f32 v94, v12, v13
    v_pk_mul_f32 v[14:15], v[62:63], v[198:199]
    v_pk_mul_f32 v[16:17], v[78:79], v[198:199]
    v_pk_fma_f32 v[14:15], v[78:79], v[214:215], v[14:15]
    v_pk_fma_f32 v[16:17], v[62:63], v[214:215], v[16:17] neg_lo:[1,0,0] neg_hi:[1,0,0]
    v_cvt_pk_f16_f32 v87, v14, v15
    v_cvt_pk_f16_f32 v95, v16, v17
    s_nop 1
    v_mfma_f32_32x32x16_f16 v[96:111], v[80:83], v[216:219], 0
    v_mfma_f32_32x32x16_f16 v[96:111], v[88:91], v[224:227], v[96:111]
    v_mfma_f32_32x32x16_f16 v[96:111], v[84:87], v[220:223], v[96:111]
    v_mfma_f32_32x32x16_f16 v[96:111], v[92:95], v[228:231], v[96:111]
    s_waitcnt lgkmcnt(0)
    v_lshlrev_b32 v48, 16, v32
    v_and_b32 v49, 0xffff0000, v32
    v_lshlrev_b32 v50, 16, v33
    v_and_b32 v51, 0xffff0000, v33
    v_lshlrev_b32 v52, 16, v34
    v_and_b32 v53, 0xffff0000, v34
    v_lshlrev_b32 v54, 16, v35
    v_and_b32 v55, 0xffff0000, v35
    v_lshlrev_b32 v56, 16, v36
    v_and_b32 v57, 0xffff0000, v36
    v_lshlrev_b32 v58, 16, v37
    v_and_b32 v59, 0xffff0000, v37
    v_lshlrev_b32 v60, 16, v38
    v_and_b32 v61, 0xffff0000, v38
    v_lshlrev_b32 v62, 16, v39
    v_and_b32 v63, 0xffff0000, v39
    s_mov_b32 s46, 0x44000000
    s_mov_b32 s47, 0x44000000
    s_nop 5
    v_pk_fma_f32 v[96:97], v[96:97], s[46:47], v[48:49]
    v_pk_fma_f32 v[98:99], v[98:99], s[46:47], v[50:51]
    v_pk_fma_f32 v[100:101], v[100:101], s[46:47], v[52:53]
    v_pk_fma_f32 v[102:103], v[102:103], s[46:47], v[54:55]
    v_pk_fma_f32 v[104:105], v[104:105], s[46:47], v[56:57]
    v_pk_fma_f32 v[106:107], v[106:107], s[46:47], v[58:59]
    v_pk_fma_f32 v[108:109], v[108:109], s[46:47], v[60:61]
    v_pk_fma_f32 v[110:111], v[110:111], s[46:47], v[62:63]
    v_and_b32 v8, 31, v1
    v_lshlrev_b32 v4, 6, v8
    v_lshl_add_u32 v4, v3, 3, v4
    s_lshl_b32 s47, s3, 12
    s_add_u32 s47, s47, 49152
    v_add_u32 v4, s47, v4
    v_lshlrev_b32 v5, 4, v1
    v_add_u32 v6, s47, v5
    v_cvt_pk_bf16_f32 v16, v96, v97
    v_cvt_pk_bf16_f32 v17, v98, v99
    v_cvt_pk_bf16_f32 v18, v100, v101
    v_cvt_pk_bf16_f32 v19, v102, v103
    v_cvt_pk_bf16_f32 v20, v104, v105
    v_cvt_pk_bf16_f32 v21, v106, v107
    v_cvt_pk_bf16_f32 v22, v108, v109
    v_cvt_pk_bf16_f32 v23, v110, v111
    ds_write_b64 v4, v[16:17] offset:0
    ds_write_b64 v4, v[18:19] offset:16
    ds_write_b64 v4, v[20:21] offset:32
    ds_write_b64 v4, v[22:23] offset:48
    s_lshl_b32 s44, s66, 3
    s_add_u32 s44, s44, s3
    s_lshl_b32 s48, s44, 11
    s_cmp_lg_u32 s40, 0
    s_cbranch_scc1 L_k4_last_174
    s_waitcnt lgkmcnt(0)
    ds_read_b128 v[24:27], v6
    ds_read_b128 v[28:31], v6 offset:1024
    v_pk_add_f32 v[10:11], v[96:97], v[98:99]
    v_pk_mul_f32 v[12:13], v[96:97], v[96:97]
    v_pk_fma_f32 v[12:13], v[98:99], v[98:99], v[12:13]
    v_pk_add_f32 v[10:11], v[10:11], v[100:101]
    v_pk_fma_f32 v[12:13], v[100:101], v[100:101], v[12:13]
    v_pk_add_f32 v[10:11], v[10:11], v[102:103]
    v_pk_fma_f32 v[12:13], v[102:103], v[102:103], v[12:13]
    v_pk_add_f32 v[10:11], v[10:11], v[104:105]
    v_pk_fma_f32 v[12:13], v[104:105], v[104:105], v[12:13]
    v_pk_add_f32 v[10:11], v[10:11], v[106:107]
    v_pk_fma_f32 v[12:13], v[106:107], v[106:107], v[12:13]
    v_pk_add_f32 v[10:11], v[10:11], v[108:109]
    v_pk_fma_f32 v[12:13], v[108:109], v[108:109], v[12:13]
    v_pk_add_f32 v[10:11], v[10:11], v[110:111]
    v_pk_fma_f32 v[12:13], v[110:111], v[110:111], v[12:13]
    v_add_f32 v10, v10, v11
    v_add_f32 v11, v12, v13
    s_nop 1
    v_add_f32_dpp v10, v10, v10 quad_perm:[1,0,3,2] row_mask:0xf bank_mask:0xf
    v_add_f32_dpp v11, v11, v11 quad_perm:[1,0,3,2] row_mask:0xf bank_mask:0xf
    s_nop 1
    v_add_f32_dpp v10, v10, v10 quad_perm:[2,3,0,1] row_mask:0xf bank_mask:0xf
    v_add_f32_dpp v11, v11, v11 quad_perm:[2,3,0,1] row_mask:0xf bank_mask:0xf
    s_nop 1
    v_add_f32_dpp v10, v10, v10 row_half_mirror row_mask:0xf bank_mask:0xf
    v_add_f32_dpp v11, v11, v11 row_half_mirror row_mask:0xf bank_mask:0xf
    s_nop 1
    v_add_f32_dpp v10, v10, v10 row_mirror row_mask:0xf bank_mask:0xf
    v_add_f32_dpp v11, v11, v11 row_mirror row_mask:0xf bank_mask:0xf
    v_mov_b32 v14, v10
    v_mov_b32 v15, v11
    s_nop 1
    v_permlane16_swap_b32 v10, v14
    v_permlane16_swap_b32 v11, v15
    s_nop 1
    v_add_f32 v10, v10, v14
    v_add_f32 v11, v11, v15
    v_mov_b32 v14, v10
    v_mov_b32 v15, v11
    s_nop 1
    v_permlane32_swap_b32 v10, v14
    v_permlane32_swap_b32 v11, v15
    s_nop 1
    v_add_f32 v10, v10, v14
    v_add_f32 v11, v11, v15
    v_mul_f32 v10, 0x3a800000, v10
    v_mul_f32 v11, 0x3a800000, v11
    v_fma_f32 v11, -v10, v10, v11
    v_max_f32 v11, 0, v11
    v_add_f32 v11, 0x3727c5ac, v11
    v_rsq_f32 v11, v11
    s_nop 0
    v_mul_f32 v12, v10, v11
    v_mov_b32 v10, v11
    v_mov_b32 v13, v12
    s_nop 0
    v_pk_fma_f32 v[96:97], v[96:97], v[10:11], v[12:13] neg_lo:[0,0,1] neg_hi:[0,0,1]
    v_pk_fma_f32 v[98:99], v[98:99], v[10:11], v[12:13] neg_lo:[0,0,1] neg_hi:[0,0,1]
    v_pk_fma_f32 v[100:101], v[100:101], v[10:11], v[12:13] neg_lo:[0,0,1] neg_hi:[0,0,1]
    v_pk_fma_f32 v[102:103], v[102:103], v[10:11], v[12:13] neg_lo:[0,0,1] neg_hi:[0,0,1]
    v_pk_fma_f32 v[104:105], v[104:105], v[10:11], v[12:13] neg_lo:[0,0,1] neg_hi:[0,0,1]
    v_pk_fma_f32 v[106:107], v[106:107], v[10:11], v[12:13] neg_lo:[0,0,1] neg_hi:[0,0,1]
    v_pk_fma_f32 v[108:109], v[108:109], v[10:11], v[12:13] neg_lo:[0,0,1] neg_hi:[0,0,1]
    v_pk_fma_f32 v[110:111], v[110:111], v[10:11], v[12:13] neg_lo:[0,0,1] neg_hi:[0,0,1]
    s_waitcnt lgkmcnt(0)
    s_add_u32 s45, s48, 28311552
    buffer_store_dwordx4 v[24:27], v5, s[28:31], s45 offen sc1
    buffer_store_dwordx4 v[28:31], v5, s[28:31], s45 offen offset:1024 sc1
    v_cvt_pk_bf16_f32 v16, v96, v97
    v_cvt_pk_bf16_f32 v17, v98, v99
    v_cvt_pk_bf16_f32 v18, v100, v101
    v_cvt_pk_bf16_f32 v19, v102, v103
    v_cvt_pk_bf16_f32 v20, v104, v105
    v_cvt_pk_bf16_f32 v21, v106, v107
    v_cvt_pk_bf16_f32 v22, v108, v109
    v_cvt_pk_bf16_f32 v23, v110, v111
    ds_write_b64 v4, v[16:17] offset:2048
    ds_write_b64 v4, v[18:19] offset:2064
    ds_write_b64 v4, v[20:21] offset:2080
    ds_write_b64 v4, v[22:23] offset:2096
    s_bfe_u32 s47, s44, 0x30001
    v_and_b32 v2, 7, v1
    v_xor_b32 v2, s47, v2
    v_lshlrev_b32 v2, 4, v2
    v_lshrrev_b32 v3, 3, v1
    v_lshl_add_u32 v7, v3, 14, v2
    s_lshr_b32 s47, s44, 7
    s_lshl_b32 s47, s47, 18
    s_and_b32 s45, s44, 127
    s_lshl_b32 s45, s45, 7
    s_add_u32 s45, s45, s47
    s_add_u32 s45, s45, 36700160
    s_waitcnt lgkmcnt(0)
    ds_read_b128 v[32:35], v6 offset:2048
    ds_read_b128 v[36:39], v6 offset:3072
    s_waitcnt lgkmcnt(0)
    buffer_store_dwordx4 v[32:35], v7, s[28:31], s45 offen sc1
    s_add_u32 s45, s45, 131072
    buffer_store_dwordx4 v[36:39], v7, s[28:31], s45 offen sc1
    s_branch L_k4_end_175
L_k4_last_174:
    s_waitcnt lgkmcnt(0)
    ds_read_b128 v[24:27], v6
    ds_read_b128 v[28:31], v6 offset:1024
    s_waitcnt lgkmcnt(0)
    buffer_store_dwordx4 v[24:27], v5, s[32:35], s48 offen sc1
    buffer_store_dwordx4 v[28:31], v5, s[32:35], s48 offen offset:1024 sc1
L_k4_end_175:
    s_cmp_lg_u32 s40, 0
    s_cbranch_scc1 L_fin
    s_add_u32 s41, s41, 16
    s_cmp_lg_u32 s3, 0
    s_waitcnt vmcnt(0) lgkmcnt(0)
    s_barrier
    s_cbranch_scc1 L_arr_176
    s_mov_b32 exec_lo, 0xff
    s_mov_b32 exec_hi, 0
    buffer_atomic_add v252, v250, s[28:31], s74 offen sc1
    s_mov_b64 exec, -1
L_arr_176:
    s_mov_b32 s40, 1
    s_and_b32 s44, s2, 7
    s_lshr_b32 s45, s2, 3
    s_and_b32 s46, s44, 1
    s_lshl_b32 s46, s46, 3
    s_and_b32 s47, s45, 7
    s_add_u32 s42, s46, s47
    s_lshr_b32 s46, s44, 1
    s_lshl_b32 s46, s46, 2
    s_lshr_b32 s47, s45, 3
    s_add_u32 s43, s46, s47
    s_cmp_ge_u32 s3, 4
    s_cbranch_scc1 L_k1pl_177
    s_lshr_b32 s48, s3, 1
    s_and_b32 s49, s3, 1
    v_and_b32 v5, 15, v1
    v_lshrrev_b32 v6, 4, v1
    v_bfe_u32 v7, v1, 1, 3
    v_lshlrev_b32 v8, 7, v5
    s_lshl_b32 s50, s48, 13
    v_add_u32 v8, s50, v8
    v_add_u32 v9, 0, v6
    v_xor_b32 v9, v9, v7
    v_lshl_add_u32 v192, v9, 4, v8
    v_add_u32 v9, 4, v6
    v_xor_b32 v9, v9, v7
    v_lshl_add_u32 v193, v9, 4, v8
    v_lshlrev_b32 v9, 4, v1
    s_lshl_b32 s50, s49, 11
    s_add_u32 s50, s50, 65536
    v_add_u32 v194, s50, v9
    v_add_u32 v195, 49152, v194
    v_mov_b32 v16, 0
    v_mov_b32 v17, 0
    v_mov_b32 v18, 0
    v_mov_b32 v19, 0
    v_mov_b32 v20, 0
    v_mov_b32 v21, 0
    v_mov_b32 v22, 0
    v_mov_b32 v23, 0
    v_mov_b32 v24, 0
    v_mov_b32 v25, 0
    v_mov_b32 v26, 0
    v_mov_b32 v27, 0
    v_mov_b32 v28, 0
    v_mov_b32 v29, 0
    v_mov_b32 v30, 0
    v_mov_b32 v31, 0
    v_mov_b32 v32, 0
    v_mov_b32 v33, 0
    v_mov_b32 v34, 0
    v_mov_b32 v35, 0
    v_mov_b32 v36, 0
    v_mov_b32 v37, 0
    v_mov_b32 v38, 0
    v_mov_b32 v39, 0
    v_mov_b32 v40, 0
    v_mov_b32 v41, 0
    v_mov_b32 v42, 0
    v_mov_b32 v43, 0
    v_mov_b32 v44, 0
    v_mov_b32 v45, 0
    v_mov_b32 v46, 0
    v_mov_b32 v47, 0
    v_mov_b32 v48, 0
    v_mov_b32 v49, 0
    v_mov_b32 v50, 0
    v_mov_b32 v51, 0
    v_mov_b32 v52, 0
    v_mov_b32 v53, 0
    v_mov_b32 v54, 0
    v_mov_b32 v55, 0
    v_mov_b32 v56, 0
    v_mov_b32 v57, 0
    v_mov_b32 v58, 0
    v_mov_b32 v59, 0
    v_mov_b32 v60, 0
    v_mov_b32 v61, 0
    v_mov_b32 v62, 0
    v_mov_b32 v63, 0
    v_mov_b32 v64, 0
    v_mov_b32 v65, 0
    v_mov_b32 v66, 0
    v_mov_b32 v67, 0
    v_mov_b32 v68, 0
    v_mov_b32 v69, 0
    v_mov_b32 v70, 0
    v_mov_b32 v71, 0
    v_mov_b32 v72, 0
    v_mov_b32 v73, 0
    v_mov_b32 v74, 0
    v_mov_b32 v75, 0
    v_mov_b32 v76, 0
    v_mov_b32 v77, 0
    v_mov_b32 v78, 0
    v_mov_b32 v79, 0
    v_mov_b32 v80, 0
    v_mov_b32 v81, 0
    v_mov_b32 v82, 0
    v_mov_b32 v83, 0
    v_mov_b32 v84, 0
    v_mov_b32 v85, 0
    v_mov_b32 v86, 0
    v_mov_b32 v87, 0
    v_mov_b32 v88, 0
    v_mov_b32 v89, 0
    v_mov_b32 v90, 0
    v_mov_b32 v91, 0
    v_mov_b32 v92, 0
    v_mov_b32 v93, 0
    v_mov_b32 v94, 0
    v_mov_b32 v95, 0
    v_mov_b32 v96, 0
    v_mov_b32 v97, 0
    v_mov_b32 v98, 0
    v_mov_b32 v99, 0
    v_mov_b32 v100, 0
    v_mov_b32 v101, 0
    v_mov_b32 v102, 0
    v_mov_b32 v103, 0
    v_mov_b32 v104, 0
    v_mov_b32 v105, 0
    v_mov_b32 v106, 0
    v_mov_b32 v107, 0
    v_mov_b32 v108, 0
    v_mov_b32 v109, 0
    v_mov_b32 v110, 0
    v_mov_b32 v111, 0
    s_branch L_k1pd_178
L_k1pl_177:
    s_sub_u32 s48, s3, 4
    v_lshlrev_b32 v4, 4, v1
    s_mul_i32 s49, s40, 4194304
    s_add_u32 s49, s49, 32505856
    s_lshl_b32 s53, s42, 18
    s_add_u32 s49, s49, s53
    s_lshl_b32 s51, s48, 12
    s_add_u32 s49, s49, s51
    s_mul_i32 s50, s43, 393216
    s_mul_i32 s52, s48, 6144
    s_add_u32 s50, s50, s52
    s_add_u32 s50, s50, 40894464
    s_add_u32 s52, s52, 65536
    s_add_u32 m0, s52, 0
    s_add_u32 s53, s50, 4096
    buffer_load_dwordx4 v4, s[28:31], s50 offen offset:0 lds
    buffer_load_dwordx4 v4, s[28:31], s50 offen offset:1024 lds
    buffer_load_dwordx4 v4, s[28:31], s50 offen offset:2048 lds
    buffer_load_dwordx4 v4, s[28:31], s50 offen offset:3072 lds
    s_add_u32 m0, s52, 4096
    s_add_u32 s50, s50, 24576
    buffer_load_dwordx4 v4, s[28:31], s53 offen offset:0 lds
    buffer_load_dwordx4 v4, s[28:31], s53 offen offset:1024 lds
    s_add_u32 m0, s52, 24576
    s_add_u32 s53, s50, 4096
    buffer_load_dwordx4 v4, s[28:31], s50 offen offset:0 lds
    buffer_load_dwordx4 v4, s[28:31], s50 offen offset:1024 lds
    buffer_load_dwordx4 v4, s[28:31], s50 offen offset:2048 lds
    buffer_load_dwordx4 v4, s[28:31], s50 offen offset:3072 lds
    s_add_u32 m0, s52, 28672
    s_add_u32 s50, s50, 24576
    buffer_load_dwordx4 v4, s[28:31], s53 offen offset:0 lds
    buffer_load_dwordx4 v4, s[28:31], s53 offen offset:1024 lds
    s_add_u32 m0, s52, 49152
    s_add_u32 s53, s50, 4096
    buffer_load_dwordx4 v4, s[28:31], s50 offen offset:0 lds
    buffer_load_dwordx4 v4, s[28:31], s50 offen offset:1024 lds
    buffer_load_dwordx4 v4, s[28:31], s50 offen offset:2048 lds
    buffer_load_dwordx4 v4, s[28:31], s50 offen offset:3072 lds
    s_add_u32 m0, s52, 53248
    s_add_u32 s50, s50, 24576
    buffer_load_dwordx4 v4, s[28:31], s53 offen offset:0 lds
    buffer_load_dwordx4 v4, s[28:31], s53 offen offset:1024 lds
    s_add_u32 m0, s52, 73728
    s_add_u32 s53, s50, 4096
    buffer_load_dwordx4 v4, s[28:31], s50 offen offset:0 lds
    buffer_load_dwordx4 v4, s[28:31], s50 offen offset:1024 lds
    buffer_load_dwordx4 v4, s[28:31], s50 offen offset:2048 lds
    buffer_load_dwordx4 v4, s[28:31], s50 offen offset:3072 lds
    s_add_u32 m0, s52, 77824
    s_add_u32 s50, s50, 24576
    buffer_load_dwordx4 v4, s[28:31], s53 offen offset:0 lds
    buffer_load_dwordx4 v4, s[28:31], s53 offen offset:1024 lds
L_k1pd_178:
    s_cmp_lg_u32 s3, 0
    s_cbranch_scc1 L_w_179
    s_mov_b32 s45, 0x100000
L_poll_180:
    buffer_load_dword v3, v251, s[28:31], s75 offen sc1
    s_sub_u32 s45, s45, 1
    s_cmp_eq_u32 s45, 0
    s_cbranch_scc1 L_pdone_181
    s_waitcnt vmcnt(0)
    v_cmp_gt_u32 vcc, s41, v3
    s_cbranch_vccnz L_poll_180
L_pdone_181:
L_w_179:
    s_barrier
    s_cmp_ge_u32 s3, 4
    s_cbranch_scc1 L_k1_loader_182
    s_barrier
    ds_read_b128 v[112:115], v192 offset:0
    ds_read_b128 v[128:131], v194 offset:0
    ds_read_b128 v[132:135], v194 offset:1024
    ds_read_b128 v[136:139], v194 offset:4096
    ds_read_b128 v[140:143], v194 offset:5120
    ds_read_b128 v[144:147], v194 offset:8192
    ds_read_b128 v[148:151], v194 offset:9216
    ds_read_b128 v[116:119], v192 offset:2048
    ds_read_b128 v[120:123], v192 offset:4096
    ds_read_b128 v[124:127], v192 offset:6144
    s_mov_b32 s55, 3
L_k1c_184:
    s_waitcnt lgkmcnt(0)
    v_mfma_f32_16x16x32_bf16 v[16:19], v[128:131], v[112:115], v[16:19]
    ds_read_b128 v[152:155], v193 offset:0
    v_mfma_f32_16x16x32_bf16 v[32:35], v[132:135], v[112:115], v[32:35]
    ds_read_b128 v[168:171], v194 offset:12288
    v_mfma_f32_16x16x32_bf16 v[48:51], v[112:115], v[136:139], v[48:51]
    ds_read_b128 v[172:175], v194 offset:13312
    v_mfma_f32_16x16x32_bf16 v[52:55], v[112:115], v[140:143], v[52:55]
    ds_read_b128 v[176:179], v194 offset:16384
    v_mfma_f32_16x16x32_bf16 v[80:83], v[112:115], v[144:147], v[80:83]
    ds_read_b128 v[180:183], v194 offset:17408
    v_mfma_f32_16x16x32_bf16 v[84:87], v[112:115], v[148:151], v[84:87]
    ds_read_b128 v[184:187], v194 offset:20480
    v_mfma_f32_16x16x32_bf16 v[20:23], v[128:131], v[116:119], v[20:23]
    ds_read_b128 v[188:191], v194 offset:21504
    v_mfma_f32_16x16x32_bf16 v[36:39], v[132:135], v[116:119], v[36:39]
    ds_read_b128 v[156:159], v193 offset:2048
    v_mfma_f32_16x16x32_bf16 v[56:59], v[116:119], v[136:139], v[56:59]
    ds_read_b128 v[160:163], v193 offset:4096
    v_mfma_f32_16x16x32_bf16 v[60:63], v[116:119], v[140:143], v[60:63]
    ds_read_b128 v[164:167], v193 offset:6144
    v_mfma_f32_16x16x32_bf16 v[88:91], v[116:119], v[144:147], v[88:91]
    v_mfma_f32_16x16x32_bf16 v[92:95], v[116:119], v[148:151], v[92:95]
    v_mfma_f32_16x16x32_bf16 v[24:27], v[128:131], v[120:123], v[24:27]
    v_mfma_f32_16x16x32_bf16 v[40:43], v[132:135], v[120:123], v[40:43]
    v_mfma_f32_16x16x32_bf16 v[64:67], v[120:123], v[136:139], v[64:67]
    v_mfma_f32_16x16x32_bf16 v[68:71], v[120:123], v[140:143], v[68:71]
    v_mfma_f32_16x16x32_bf16 v[96:99], v[120:123], v[144:147], v[96:99]
    v_mfma_f32_16x16x32_bf16 v[100:103], v[120:123], v[148:151], v[100:103]
    v_mfma_f32_16x16x32_bf16 v[28:31], v[128:131], v[124:127], v[28:31]
    v_mfma_f32_16x16x32_bf16 v[44:47], v[132:135], v[124:127], v[44:47]
    v_mfma_f32_16x16x32_bf16 v[72:75], v[124:127], v[136:139], v[72:75]
    v_mfma_f32_16x16x32_bf16 v[76:79], v[124:127], v[140:143], v[76:79]
    v_mfma_f32_16x16x32_bf16 v[104:107], v[124:127], v[144:147], v[104:107]
    v_mfma_f32_16x16x32_bf16 v[108:111], v[124:127], v[148:151], v[108:111]
    s_waitcnt lgkmcnt(0)
    v_mfma_f32_16x16x32_bf16 v[16:19], v[168:171], v[152:155], v[16:19]
    v_mfma_f32_16x16x32_bf16 v[32:35], v[172:175], v[152:155], v[32:35]
    s_barrier
    ds_read_b128 v[112:115], v192 offset:16384
    v_mfma_f32_16x16x32_bf16 v[48:51], v[152:155], v[176:179], v[48:51]
    ds_read_b128 v[128:131], v194 offset:24576
    v_mfma_f32_16x16x32_bf16 v[52:55], v[152:155], v[180:183], v[52:55]
    ds_read_b128 v[132:135], v194 offset:25600
    v_mfma_f32_16x16x32_bf16 v[80:83], v[152:155], v[184:187], v[80:83]
    ds_read_b128 v[136:139], v194 offset:28672
    v_mfma_f32_16x16x32_bf16 v[84:87], v[152:155], v[188:191], v[84:87]
    ds_read_b128 v[140:143], v194 offset:29696
    v_mfma_f32_16x16x32_bf16 v[20:23], v[168:171], v[156:159], v[20:23]
    ds_read_b128 v[144:147], v194 offset:32768
    v_mfma_f32_16x16x32_bf16 v[36:39], v[172:175], v[156:159], v[36:39]
    ds_read_b128 v[148:151], v194 offset:33792
    v_mfma_f32_16x16x32_bf16 v[56:59], v[156:159], v[176:179], v[56:59]
    ds_read_b128 v[116:119], v192 offset:18432
    v_mfma_f32_16x16x32_bf16 v[60:63], v[156:159], v[180:183], v[60:63]
    ds_read_b128 v[120:123], v192 offset:20480
    v_mfma_f32_16x16x32_bf16 v[88:91], v[156:159], v[184:187], v[88:91]
    ds_read_b128 v[124:127], v192 offset:22528
    v_mfma_f32_16x16x32_bf16 v[92:95], v[156:159], v[188:191], v[92:95]
    v_mfma_f32_16x16x32_bf16 v[24:27], v[168:171], v[160:163], v[24:27]
    v_mfma_f32_16x16x32_bf16 v[40:43], v[172:175], v[160:163], v[40:43]
    v_mfma_f32_16x16x32_bf16 v[64:67], v[160:163], v[176:179], v[64:67]
    v_mfma_f32_16x16x32_bf16 v[68:71], v[160:163], v[180:183], v[68:71]
    v_mfma_f32_16x16x32_bf16 v[96:99], v[160:163], v[184:187], v[96:99]
    v_mfma_f32_16x16x32_bf16 v[100:103], v[160:163], v[188:191], v[100:103]
    v_mfma_f32_16x16x32_bf16 v[28:31], v[168:171], v[164:167], v[28:31]
    v_mfma_f32_16x16x32_bf16 v[44:47], v[172:175], v[164:167], v[44:47]
    v_mfma_f32_16x16x32_bf16 v[72:75], v[164:167], v[176:179], v[72:75]
    v_mfma_f32_16x16x32_bf16 v[76:79], v[164:167], v[180:183], v[76:79]
    v_mfma_f32_16x16x32_bf16 v[104:107], v[164:167], v[184:187], v[104:107]
    v_mfma_f32_16x16x32_bf16 v[108:111], v[164:167], v[188:191], v[108:111]
    s_waitcnt lgkmcnt(0)
    v_mfma_f32_16x16x32_bf16 v[16:19], v[128:131], v[112:115], v[16:19]
    ds_read_b128 v[152:155], v193 offset:16384
    v_mfma_f32_16x16x32_bf16 v[32:35], v[132:135], v[112:115], v[32:35]
    ds_read_b128 v[168:171], v194 offset:36864
    v_mfma_f32_16x16x32_bf16 v[48:51], v[112:115], v[136:139], v[48:51]
    ds_read_b128 v[172:175], v194 offset:37888
    v_mfma_f32_16x16x32_bf16 v[52:55], v[112:115], v[140:143], v[52:55]
    ds_read_b128 v[176:179], v194 offset:40960
    v_mfma_f32_16x16x32_bf16 v[80:83], v[112:115], v[144:147], v[80:83]
    ds_read_b128 v[180:183], v194 offset:41984
    v_mfma_f32_16x16x32_bf16 v[84:87], v[112:115], v[148:151], v[84:87]
    ds_read_b128 v[184:187], v194 offset:45056
    v_mfma_f32_16x16x32_bf16 v[20:23], v[128:131], v[116:119], v[20:23]
    ds_read_b128 v[188:191], v194 offset:46080
    v_mfma_f32_16x16x32_bf16 v[36:39], v[132:135], v[116:119], v[36:39]
    ds_read_b128 v[156:159], v193 offset:18432
    v_mfma_f32_16x16x32_bf16 v[56:59], v[116:119], v[136:139], v[56:59]
    ds_read_b128 v[160:163], v193 offset:20480
    v_mfma_f32_16x16x32_bf16 v[60:63], v[116:119], v[140:143], v[60:63]
    ds_read_b128 v[164:167], v193 offset:22528
    v_mfma_f32_16x16x32_bf16 v[88:91], v[116:119], v[144:147], v[88:91]
    v_mfma_f32_16x16x32_bf16 v[92:95], v[116:119], v[148:151], v[92:95]
    v_mfma_f32_16x16x32_bf16 v[24:27], v[128:131], v[120:123], v[24:27]
    v_mfma_f32_16x16x32_bf16 v[40:43], v[132:135], v[120:123], v[40:43]
    v_mfma_f32_16x16x32_bf16 v[64:67], v[120:123], v[136:139], v[64:67]
    v_mfma_f32_16x16x32_bf16 v[68:71], v[120:123], v[140:143], v[68:71]
    v_mfma_f32_16x16x32_bf16 v[96:99], v[120:123], v[144:147], v[96:99]
    v_mfma_f32_16x16x32_bf16 v[100:103], v[120:123], v[148:151], v[100:103]
    v_mfma_f32_16x16x32_bf16 v[28:31], v[128:131], v[124:127], v[28:31]
    v_mfma_f32_16x16x32_bf16 v[44:47], v[132:135], v[124:127], v[44:47]
    v_mfma_f32_16x16x32_bf16 v[72:75], v[124:127], v[136:139], v[72:75]
    v_mfma_f32_16x16x32_bf16 v[76:79], v[124:127], v[140:143], v[76:79]
    v_mfma_f32_16x16x32_bf16 v[104:107], v[124:127], v[144:147], v[104:107]
    v_mfma_f32_16x16x32_bf16 v[108:111], v[124:127], v[148:151], v[108:111]
    s_waitcnt lgkmcnt(0)
    v_mfma_f32_16x16x32_bf16 v[16:19], v[168:171], v[152:155], v[16:19]
    v_mfma_f32_16x16x32_bf16 v[32:35], v[172:175], v[152:155], v[32:35]
    s_barrier
    ds_read_b128 v[112:115], v192 offset:32768
    v_mfma_f32_16x16x32_bf16 v[48:51], v[152:155], v[176:179], v[48:51]
    ds_read_b128 v[128:131], v195 offset:0
    v_mfma_f32_16x16x32_bf16 v[52:55], v[152:155], v[180:183], v[52:55]
    ds_read_b128 v[132:135], v195 offset:1024
    v_mfma_f32_16x16x32_bf16 v[80:83], v[152:155], v[184:187], v[80:83]
    ds_read_b128 v[136:139], v195 offset:4096
    v_mfma_f32_16x16x32_bf16 v[84:87], v[152:155], v[188:191], v[84:87]
    ds_read_b128 v[140:143], v195 offset:5120
    v_mfma_f32_16x16x32_bf16 v[20:23], v[168:171], v[156:159], v[20:23]
    ds_read_b128 v[144:147], v195 offset:8192
    v_mfma_f32_16x16x32_bf16 v[36:39], v[172:175], v[156:159], v[36:39]
    ds_read_b128 v[148:151], v195 offset:9216
    v_mfma_f32_16x16x32_bf16 v[56:59], v[156:159], v[176:179], v[56:59]
    ds_read_b128 v[116:119], v192 offset:34816
    v_mfma_f32_16x16x32_bf16 v[60:63], v[156:159], v[180:183], v[60:63]
    ds_read_b128 v[120:123], v192 offset:36864
    v_mfma_f32_16x16x32_bf16 v[88:91], v[156:159], v[184:187], v[88:91]
    ds_read_b128 v[124:127], v192 offset:38912
    v_mfma_f32_16x16x32_bf16 v[92:95], v[156:159], v[188:191], v[92:95]
    v_mfma_f32_16x16x32_bf16 v[24:27], v[168:171], v[160:163], v[24:27]
    v_mfma_f32_16x16x32_bf16 v[40:43], v[172:175], v[160:163], v[40:43]
    v_mfma_f32_16x16x32_bf16 v[64:67], v[160:163], v[176:179], v[64:67]
    v_mfma_f32_16x16x32_bf16 v[68:71], v[160:163], v[180:183], v[68:71]
    v_mfma_f32_16x16x32_bf16 v[96:99], v[160:163], v[184:187], v[96:99]
    v_mfma_f32_16x16x32_bf16 v[100:103], v[160:163], v[188:191], v[100:103]
    v_mfma_f32_16x16x32_bf16 v[28:31], v[168:171], v[164:167], v[28:31]
    v_mfma_f32_16x16x32_bf16 v[44:47], v[172:175], v[164:167], v[44:47]
    v_mfma_f32_16x16x32_bf16 v[72:75], v[164:167], v[176:179], v[72:75]
    v_mfma_f32_16x16x32_bf16 v[76:79], v[164:167], v[180:183], v[76:79]
    v_mfma_f32_16x16x32_bf16 v[104:107], v[164:167], v[184:187], v[104:107]
    v_mfma_f32_16x16x32_bf16 v[108:111], v[164:167], v[188:191], v[108:111]
    s_waitcnt lgkmcnt(0)
    v_mfma_f32_16x16x32_bf16 v[16:19], v[128:131], v[112:115], v[16:19]
    ds_read_b128 v[152:155], v193 offset:32768
    v_mfma_f32_16x16x32_bf16 v[32:35], v[132:135], v[112:115], v[32:35]
    ds_read_b128 v[168:171], v195 offset:12288
    v_mfma_f32_16x16x32_bf16 v[48:51], v[112:115], v[136:139], v[48:51]
    ds_read_b128 v[172:175], v195 offset:13312
    v_mfma_f32_16x16x32_bf16 v[52:55], v[112:115], v[140:143], v[52:55]
    ds_read_b128 v[176:179], v195 offset:16384
    v_mfma_f32_16x16x32_bf16 v[80:83], v[112:115], v[144:147], v[80:83]
    ds_read_b128 v[180:183], v195 offset:17408
    v_mfma_f32_16x16x32_bf16 v[84:87], v[112:115], v[148:151], v[84:87]
    ds_read_b128 v[184:187], v195 offset:20480
    v_mfma_f32_16x16x32_bf16 v[20:23], v[128:131], v[116:119], v[20:23]
    ds_read_b128 v[188:191], v195 offset:21504
    v_mfma_f32_16x16x32_bf16 v[36:39], v[132:135], v[116:119], v[36:39]
    ds_read_b128 v[156:159], v193 offset:34816
    v_mfma_f32_16x16x32_bf16 v[56:59], v[116:119], v[136:139], v[56:59]
    ds_read_b128 v[160:163], v193 offset:36864
    v_mfma_f32_16x16x32_bf16 v[60:63], v[116:119], v[140:143], v[60:63]
    ds_read_b128 v[164:167], v193 offset:38912
    v_mfma_f32_16x16x32_bf16 v[88:91], v[116:119], v[144:147], v[88:91]
    v_mfma_f32_16x16x32_bf16 v[92:95], v[116:119], v[148:151], v[92:95]
    v_mfma_f32_16x16x32_bf16 v[24:27], v[128:131], v[120:123], v[24:27]
    v_mfma_f32_16x16x32_bf16 v[40:43], v[132:135], v[120:123], v[40:43]
    v_mfma_f32_16x16x32_bf16 v[64:67], v[120:123], v[136:139], v[64:67]
    v_mfma_f32_16x16x32_bf16 v[68:71], v[120:123], v[140:143], v[68:71]
    v_mfma_f32_16x16x32_bf16 v[96:99], v[120:123], v[144:147], v[96:99]
    v_mfma_f32_16x16x32_bf16 v[100:103], v[120:123], v[148:151], v[100:103]
    v_mfma_f32_16x16x32_bf16 v[28:31], v[128:131], v[124:127], v[28:31]
    v_mfma_f32_16x16x32_bf16 v[44:47], v[132:135], v[124:127], v[44:47]
    v_mfma_f32_16x16x32_bf16 v[72:75], v[124:127], v[136:139], v[72:75]
    v_mfma_f32_16x16x32_bf16 v[76:79], v[124:127], v[140:143], v[76:79]
    v_mfma_f32_16x16x32_bf16 v[104:107], v[124:127], v[144:147], v[104:107]
    v_mfma_f32_16x16x32_bf16 v[108:111], v[124:127], v[148:151], v[108:111]
    s_waitcnt lgkmcnt(0)
    v_mfma_f32_16x16x32_bf16 v[16:19], v[168:171], v[152:155], v[16:19]
    v_mfma_f32_16x16x32_bf16 v[32:35], v[172:175], v[152:155], v[32:35]
    s_barrier
    ds_read_b128 v[112:115], v192 offset:49152
    v_mfma_f32_16x16x32_bf16 v[48:51], v[152:155], v[176:179], v[48:51]
    ds_read_b128 v[128:131], v195 offset:24576
    v_mfma_f32_16x16x32_bf16 v[52:55], v[152:155], v[180:183], v[52:55]
    ds_read_b128 v[132:135], v195 offset:25600
    v_mfma_f32_16x16x32_bf16 v[80:83], v[152:155], v[184:187], v[80:83]
    ds_read_b128 v[136:139], v195 offset:28672
    v_mfma_f32_16x16x32_bf16 v[84:87], v[152:155], v[188:191], v[84:87]
    ds_read_b128 v[140:143], v195 offset:29696
    v_mfma_f32_16x16x32_bf16 v[20:23], v[168:171], v[156:159], v[20:23]
    ds_read_b128 v[144:147], v195 offset:32768
    v_mfma_f32_16x16x32_bf16 v[36:39], v[172:175], v[156:159], v[36:39]
    ds_read_b128 v[148:151], v195 offset:33792
    v_mfma_f32_16x16x32_bf16 v[56:59], v[156:159], v[176:179], v[56:59]
    ds_read_b128 v[116:119], v192 offset:51200
    v_mfma_f32_16x16x32_bf16 v[60:63], v[156:159], v[180:183], v[60:63]
    ds_read_b128 v[120:123], v192 offset:53248
    v_mfma_f32_16x16x32_bf16 v[88:91], v[156:159], v[184:187], v[88:91]
    ds_read_b128 v[124:127], v192 offset:55296
    v_mfma_f32_16x16x32_bf16 v[92:95], v[156:159], v[188:191], v[92:95]
    v_mfma_f32_16x16x32_bf16 v[24:27], v[168:171], v[160:163], v[24:27]
    v_mfma_f32_16x16x32_bf16 v[40:43], v[172:175], v[160:163], v[40:43]
    v_mfma_f32_16x16x32_bf16 v[64:67], v[160:163], v[176:179], v[64:67]
    v_mfma_f32_16x16x32_bf16 v[68:71], v[160:163], v[180:183], v[68:71]
    v_mfma_f32_16x16x32_bf16 v[96:99], v[160:163], v[184:187], v[96:99]
    v_mfma_f32_16x16x32_bf16 v[100:103], v[160:163], v[188:191], v[100:103]
    v_mfma_f32_16x16x32_bf16 v[28:31], v[168:171], v[164:167], v[28:31]
    v_mfma_f32_16x16x32_bf16 v[44:47], v[172:175], v[164:167], v[44:47]
    v_mfma_f32_16x16x32_bf16 v[72:75], v[164:167], v[176:179], v[72:75]
    v_mfma_f32_16x16x32_bf16 v[76:79], v[164:167], v[180:183], v[76:79]
    v_mfma_f32_16x16x32_bf16 v[104:107], v[164:167], v[184:187], v[104:107]
    v_mfma_f32_16x16x32_bf16 v[108:111], v[164:167], v[188:191], v[108:111]
    s_waitcnt lgkmcnt(0)
    v_mfma_f32_16x16x32_bf16 v[16:19], v[128:131], v[112:115], v[16:19]
    ds_read_b128 v[152:155], v193 offset:49152
    v_mfma_f32_16x16x32_bf16 v[32:35], v[132:135], v[112:115], v[32:35]
    ds_read_b128 v[168:171], v195 offset:36864
    v_mfma_f32_16x16x32_bf16 v[48:51], v[112:115], v[136:139], v[48:51]
    ds_read_b128 v[172:175], v195 offset:37888
    v_mfma_f32_16x16x32_bf16 v[52:55], v[112:115], v[140:143], v[52:55]
    ds_read_b128 v[176:179], v195 offset:40960
    v_mfma_f32_16x16x32_bf16 v[80:83], v[112:115], v[144:147], v[80:83]
    ds_read_b128 v[180:183], v195 offset:41984
    v_mfma_f32_16x16x32_bf16 v[84:87], v[112:115], v[148:151], v[84:87]
    ds_read_b128 v[184:187], v195 offset:45056
    v_mfma_f32_16x16x32_bf16 v[20:23], v[128:131], v[116:119], v[20:23]
    ds_read_b128 v[188:191], v195 offset:46080
    v_mfma_f32_16x16x32_bf16 v[36:39], v[132:135], v[116:119], v[36:39]
    ds_read_b128 v[156:159], v193 offset:51200
    v_mfma_f32_16x16x32_bf16 v[56:59], v[116:119], v[136:139], v[56:59]
    ds_read_b128 v[160:163], v193 offset:53248
    v_mfma_f32_16x16x32_bf16 v[60:63], v[116:119], v[140:143], v[60:63]
    ds_read_b128 v[164:167], v193 offset:55296
    v_mfma_f32_16x16x32_bf16 v[88:91], v[116:119], v[144:147], v[88:91]
    v_mfma_f32_16x16x32_bf16 v[92:95], v[116:119], v[148:151], v[92:95]
    v_mfma_f32_16x16x32_bf16 v[24:27], v[128:131], v[120:123], v[24:27]
    v_mfma_f32_16x16x32_bf16 v[40:43], v[132:135], v[120:123], v[40:43]
    v_mfma_f32_16x16x32_bf16 v[64:67], v[120:123], v[136:139], v[64:67]
    v_mfma_f32_16x16x32_bf16 v[68:71], v[120:123], v[140:143], v[68:71]
    v_mfma_f32_16x16x32_bf16 v[96:99], v[120:123], v[144:147], v[96:99]
    v_mfma_f32_16x16x32_bf16 v[100:103], v[120:123], v[148:151], v[100:103]
    v_mfma_f32_16x16x32_bf16 v[28:31], v[128:131], v[124:127], v[28:31]
    v_mfma_f32_16x16x32_bf16 v[44:47], v[132:135], v[124:127], v[44:47]
    v_mfma_f32_16x16x32_bf16 v[72:75], v[124:127], v[136:139], v[72:75]
    v_mfma_f32_16x16x32_bf16 v[76:79], v[124:127], v[140:143], v[76:79]
    v_mfma_f32_16x16x32_bf16 v[104:107], v[124:127], v[144:147], v[104:107]
    v_mfma_f32_16x16x32_bf16 v[108:111], v[124:127], v[148:151], v[108:111]
    s_waitcnt lgkmcnt(0)
    v_mfma_f32_16x16x32_bf16 v[16:19], v[168:171], v[152:155], v[16:19]
    v_mfma_f32_16x16x32_bf16 v[32:35], v[172:175], v[152:155], v[32:35]
    s_barrier
    ds_read_b128 v[112:115], v192 offset:0
    v_mfma_f32_16x16x32_bf16 v[48:51], v[152:155], v[176:179], v[48:51]
    ds_read_b128 v[128:131], v194 offset:0
    v_mfma_f32_16x16x32_bf16 v[52:55], v[152:155], v[180:183], v[52:55]
    ds_read_b128 v[132:135], v194 offset:1024
    v_mfma_f32_16x16x32_bf16 v[80:83], v[152:155], v[184:187], v[80:83]
    ds_read_b128 v[136:139], v194 offset:4096
    v_mfma_f32_16x16x32_bf16 v[84:87], v[152:155], v[188:191], v[84:87]
    ds_read_b128 v[140:143], v194 offset:5120
    v_mfma_f32_16x16x32_bf16 v[20:23], v[168:171], v[156:159], v[20:23]
    ds_read_b128 v[144:147], v194 offset:8192
    v_mfma_f32_16x16x32_bf16 v[36:39], v[172:175], v[156:159], v[36:39]
    ds_read_b128 v[148:151], v194 offset:9216
    v_mfma_f32_16x16x32_bf16 v[56:59], v[156:159], v[176:179], v[56:59]
    ds_read_b128 v[116:119], v192 offset:2048
    v_mfma_f32_16x16x32_bf16 v[60:63], v[156:159], v[180:183], v[60:63]
    ds_read_b128 v[120:123], v192 offset:4096
    v_mfma_f32_16x16x32_bf16 v[88:91], v[156:159], v[184:187], v[88:91]
    ds_read_b128 v[124:127], v192 offset:6144
    v_mfma_f32_16x16x32_bf16 v[92:95], v[156:159], v[188:191], v[92:95]
    v_mfma_f32_16x16x32_bf16 v[24:27], v[168:171], v[160:163], v[24:27]
    v_mfma_f32_16x16x32_bf16 v[40:43], v[172:175], v[160:163], v[40:43]
    v_mfma_f32_16x16x32_bf16 v[64:67], v[160:163], v[176:179], v[64:67]
    v_mfma_f32_16x16x32_bf16 v[68:71], v[160:163], v[180:183], v[68:71]
    v_mfma_f32_16x16x32_bf16 v[96:99], v[160:163], v[184:187], v[96:99]
    v_mfma_f32_16x16x32_bf16 v[100:103], v[160:163], v[188:191], v[100:103]
    v_mfma_f32_16x16x32_bf16 v[28:31], v[168:171], v[164:167], v[28:31]
    v_mfma_f32_16x16x32_bf16 v[44:47], v[172:175], v[164:167], v[44:47]
    v_mfma_f32_16x16x32_bf16 v[72:75], v[164:167], v[176:179], v[72:75]
    v_mfma_f32_16x16x32_bf16 v[76:79], v[164:167], v[180:183], v[76:79]
    v_mfma_f32_16x16x32_bf16 v[104:107], v[164:167], v[184:187], v[104:107]
    v_mfma_f32_16x16x32_bf16 v[108:111], v[164:167], v[188:191], v[108:111]
    s_sub_u32 s55, s55, 1
    s_cmp_lg_u32 s55, 0
    s_cbranch_scc1 L_k1c_184
    s_waitcnt lgkmcnt(0)
    v_mfma_f32_16x16x32_bf16 v[16:19], v[128:131], v[112:115], v[16:19]
    ds_read_b128 v[152:155], v193 offset:0
    v_mfma_f32_16x16x32_bf16 v[32:35], v[132:135], v[112:115], v[32:35]
    ds_read_b128 v[168:171], v194 offset:12288
    v_mfma_f32_16x16x32_bf16 v[48:51], v[112:115], v[136:139], v[48:51]
    ds_read_b128 v[172:175], v194 offset:13312
    v_mfma_f32_16x16x32_bf16 v[52:55], v[112:115], v[140:143], v[52:55]
    ds_read_b128 v[176:179], v194 offset:16384
    v_mfma_f32_16x16x32_bf16 v[80:83], v[112:115], v[144:147], v[80:83]
    ds_read_b128 v[180:183], v194 offset:17408
    v_mfma_f32_16x16x32_bf16 v[84:87], v[112:115], v[148:151], v[84:87]
    ds_read_b128 v[184:187], v194 offset:20480
    v_mfma_f32_16x16x32_bf16 v[20:23], v[128:131], v[116:119], v[20:23]
    ds_read_b128 v[188:191], v194 offset:21504
    v_mfma_f32_16x16x32_bf16 v[36:39], v[132:135], v[116:119], v[36:39]
    ds_read_b128 v[156:159], v193 offset:2048
    v_mfma_f32_16x16x32_bf16 v[56:59], v[116:119], v[136:139], v[56:59]
    ds_read_b128 v[160:163], v193 offset:4096
    v_mfma_f32_16x16x32_bf16 v[60:63], v[116:119], v[140:143], v[60:63]
    ds_read_b128 v[164:167], v193 offset:6144
    v_mfma_f32_16x16x32_bf16 v[88:91], v[116:119], v[144:147], v[88:91]
    v_mfma_f32_16x16x32_bf16 v[92:95], v[116:119], v[148:151], v[92:95]
    v_mfma_f32_16x16x32_bf16 v[24:27], v[128:131], v[120:123], v[24:27]
    v_mfma_f32_16x16x32_bf16 v[40:43], v[132:135], v[120:123], v[40:43]
    v_mfma_f32_16x16x32_bf16 v[64:67], v[120:123], v[136:139], v[64:67]
    v_mfma_f32_16x16x32_bf16 v[68:71], v[120:123], v[140:143], v[68:71]
    v_mfma_f32_16x16x32_bf16 v[96:99], v[120:123], v[144:147], v[96:99]
    v_mfma_f32_16x16x32_bf16 v[100:103], v[120:123], v[148:151], v[100:103]
    v_mfma_f32_16x16x32_bf16 v[28:31], v[128:131], v[124:127], v[28:31]
    v_mfma_f32_16x16x32_bf16 v[44:47], v[132:135], v[124:127], v[44:47]
    v_mfma_f32_16x16x32_bf16 v[72:75], v[124:127], v[136:139], v[72:75]
    v_mfma_f32_16x16x32_bf16 v[76:79], v[124:127], v[140:143], v[76:79]
    v_mfma_f32_16x16x32_bf16 v[104:107], v[124:127], v[144:147], v[104:107]
    v_mfma_f32_16x16x32_bf16 v[108:111], v[124:127], v[148:151], v[108:111]
    s_waitcnt lgkmcnt(0)
    v_mfma_f32_16x16x32_bf16 v[16:19], v[168:171], v[152:155], v[16:19]
    v_mfma_f32_16x16x32_bf16 v[32:35], v[172:175], v[152:155], v[32:35]
    s_barrier
    ds_read_b128 v[112:115], v192 offset:16384
    v_mfma_f32_16x16x32_bf16 v[48:51], v[152:155], v[176:179], v[48:51]
    ds_read_b128 v[128:131], v194 offset:24576
    v_mfma_f32_16x16x32_bf16 v[52:55], v[152:155], v[180:183], v[52:55]
    ds_read_b128 v[132:135], v194 offset:25600
    v_mfma_f32_16x16x32_bf16 v[80:83], v[152:155], v[184:187], v[80:83]
    ds_read_b128 v[136:139], v194 offset:28672
    v_mfma_f32_16x16x32_bf16 v[84:87], v[152:155], v[188:191], v[84:87]
    ds_read_b128 v[140:143], v194 offset:29696
    v_mfma_f32_16x16x32_bf16 v[20:23], v[168:171], v[156:159], v[20:23]
    ds_read_b128 v[144:147], v194 offset:32768
    v_mfma_f32_16x16x32_bf16 v[36:39], v[172:175], v[156:159], v[36:39]
    ds_read_b128 v[148:151], v194 offset:33792
    v_mfma_f32_16x16x32_bf16 v[56:59], v[156:159], v[176:179], v[56:59]
    ds_read_b128 v[116:119], v192 offset:18432
    v_mfma_f32_16x16x32_bf16 v[60:63], v[156:159], v[180:183], v[60:63]
    ds_read_b128 v[120:123], v192 offset:20480
    v_mfma_f32_16x16x32_bf16 v[88:91], v[156:159], v[184:187], v[88:91]
    ds_read_b128 v[124:127], v192 offset:22528
    v_mfma_f32_16x16x32_bf16 v[92:95], v[156:159], v[188:191], v[92:95]
    v_mfma_f32_16x16x32_bf16 v[24:27], v[168:171], v[160:163], v[24:27]
    v_mfma_f32_16x16x32_bf16 v[40:43], v[172:175], v[160:163], v[40:43]
    v_mfma_f32_16x16x32_bf16 v[64:67], v[160:163], v[176:179], v[64:67]
    v_mfma_f32_16x16x32_bf16 v[68:71], v[160:163], v[180:183], v[68:71]
    v_mfma_f32_16x16x32_bf16 v[96:99], v[160:163], v[184:187], v[96:99]
    v_mfma_f32_16x16x32_bf16 v[100:103], v[160:163], v[188:191], v[100:103]
    v_mfma_f32_16x16x32_bf16 v[28:31], v[168:171], v[164:167], v[28:31]
    v_mfma_f32_16x16x32_bf16 v[44:47], v[172:175], v[164:167], v[44:47]
    v_mfma_f32_16x16x32_bf16 v[72:75], v[164:167], v[176:179], v[72:75]
    v_mfma_f32_16x16x32_bf16 v[76:79], v[164:167], v[180:183], v[76:79]
    v_mfma_f32_16x16x32_bf16 v[104:107], v[164:167], v[184:187], v[104:107]
    v_mfma_f32_16x16x32_bf16 v[108:111], v[164:167], v[188:191], v[108:111]
    s_waitcnt lgkmcnt(0)
    v_mfma_f32_16x16x32_bf16 v[16:19], v[128:131], v[112:115], v[16:19]
    ds_read_b128 v[152:155], v193 offset:16384
    v_mfma_f32_16x16x32_bf16 v[32:35], v[132:135], v[112:115], v[32:35]
    ds_read_b128 v[168:171], v194 offset:36864
    v_mfma_f32_16x16x32_bf16 v[48:51], v[112:115], v[136:139], v[48:51]
    ds_read_b128 v[172:175], v194 offset:37888
    v_mfma_f32_16x16x32_bf16 v[52:55], v[112:115], v[140:143], v[52:55]
    ds_read_b128 v[176:179], v194 offset:40960
    v_mfma_f32_16x16x32_bf16 v[80:83], v[112:115], v[144:147], v[80:83]
    ds_read_b128 v[180:183], v194 offset:41984
    v_mfma_f32_16x16x32_bf16 v[84:87], v[112:115], v[148:151], v[84:87]
    ds_read_b128 v[184:187], v194 offset:45056
    v_mfma_f32_16x16x32_bf16 v[20:23], v[128:131], v[116:119], v[20:23]
    ds_read_b128 v[188:191], v194 offset:46080
    v_mfma_f32_16x16x32_bf16 v[36:39], v[132:135], v[116:119], v[36:39]
    ds_read_b128 v[156:159], v193 offset:18432
    v_mfma_f32_16x16x32_bf16 v[56:59], v[116:119], v[136:139], v[56:59]
    ds_read_b128 v[160:163], v193 offset:20480
    v_mfma_f32_16x16x32_bf16 v[60:63], v[116:119], v[140:143], v[60:63]
    ds_read_b128 v[164:167], v193 offset:22528
    v_mfma_f32_16x16x32_bf16 v[88:91], v[116:119], v[144:147], v[88:91]
    v_mfma_f32_16x16x32_bf16 v[92:95], v[116:119], v[148:151], v[92:95]
    v_mfma_f32_16x16x32_bf16 v[24:27], v[128:131], v[120:123], v[24:27]
    v_mfma_f32_16x16x32_bf16 v[40:43], v[132:135], v[120:123], v[40:43]
    v_mfma_f32_16x16x32_bf16 v[64:67], v[120:123], v[136:139], v[64:67]
    v_mfma_f32_16x16x32_bf16 v[68:71], v[120:123], v[140:143], v[68:71]
    v_mfma_f32_16x16x32_bf16 v[96:99], v[120:123], v[144:147], v[96:99]
    v_mfma_f32_16x16x32_bf16 v[100:103], v[120:123], v[148:151], v[100:103]
    v_mfma_f32_16x16x32_bf16 v[28:31], v[128:131], v[124:127], v[28:31]
    v_mfma_f32_16x16x32_bf16 v[44:47], v[132:135], v[124:127], v[44:47]
    v_mfma_f32_16x16x32_bf16 v[72:75], v[124:127], v[136:139], v[72:75]
    v_mfma_f32_16x16x32_bf16 v[76:79], v[124:127], v[140:143], v[76:79]
    v_mfma_f32_16x16x32_bf16 v[104:107], v[124:127], v[144:147], v[104:107]
    v_mfma_f32_16x16x32_bf16 v[108:111], v[124:127], v[148:151], v[108:111]
    s_waitcnt lgkmcnt(0)
    v_mfma_f32_16x16x32_bf16 v[16:19], v[168:171], v[152:155], v[16:19]
    v_mfma_f32_16x16x32_bf16 v[32:35], v[172:175], v[152:155], v[32:35]
    s_barrier
    ds_read_b128 v[112:115], v192 offset:32768
    v_mfma_f32_16x16x32_bf16 v[48:51], v[152:155], v[176:179], v[48:51]
    ds_read_b128 v[128:131], v195 offset:0
    v_mfma_f32_16x16x32_bf16 v[52:55], v[152:155], v[180:183], v[52:55]
    ds_read_b128 v[132:135], v195 offset:1024
    v_mfma_f32_16x16x32_bf16 v[80:83], v[152:155], v[184:187], v[80:83]
    ds_read_b128 v[136:139], v195 offset:4096
    v_mfma_f32_16x16x32_bf16 v[84:87], v[152:155], v[188:191], v[84:87]
    ds_read_b128 v[140:143], v195 offset:5120
    v_mfma_f32_16x16x32_bf16 v[20:23], v[168:171], v[156:159], v[20:23]
    ds_read_b128 v[144:147], v195 offset:8192
    v_mfma_f32_16x16x32_bf16 v[36:39], v[172:175], v[156:159], v[36:39]
    ds_read_b128 v[148:151], v195 offset:9216
    v_mfma_f32_16x16x32_bf16 v[56:59], v[156:159], v[176:179], v[56:59]
    ds_read_b128 v[116:119], v192 offset:34816
    v_mfma_f32_16x16x32_bf16 v[60:63], v[156:159], v[180:183], v[60:63]
    ds_read_b128 v[120:123], v192 offset:36864
    v_mfma_f32_16x16x32_bf16 v[88:91], v[156:159], v[184:187], v[88:91]
    ds_read_b128 v[124:127], v192 offset:38912
    v_mfma_f32_16x16x32_bf16 v[92:95], v[156:159], v[188:191], v[92:95]
    v_mfma_f32_16x16x32_bf16 v[24:27], v[168:171], v[160:163], v[24:27]
    v_mfma_f32_16x16x32_bf16 v[40:43], v[172:175], v[160:163], v[40:43]
    v_mfma_f32_16x16x32_bf16 v[64:67], v[160:163], v[176:179], v[64:67]
    v_mfma_f32_16x16x32_bf16 v[68:71], v[160:163], v[180:183], v[68:71]
    v_mfma_f32_16x16x32_bf16 v[96:99], v[160:163], v[184:187], v[96:99]
    v_mfma_f32_16x16x32_bf16 v[100:103], v[160:163], v[188:191], v[100:103]
    v_mfma_f32_16x16x32_bf16 v[28:31], v[168:171], v[164:167], v[28:31]
    v_mfma_f32_16x16x32_bf16 v[44:47], v[172:175], v[164:167], v[44:47]
    v_mfma_f32_16x16x32_bf16 v[72:75], v[164:167], v[176:179], v[72:75]
    v_mfma_f32_16x16x32_bf16 v[76:79], v[164:167], v[180:183], v[76:79]
    v_mfma_f32_16x16x32_bf16 v[104:107], v[164:167], v[184:187], v[104:107]
    v_mfma_f32_16x16x32_bf16 v[108:111], v[164:167], v[188:191], v[108:111]
    s_waitcnt lgkmcnt(0)
    v_mfma_f32_16x16x32_bf16 v[16:19], v[128:131], v[112:115], v[16:19]
    ds_read_b128 v[152:155], v193 offset:32768
    v_mfma_f32_16x16x32_bf16 v[32:35], v[132:135], v[112:115], v[32:35]
    ds_read_b128 v[168:171], v195 offset:12288
    v_mfma_f32_16x16x32_bf16 v[48:51], v[112:115], v[136:139], v[48:51]
    ds_read_b128 v[172:175], v195 offset:13312
    v_mfma_f32_16x16x32_bf16 v[52:55], v[112:115], v[140:143], v[52:55]
    ds_read_b128 v[176:179], v195 offset:16384
    v_mfma_f32_16x16x32_bf16 v[80:83], v[112:115], v[144:147], v[80:83]
    ds_read_b128 v[180:183], v195 offset:17408
    v_mfma_f32_16x16x32_bf16 v[84:87], v[112:115], v[148:151], v[84:87]
    ds_read_b128 v[184:187], v195 offset:20480
    v_mfma_f32_16x16x32_bf16 v[20:23], v[128:131], v[116:119], v[20:23]
    ds_read_b128 v[188:191], v195 offset:21504
    v_mfma_f32_16x16x32_bf16 v[36:39], v[132:135], v[116:119], v[36:39]
    ds_read_b128 v[156:159], v193 offset:34816
    v_mfma_f32_16x16x32_bf16 v[56:59], v[116:119], v[136:139], v[56:59]
    ds_read_b128 v[160:163], v193 offset:36864
    v_mfma_f32_16x16x32_bf16 v[60:63], v[116:119], v[140:143], v[60:63]
    ds_read_b128 v[164:167], v193 offset:38912
    v_mfma_f32_16x16x32_bf16 v[88:91], v[116:119], v[144:147], v[88:91]
    v_mfma_f32_16x16x32_bf16 v[92:95], v[116:119], v[148:151], v[92:95]
    v_mfma_f32_16x16x32_bf16 v[24:27], v[128:131], v[120:123], v[24:27]
    v_mfma_f32_16x16x32_bf16 v[40:43], v[132:135], v[120:123], v[40:43]
    v_mfma_f32_16x16x32_bf16 v[64:67], v[120:123], v[136:139], v[64:67]
    v_mfma_f32_16x16x32_bf16 v[68:71], v[120:123], v[140:143], v[68:71]
    v_mfma_f32_16x16x32_bf16 v[96:99], v[120:123], v[144:147], v[96:99]
    v_mfma_f32_16x16x32_bf16 v[100:103], v[120:123], v[148:151], v[100:103]
    v_mfma_f32_16x16x32_bf16 v[28:31], v[128:131], v[124:127], v[28:31]
    v_mfma_f32_16x16x32_bf16 v[44:47], v[132:135], v[124:127], v[44:47]
    v_mfma_f32_16x16x32_bf16 v[72:75], v[124:127], v[136:139], v[72:75]
    v_mfma_f32_16x16x32_bf16 v[76:79], v[124:127], v[140:143], v[76:79]
    v_mfma_f32_16x16x32_bf16 v[104:107], v[124:127], v[144:147], v[104:107]
    v_mfma_f32_16x16x32_bf16 v[108:111], v[124:127], v[148:151], v[108:111]
    s_waitcnt lgkmcnt(0)
    v_mfma_f32_16x16x32_bf16 v[16:19], v[168:171], v[152:155], v[16:19]
    v_mfma_f32_16x16x32_bf16 v[32:35], v[172:175], v[152:155], v[32:35]
    s_barrier
    ds_read_b128 v[112:115], v192 offset:49152
    v_mfma_f32_16x16x32_bf16 v[48:51], v[152:155], v[176:179], v[48:51]
    ds_read_b128 v[128:131], v195 offset:24576
    v_mfma_f32_16x16x32_bf16 v[52:55], v[152:155], v[180:183], v[52:55]
    ds_read_b128 v[132:135], v195 offset:25600
    v_mfma_f32_16x16x32_bf16 v[80:83], v[152:155], v[184:187], v[80:83]
    ds_read_b128 v[136:139], v195 offset:28672
    v_mfma_f32_16x16x32_bf16 v[84:87], v[152:155], v[188:191], v[84:87]
    ds_read_b128 v[140:143], v195 offset:29696
    v_mfma_f32_16x16x32_bf16 v[20:23], v[168:171], v[156:159], v[20:23]
    ds_read_b128 v[144:147], v195 offset:32768
    v_mfma_f32_16x16x32_bf16 v[36:39], v[172:175], v[156:159], v[36:39]
    ds_read_b128 v[148:151], v195 offset:33792
    v_mfma_f32_16x16x32_bf16 v[56:59], v[156:159], v[176:179], v[56:59]
    ds_read_b128 v[116:119], v192 offset:51200
    v_mfma_f32_16x16x32_bf16 v[60:63], v[156:159], v[180:183], v[60:63]
    ds_read_b128 v[120:123], v192 offset:53248
    v_mfma_f32_16x16x32_bf16 v[88:91], v[156:159], v[184:187], v[88:91]
    ds_read_b128 v[124:127], v192 offset:55296
    v_mfma_f32_16x16x32_bf16 v[92:95], v[156:159], v[188:191], v[92:95]
    v_mfma_f32_16x16x32_bf16 v[24:27], v[168:171], v[160:163], v[24:27]
    v_mfma_f32_16x16x32_bf16 v[40:43], v[172:175], v[160:163], v[40:43]
    v_mfma_f32_16x16x32_bf16 v[64:67], v[160:163], v[176:179], v[64:67]
    v_mfma_f32_16x16x32_bf16 v[68:71], v[160:163], v[180:183], v[68:71]
    v_mfma_f32_16x16x32_bf16 v[96:99], v[160:163], v[184:187], v[96:99]
    v_mfma_f32_16x16x32_bf16 v[100:103], v[160:163], v[188:191], v[100:103]
    v_mfma_f32_16x16x32_bf16 v[28:31], v[168:171], v[164:167], v[28:31]
    v_mfma_f32_16x16x32_bf16 v[44:47], v[172:175], v[164:167], v[44:47]
    v_mfma_f32_16x16x32_bf16 v[72:75], v[164:167], v[176:179], v[72:75]
    v_mfma_f32_16x16x32_bf16 v[76:79], v[164:167], v[180:183], v[76:79]
    v_mfma_f32_16x16x32_bf16 v[104:107], v[164:167], v[184:187], v[104:107]
    v_mfma_f32_16x16x32_bf16 v[108:111], v[164:167], v[188:191], v[108:111]
    s_waitcnt lgkmcnt(0)
    v_mfma_f32_16x16x32_bf16 v[16:19], v[128:131], v[112:115], v[16:19]
    ds_read_b128 v[152:155], v193 offset:49152
    v_mfma_f32_16x16x32_bf16 v[32:35], v[132:135], v[112:115], v[32:35]
    ds_read_b128 v[168:171], v195 offset:36864
    v_mfma_f32_16x16x32_bf16 v[48:51], v[112:115], v[136:139], v[48:51]
    ds_read_b128 v[172:175], v195 offset:37888
    v_mfma_f32_16x16x32_bf16 v[52:55], v[112:115], v[140:143], v[52:55]
    ds_read_b128 v[176:179], v195 offset:40960
    v_mfma_f32_16x16x32_bf16 v[80:83], v[112:115], v[144:147], v[80:83]
    ds_read_b128 v[180:183], v195 offset:41984
    v_mfma_f32_16x16x32_bf16 v[84:87], v[112:115], v[148:151], v[84:87]
    ds_read_b128 v[184:187], v195 offset:45056
    v_mfma_f32_16x16x32_bf16 v[20:23], v[128:131], v[116:119], v[20:23]
    ds_read_b128 v[188:191], v195 offset:46080
    v_mfma_f32_16x16x32_bf16 v[36:39], v[132:135], v[116:119], v[36:39]
    ds_read_b128 v[156:159], v193 offset:51200
    v_mfma_f32_16x16x32_bf16 v[56:59], v[116:119], v[136:139], v[56:59]
    ds_read_b128 v[160:163], v193 offset:53248
    v_mfma_f32_16x16x32_bf16 v[60:63], v[116:119], v[140:143], v[60:63]
    ds_read_b128 v[164:167], v193 offset:55296
    v_mfma_f32_16x16x32_bf16 v[88:91], v[116:119], v[144:147], v[88:91]
    v_mfma_f32_16x16x32_bf16 v[92:95], v[116:119], v[148:151], v[92:95]
    v_mfma_f32_16x16x32_bf16 v[24:27], v[128:131], v[120:123], v[24:27]
    v_mfma_f32_16x16x32_bf16 v[40:43], v[132:135], v[120:123], v[40:43]
    v_mfma_f32_16x16x32_bf16 v[64:67], v[120:123], v[136:139], v[64:67]
    v_mfma_f32_16x16x32_bf16 v[68:71], v[120:123], v[140:143], v[68:71]
    v_mfma_f32_16x16x32_bf16 v[96:99], v[120:123], v[144:147], v[96:99]
    v_mfma_f32_16x16x32_bf16 v[100:103], v[120:123], v[148:151], v[100:103]
    v_mfma_f32_16x16x32_bf16 v[28:31], v[128:131], v[124:127], v[28:31]
    v_mfma_f32_16x16x32_bf16 v[44:47], v[132:135], v[124:127], v[44:47]
    v_mfma_f32_16x16x32_bf16 v[72:75], v[124:127], v[136:139], v[72:75]
    v_mfma_f32_16x16x32_bf16 v[76:79], v[124:127], v[140:143], v[76:79]
    v_mfma_f32_16x16x32_bf16 v[104:107], v[124:127], v[144:147], v[104:107]
    v_mfma_f32_16x16x32_bf16 v[108:111], v[124:127], v[148:151], v[108:111]
    s_waitcnt lgkmcnt(0)
    v_mfma_f32_16x16x32_bf16 v[16:19], v[168:171], v[152:155], v[16:19]
    v_mfma_f32_16x16x32_bf16 v[32:35], v[172:175], v[152:155], v[32:35]
    v_mfma_f32_16x16x32_bf16 v[48:51], v[152:155], v[176:179], v[48:51]
    v_mfma_f32_16x16x32_bf16 v[52:55], v[152:155], v[180:183], v[52:55]
    v_mfma_f32_16x16x32_bf16 v[80:83], v[152:155], v[184:187], v[80:83]
    v_mfma_f32_16x16x32_bf16 v[84:87], v[152:155], v[188:191], v[84:87]
    v_mfma_f32_16x16x32_bf16 v[20:23], v[168:171], v[156:159], v[20:23]
    v_mfma_f32_16x16x32_bf16 v[36:39], v[172:175], v[156:159], v[36:39]
    v_mfma_f32_16x16x32_bf16 v[56:59], v[156:159], v[176:179], v[56:59]
    v_mfma_f32_16x16x32_bf16 v[60:63], v[156:159], v[180:183], v[60:63]
    v_mfma_f32_16x16x32_bf16 v[88:91], v[156:159], v[184:187], v[88:91]
    v_mfma_f32_16x16x32_bf16 v[92:95], v[156:159], v[188:191], v[92:95]
    v_mfma_f32_16x16x32_bf16 v[24:27], v[168:171], v[160:163], v[24:27]
    v_mfma_f32_16x16x32_bf16 v[40:43], v[172:175], v[160:163], v[40:43]
    v_mfma_f32_16x16x32_bf16 v[64:67], v[160:163], v[176:179], v[64:67]
    v_mfma_f32_16x16x32_bf16 v[68:71], v[160:163], v[180:183], v[68:71]
    v_mfma_f32_16x16x32_bf16 v[96:99], v[160:163], v[184:187], v[96:99]
    v_mfma_f32_16x16x32_bf16 v[100:103], v[160:163], v[188:191], v[100:103]
    v_mfma_f32_16x16x32_bf16 v[28:31], v[168:171], v[164:167], v[28:31]
    v_mfma_f32_16x16x32_bf16 v[44:47], v[172:175], v[164:167], v[44:47]
    v_mfma_f32_16x16x32_bf16 v[72:75], v[164:167], v[176:179], v[72:75]
    v_mfma_f32_16x16x32_bf16 v[76:79], v[164:167], v[180:183], v[76:79]
    v_mfma_f32_16x16x32_bf16 v[104:107], v[164:167], v[184:187], v[104:107]
    v_mfma_f32_16x16x32_bf16 v[108:111], v[164:167], v[188:191], v[108:111]
    v_lshlrev_b32 v14, 4, v1
    s_lshl_b32 s50, s3, 13
    s_add_u32 s50, s50, 65536
    v_add_u32 v9, s50, v14
    s_nop 4
    ds_write_b128 v9, v[16:19] offset:0
    ds_write_b128 v9, v[20:23] offset:1024
    ds_write_b128 v9, v[24:27] offset:2048
    ds_write_b128 v9, v[28:31] offset:3072
    ds_write_b128 v9, v[32:35] offset:4096
    ds_write_b128 v9, v[36:39] offset:5120
    ds_write_b128 v9, v[40:43] offset:6144
    ds_write_b128 v9, v[44:47] offset:7168
    s_waitcnt lgkmcnt(0)
    s_barrier
    s_mov_b32 s68, 1069066811
    s_mov_b32 s69, 1069066811
    v_mov_b32 v10, 0x358637bd
    v_mov_b32 v11, 0x358637bd
    v_pk_mul_f32 v[12:13], v[48:49], s[68:69]
    v_pk_add_f32 v[48:49], v[48:49], v[10:11]
    v_exp_f32 v12, v12 clamp
    v_exp_f32 v13, v13 clamp
    v_max_f32 v48, v48, v11
    v_max_f32 v49, v49, v11
    v_pk_add_f32 v[48:49], v[48:49], v[12:13]
    v_cvt_pk_bf16_f32 v112, v48, v49
    v_pk_mul_f32 v[2:3], v[50:51], s[68:69]
    v_pk_add_f32 v[50:51], v[50:51], v[10:11]
    v_exp_f32 v2, v2 clamp
    v_exp_f32 v3, v3 clamp
    v_max_f32 v50, v50, v11
    v_max_f32 v51, v51, v11
    v_pk_add_f32 v[50:51], v[50:51], v[2:3]
    v_cvt_pk_bf16_f32 v113, v50, v51
    v_pk_mul_f32 v[12:13], v[56:57], s[68:69]
    v_pk_add_f32 v[56:57], v[56:57], v[10:11]
    v_exp_f32 v12, v12 clamp
    v_exp_f32 v13, v13 clamp
    v_max_f32 v56, v56, v11
    v_max_f32 v57, v57, v11
    v_pk_add_f32 v[56:57], v[56:57], v[12:13]
    v_cvt_pk_bf16_f32 v114, v56, v57
    v_pk_mul_f32 v[2:3], v[58:59], s[68:69]
    v_pk_add_f32 v[58:59], v[58:59], v[10:11]
    v_exp_f32 v2, v2 clamp
    v_exp_f32 v3, v3 clamp
    v_max_f32 v58, v58, v11
    v_max_f32 v59, v59, v11
    v_pk_add_f32 v[58:59], v[58:59], v[2:3]
    v_cvt_pk_bf16_f32 v115, v58, v59
    v_pk_mul_f32 v[12:13], v[64:65], s[68:69]
    v_pk_add_f32 v[64:65], v[64:65], v[10:11]
    v_exp_f32 v12, v12 clamp
    v_exp_f32 v13, v13 clamp
    v_max_f32 v64, v64, v11
    v_max_f32 v65, v65, v11
    v_pk_add_f32 v[64:65], v[64:65], v[12:13]
    v_cvt_pk_bf16_f32 v116, v64, v65
    v_pk_mul_f32 v[2:3], v[66:67], s[68:69]
    v_pk_add_f32 v[66:67], v[66:67], v[10:11]
    v_exp_f32 v2, v2 clamp
    v_exp_f32 v3, v3 clamp
    v_max_f32 v66, v66, v11
    v_max_f32 v67, v67, v11
    v_pk_add_f32 v[66:67], v[66:67], v[2:3]
    v_cvt_pk_bf16_f32 v117, v66, v67
    v_pk_mul_f32 v[12:13], v[72:73], s[68:69]
    v_pk_add_f32 v[72:73], v[72:73], v[10:11]
    v_exp_f32 v12, v12 clamp
    v_exp_f32 v13, v13 clamp
    v_max_f32 v72, v72, v11
    v_max_f32 v73, v73, v11
    v_pk_add_f32 v[72:73], v[72:73], v[12:13]
    v_cvt_pk_bf16_f32 v118, v72, v73
    v_pk_mul_f32 v[2:3], v[74:75], s[68:69]
    v_pk_add_f32 v[74:75], v[74:75], v[10:11]
    v_exp_f32 v2, v2 clamp
    v_exp_f32 v3, v3 clamp
    v_max_f32 v74, v74, v11
    v_max_f32 v75, v75, v11
    v_pk_add_f32 v[74:75], v[74:75], v[2:3]
    v_cvt_pk_bf16_f32 v119, v74, v75
    v_pk_mul_f32 v[12:13], v[52:53], s[68:69]
    v_pk_add_f32 v[52:53], v[52:53], v[10:11]
    v_exp_f32 v12, v12 clamp
    v_exp_f32 v13, v13 clamp
    v_max_f32 v52, v52, v11
    v_max_f32 v53, v53, v11
    v_pk_add_f32 v[52:53], v[52:53], v[12:13]
    v_cvt_pk_bf16_f32 v120, v52, v53
    v_pk_mul_f32 v[2:3], v[54:55], s[68:69]
    v_pk_add_f32 v[54:55], v[54:55], v[10:11]
    v_exp_f32 v2, v2 clamp
    v_exp_f32 v3, v3 clamp
    v_max_f32 v54, v54, v11
    v_max_f32 v55, v55, v11
    v_pk_add_f32 v[54:55], v[54:55], v[2:3]
    v_cvt_pk_bf16_f32 v121, v54, v55
    v_pk_mul_f32 v[12:13], v[60:61], s[68:69]
    v_pk_add_f32 v[60:61], v[60:61], v[10:11]
    v_exp_f32 v12, v12 clamp
    v_exp_f32 v13, v13 clamp
    v_max_f32 v60, v60, v11
    v_max_f32 v61, v61, v11
    v_pk_add_f32 v[60:61], v[60:61], v[12:13]
    v_cvt_pk_bf16_f32 v122, v60, v61
    v_pk_mul_f32 v[2:3], v[62:63], s[68:69]
    v_pk_add_f32 v[62:63], v[62:63], v[10:11]
    v_exp_f32 v2, v2 clamp
    v_exp_f32 v3, v3 clamp
    v_max_f32 v62, v62, v11
    v_max_f32 v63, v63, v11
    v_pk_add_f32 v[62:63], v[62:63], v[2:3]
    v_cvt_pk_bf16_f32 v123, v62, v63
    v_pk_mul_f32 v[12:13], v[68:69], s[68:69]
    v_pk_add_f32 v[68:69], v[68:69], v[10:11]
    v_exp_f32 v12, v12 clamp
    v_exp_f32 v13, v13 clamp
    v_max_f32 v68, v68, v11
    v_max_f32 v69, v69, v11
    v_pk_add_f32 v[68:69], v[68:69], v[12:13]
    v_cvt_pk_bf16_f32 v124, v68, v69
    v_pk_mul_f32 v[2:3], v[70:71], s[68:69]
    v_pk_add_f32 v[70:71], v[70:71], v[10:11]
    v_exp_f32 v2, v2 clamp
    v_exp_f32 v3, v3 clamp
    v_max_f32 v70, v70, v11
    v_max_f32 v71, v71, v11
    v_pk_add_f32 v[70:71], v[70:71], v[2:3]
    v_cvt_pk_bf16_f32 v125, v70, v71
    v_pk_mul_f32 v[12:13], v[76:77], s[68:69]
    v_pk_add_f32 v[76:77], v[76:77], v[10:11]
    v_exp_f32 v12, v12 clamp
    v_exp_f32 v13, v13 clamp
    v_max_f32 v76, v76, v11
    v_max_f32 v77, v77, v11
    v_pk_add_f32 v[76:77], v[76:77], v[12:13]
    v_cvt_pk_bf16_f32 v126, v76, v77
    v_pk_mul_f32 v[2:3], v[78:79], s[68:69]
    v_pk_add_f32 v[78:79], v[78:79], v[10:11]
    v_exp_f32 v2, v2 clamp
    v_exp_f32 v3, v3 clamp
    v_max_f32 v78, v78, v11
    v_max_f32 v79, v79, v11
    v_pk_add_f32 v[78:79], v[78:79], v[2:3]
    v_cvt_pk_bf16_f32 v127, v78, v79
    v_cvt_pk_bf16_f32 v128, v80, v81
    v_cvt_pk_bf16_f32 v129, v82, v83
    v_cvt_pk_bf16_f32 v130, v88, v89
    v_cvt_pk_bf16_f32 v131, v90, v91
    v_cvt_pk_bf16_f32 v132, v96, v97
    v_cvt_pk_bf16_f32 v133, v98, v99
    v_cvt_pk_bf16_f32 v134, v104, v105
    v_cvt_pk_bf16_f32 v135, v106, v107
    v_cvt_pk_bf16_f32 v136, v84, v85
    v_cvt_pk_bf16_f32 v137, v86, v87
    v_cvt_pk_bf16_f32 v138, v92, v93
    v_cvt_pk_bf16_f32 v139, v94, v95
    v_cvt_pk_bf16_f32 v140, v100, v101
    v_cvt_pk_bf16_f32 v141, v102, v103
    v_cvt_pk_bf16_f32 v142, v108, v109
    v_cvt_pk_bf16_f32 v143, v110, v111
    v_mov_b32 v144, 0x3f803f80
    v_mov_b32 v145, 0x3f803f80
    v_mov_b32 v146, 0x3f803f80
    v_mov_b32 v147, 0x3f803f80
    s_nop 1
    v_mfma_f32_16x16x32_bf16 v[148:151], v[112:115], v[128:131], 0
    v_mfma_f32_16x16x32_bf16 v[152:155], v[112:115], v[136:139], 0
    v_mfma_f32_16x16x32_bf16 v[164:167], v[144:147], v[112:115], 0
    v_mfma_f32_16x16x32_bf16 v[156:159], v[120:123], v[128:131], 0
    v_mfma_f32_16x16x32_bf16 v[160:163], v[120:123], v[136:139], 0
    v_mfma_f32_16x16x32_bf16 v[168:171], v[144:147], v[120:123], 0
    v_mfma_f32_16x16x32_bf16 v[148:151], v[116:119], v[132:135], v[148:151]
    v_mfma_f32_16x16x32_bf16 v[152:155], v[116:119], v[140:143], v[152:155]
    v_mfma_f32_16x16x32_bf16 v[164:167], v[144:147], v[116:119], v[164:167]
    v_mfma_f32_16x16x32_bf16 v[156:159], v[124:127], v[132:135], v[156:159]
    v_mfma_f32_16x16x32_bf16 v[160:163], v[124:127], v[140:143], v[160:163]
    v_mfma_f32_16x16x32_bf16 v[168:171], v[144:147], v[124:127], v[168:171]
    s_lshl_b32 s52, s43, 1
    s_add_u32 s52, s52, s49
    v_lshlrev_b32 v14, 4, v1
    s_mul_i32 s50, s49, 5120
    v_add_u32 v9, s50, v14
    v_lshlrev_b32 v15, 2, v1
    v_add_u32 v10, s50, v15
    v_cmp_gt_u32 vcc, 16, v1
    s_nop 4
    v_cndmask_b32 v164, v168, v164, vcc
    s_cmp_eq_u32 s48, 0
    s_cbranch_scc1 L_kvw_185
    ds_write_b128 v9, v[148:151] offset:0
    ds_write_b128 v9, v[152:155] offset:1024
    ds_write_b128 v9, v[156:159] offset:2048
    ds_write_b128 v9, v[160:163] offset:3072
    ds_write_b32 v10, v164 offset:4096
    s_waitcnt lgkmcnt(0)
L_kvw_185:
    s_barrier
    s_cmp_lg_u32 s48, 0
    s_cbranch_scc1 L_kvr_186
    ds_read_b128 v[180:183], v9 offset:0
    ds_read_b128 v[184:187], v9 offset:1024
    ds_read_b128 v[188:191], v9 offset:2048
    ds_read_b128 v[192:195], v9 offset:3072
    ds_read_b32 v196, v10 offset:4096
    s_mul_i32 s53, s40, 65536
    s_add_u32 s53, s53, 32768
    s_lshl_b32 s50, s52, 11
    s_add_u32 s50, s50, s53
    s_waitcnt lgkmcnt(0)
    v_pk_add_f32 v[148:149], v[148:149], v[180:181]
    v_pk_add_f32 v[150:151], v[150:151], v[182:183]
    v_pk_add_f32 v[152:153], v[152:153], v[184:185]
    v_pk_add_f32 v[154:155], v[154:155], v[186:187]
    v_pk_add_f32 v[156:157], v[156:157], v[188:189]
    v_pk_add_f32 v[158:159], v[158:159], v[190:191]
    v_pk_add_f32 v[160:161], v[160:161], v[192:193]
    v_pk_add_f32 v[162:163], v[162:163], v[194:195]
    v_add_f32 v164, v164, v196
    v_cvt_pk_bf16_f32 v180, v148, v149
    v_cvt_pk_bf16_f32 v181, v150, v151
    v_cvt_pk_bf16_f32 v182, v156, v157
    v_cvt_pk_bf16_f32 v183, v158, v159
    v_cvt_pk_bf16_f32 v184, v152, v153
    v_cvt_pk_bf16_f32 v185, v154, v155
    v_cvt_pk_bf16_f32 v186, v160, v161
    v_cvt_pk_bf16_f32 v187, v162, v163
    buffer_atomic_pk_add_bf16 v180, v15, s[28:31], s50 offen offset:0
    buffer_atomic_pk_add_bf16 v181, v15, s[28:31], s50 offen offset:256
    buffer_atomic_pk_add_bf16 v182, v15, s[28:31], s50 offen offset:512
    buffer_atomic_pk_add_bf16 v183, v15, s[28:31], s50 offen offset:768
    buffer_atomic_pk_add_bf16 v184, v15, s[28:31], s50 offen offset:1024
    buffer_atomic_pk_add_bf16 v185, v15, s[28:31], s50 offen offset:1280
    buffer_atomic_pk_add_bf16 v186, v15, s[28:31], s50 offen offset:1536
    buffer_atomic_pk_add_bf16 v187, v15, s[28:31], s50 offen offset:1792
    s_mul_i32 s53, s40, 4096
    s_add_u32 s53, s53, 163840
    s_lshl_b32 s50, s52, 7
    s_add_u32 s50, s50, s53
    s_mov_b64 s[46:47], exec
    s_mov_b32 exec_lo, 0xffffffff
    s_mov_b32 exec_hi, 0x0
    buffer_atomic_add_f32 v164, v15, s[28:31], s50 offen
    s_mov_b64 exec, s[46:47]
L_kvr_186:
    s_branch L_k1_done_183
L_k1_loader_182:
    s_add_u32 m0, s51, 0
    s_nop 0
    buffer_load_dwordx4 v4, s[28:31], s49 offen offset:0 lds
    buffer_load_dwordx4 v4, s[28:31], s49 offen offset:1024 lds
    buffer_load_dwordx4 v4, s[28:31], s49 offen offset:2048 lds
    buffer_load_dwordx4 v4, s[28:31], s49 offen offset:3072 lds
    s_add_u32 s49, s49, 16384
    s_add_u32 m0, s51, 16384
    s_nop 0
    buffer_load_dwordx4 v4, s[28:31], s49 offen offset:0 lds
    buffer_load_dwordx4 v4, s[28:31], s49 offen offset:1024 lds
    buffer_load_dwordx4 v4, s[28:31], s49 offen offset:2048 lds
    buffer_load_dwordx4 v4, s[28:31], s49 offen offset:3072 lds
    s_add_u32 s49, s49, 16384
    s_waitcnt vmcnt(4)
    s_barrier
    s_add_u32 m0, s51, 32768
    s_nop 0
    buffer_load_dwordx4 v4, s[28:31], s49 offen offset:0 lds
    buffer_load_dwordx4 v4, s[28:31], s49 offen offset:1024 lds
    buffer_load_dwordx4 v4, s[28:31], s49 offen offset:2048 lds
    buffer_load_dwordx4 v4, s[28:31], s49 offen offset:3072 lds
    s_add_u32 s49, s49, 16384
    s_add_u32 m0, s51, 49152
    s_nop 0
    buffer_load_dwordx4 v4, s[28:31], s49 offen offset:0 lds
    buffer_load_dwordx4 v4, s[28:31], s49 offen offset:1024 lds
    buffer_load_dwordx4 v4, s[28:31], s49 offen offset:2048 lds
    buffer_load_dwordx4 v4, s[28:31], s49 offen offset:3072 lds
    s_add_u32 s49, s49, 16384
    s_waitcnt vmcnt(8)
    s_barrier
    s_add_u32 m0, s51, 0
    s_nop 0
    buffer_load_dwordx4 v4, s[28:31], s49 offen offset:0 lds
    buffer_load_dwordx4 v4, s[28:31], s49 offen offset:1024 lds
    buffer_load_dwordx4 v4, s[28:31], s49 offen offset:2048 lds
    buffer_load_dwordx4 v4, s[28:31], s49 offen offset:3072 lds
    s_add_u32 s49, s49, 16384
    s_add_u32 m0, s52, 0
    s_add_u32 s53, s50, 4096
    buffer_load_dwordx4 v4, s[28:31], s50 offen offset:0 lds
    buffer_load_dwordx4 v4, s[28:31], s50 offen offset:1024 lds
    buffer_load_dwordx4 v4, s[28:31], s50 offen offset:2048 lds
    buffer_load_dwordx4 v4, s[28:31], s50 offen offset:3072 lds
    s_add_u32 m0, s52, 4096
    s_add_u32 s50, s50, 24576
    buffer_load_dwordx4 v4, s[28:31], s53 offen offset:0 lds
    buffer_load_dwordx4 v4, s[28:31], s53 offen offset:1024 lds
    s_waitcnt vmcnt(14)
    s_barrier
    s_add_u32 m0, s51, 16384
    s_nop 0
    buffer_load_dwordx4 v4, s[28:31], s49 offen offset:0 lds
    buffer_load_dwordx4 v4, s[28:31], s49 offen offset:1024 lds
    buffer_load_dwordx4 v4, s[28:31], s49 offen offset:2048 lds
    buffer_load_dwordx4 v4, s[28:31], s49 offen offset:3072 lds
    s_add_u32 s49, s49, 16384
    s_add_u32 m0, s52, 24576
    s_add_u32 s53, s50, 4096
    buffer_load_dwordx4 v4, s[28:31], s50 offen offset:0 lds
    buffer_load_dwordx4 v4, s[28:31], s50 offen offset:1024 lds
    buffer_load_dwordx4 v4, s[28:31], s50 offen offset:2048 lds
    buffer_load_dwordx4 v4, s[28:31], s50 offen offset:3072 lds
    s_add_u32 m0, s52, 28672
    s_add_u32 s50, s50, 24576
    buffer_load_dwordx4 v4, s[28:31], s53 offen offset:0 lds
    buffer_load_dwordx4 v4, s[28:31], s53 offen offset:1024 lds
    s_waitcnt vmcnt(20)
    s_barrier
    s_add_u32 m0, s51, 32768
    s_nop 0
    buffer_load_dwordx4 v4, s[28:31], s49 offen offset:0 lds
    buffer_load_dwordx4 v4, s[28:31], s49 offen offset:1024 lds
    buffer_load_dwordx4 v4, s[28:31], s49 offen offset:2048 lds
    buffer_load_dwordx4 v4, s[28:31], s49 offen offset:3072 lds
    s_add_u32 s49, s49, 16384
    s_add_u32 m0, s52, 49152
    s_add_u32 s53, s50, 4096
    buffer_load_dwordx4 v4, s[28:31], s50 offen offset:0 lds
    buffer_load_dwordx4 v4, s[28:31], s50 offen offset:1024 lds
    buffer_load_dwordx4 v4, s[28:31], s50 offen offset:2048 lds
    buffer_load_dwordx4 v4, s[28:31], s50 offen offset:3072 lds
    s_add_u32 m0, s52, 53248
    s_add_u32 s50, s50, 24576
    buffer_load_dwordx4 v4, s[28:31], s53 offen offset:0 lds
    buffer_load_dwordx4 v4, s[28:31], s53 offen offset:1024 lds
    s_waitcnt vmcnt(20)
    s_barrier
    s_add_u32 m0, s51, 49152
    s_nop 0
    buffer_load_dwordx4 v4, s[28:31], s49 offen offset:0 lds
    buffer_load_dwordx4 v4, s[28:31], s49 offen offset:1024 lds
    buffer_load_dwordx4 v4, s[28:31], s49 offen offset:2048 lds
    buffer_load_dwordx4 v4, s[28:31], s49 offen offset:3072 lds
    s_add_u32 s49, s49, 16384
    s_add_u32 m0, s52, 73728
    s_add_u32 s53, s50, 4096
    buffer_load_dwordx4 v4, s[28:31], s50 offen offset:0 lds
    buffer_load_dwordx4 v4, s[28:31], s50 offen offset:1024 lds
    buffer_load_dwordx4 v4, s[28:31], s50 offen offset:2048 lds
    buffer_load_dwordx4 v4, s[28:31], s50 offen offset:3072 lds
    s_add_u32 m0, s52, 77824
    s_add_u32 s50, s50, 24576
    buffer_load_dwordx4 v4, s[28:31], s53 offen offset:0 lds
    buffer_load_dwordx4 v4, s[28:31], s53 offen offset:1024 lds
    s_mov_b32 s55, 2
L_k1l_187:
    s_waitcnt vmcnt(20)
    s_barrier
    s_add_u32 m0, s51, 0
    s_nop 0
    buffer_load_dwordx4 v4, s[28:31], s49 offen offset:0 lds
    buffer_load_dwordx4 v4, s[28:31], s49 offen offset:1024 lds
    buffer_load_dwordx4 v4, s[28:31], s49 offen offset:2048 lds
    buffer_load_dwordx4 v4, s[28:31], s49 offen offset:3072 lds
    s_add_u32 s49, s49, 16384
    s_add_u32 m0, s52, 0
    s_add_u32 s53, s50, 4096
    buffer_load_dwordx4 v4, s[28:31], s50 offen offset:0 lds
    buffer_load_dwordx4 v4, s[28:31], s50 offen offset:1024 lds
    buffer_load_dwordx4 v4, s[28:31], s50 offen offset:2048 lds
    buffer_load_dwordx4 v4, s[28:31], s50 offen offset:3072 lds
    s_add_u32 m0, s52, 4096
    s_add_u32 s50, s50, 24576
    buffer_load_dwordx4 v4, s[28:31], s53 offen offset:0 lds
    buffer_load_dwordx4 v4, s[28:31], s53 offen offset:1024 lds
    s_waitcnt vmcnt(20)
    s_barrier
    s_add_u32 m0, s51, 16384
    s_nop 0
    buffer_load_dwordx4 v4, s[28:31], s49 offen offset:0 lds
    buffer_load_dwordx4 v4, s[28:31], s49 offen offset:1024 lds
    buffer_load_dwordx4 v4, s[28:31], s49 offen offset:2048 lds
    buffer_load_dwordx4 v4, s[28:31], s49 offen offset:3072 lds
    s_add_u32 s49, s49, 16384
    s_add_u32 m0, s52, 24576
    s_add_u32 s53, s50, 4096
    buffer_load_dwordx4 v4, s[28:31], s50 offen offset:0 lds
    buffer_load_dwordx4 v4, s[28:31], s50 offen offset:1024 lds
    buffer_load_dwordx4 v4, s[28:31], s50 offen offset:2048 lds
    buffer_load_dwordx4 v4, s[28:31], s50 offen offset:3072 lds
    s_add_u32 m0, s52, 28672
    s_add_u32 s50, s50, 24576
    buffer_load_dwordx4 v4, s[28:31], s53 offen offset:0 lds
    buffer_load_dwordx4 v4, s[28:31], s53 offen offset:1024 lds
    s_waitcnt vmcnt(20)
    s_barrier
    s_add_u32 m0, s51, 32768
    s_nop 0
    buffer_load_dwordx4 v4, s[28:31], s49 offen offset:0 lds
    buffer_load_dwordx4 v4, s[28:31], s49 offen offset:1024 lds
    buffer_load_dwordx4 v4, s[28:31], s49 offen offset:2048 lds
    buffer_load_dwordx4 v4, s[28:31], s49 offen offset:3072 lds
    s_add_u32 s49, s49, 16384
    s_add_u32 m0, s52, 49152
    s_add_u32 s53, s50, 4096
    buffer_load_dwordx4 v4, s[28:31], s50 offen offset:0 lds
    buffer_load_dwordx4 v4, s[28:31], s50 offen offset:1024 lds
    buffer_load_dwordx4 v4, s[28:31], s50 offen offset:2048 lds
    buffer_load_dwordx4 v4, s[28:31], s50 offen offset:3072 lds
    s_add_u32 m0, s52, 53248
    s_add_u32 s50, s50, 24576
    buffer_load_dwordx4 v4, s[28:31], s53 offen offset:0 lds
    buffer_load_dwordx4 v4, s[28:31], s53 offen offset:1024 lds
    s_waitcnt vmcnt(20)
    s_barrier
    s_add_u32 m0, s51, 49152
    s_nop 0
    buffer_load_dwordx4 v4, s[28:31], s49 offen offset:0 lds
    buffer_load_dwordx4 v4, s[28:31], s49 offen offset:1024 lds
    buffer_load_dwordx4 v4, s[28:31], s49 offen offset:2048 lds
    buffer_load_dwordx4 v4, s[28:31], s49 offen offset:3072 lds
    s_add_u32 s49, s49, 16384
    s_add_u32 m0, s52, 73728
    s_add_u32 s53, s50, 4096
    buffer_load_dwordx4 v4, s[28:31], s50 offen offset:0 lds
    buffer_load_dwordx4 v4, s[28:31], s50 offen offset:1024 lds
    buffer_load_dwordx4 v4, s[28:31], s50 offen offset:2048 lds
    buffer_load_dwordx4 v4, s[28:31], s50 offen offset:3072 lds
    s_add_u32 m0, s52, 77824
    s_add_u32 s50, s50, 24576
    buffer_load_dwordx4 v4, s[28:31], s53 offen offset:0 lds
    buffer_load_dwordx4 v4, s[28:31], s53 offen offset:1024 lds
    s_sub_u32 s55, s55, 1
    s_cmp_lg_u32 s55, 0
    s_cbranch_scc1 L_k1l_187
    s_waitcnt vmcnt(20)
    s_barrier
    s_waitcnt vmcnt(10)
    s_barrier
    s_waitcnt vmcnt(0)
    s_barrier
    s_barrier
    s_sub_u32 s50, s3, 4
    s_lshr_b32 s48, s50, 1
    s_and_b32 s49, s50, 1
    v_lshlrev_b32 v14, 4, v1
    s_lshl_b32 s51, s50, 13
    s_add_u32 s51, s51, 65536
    v_add_u32 v9, s51, v14
    ds_read_b128 v[16:19], v9 offset:0
    ds_read_b128 v[20:23], v9 offset:1024
    ds_read_b128 v[24:27], v9 offset:2048
    ds_read_b128 v[28:31], v9 offset:3072
    ds_read_b128 v[32:35], v9 offset:4096
    ds_read_b128 v[36:39], v9 offset:5120
    ds_read_b128 v[40:43], v9 offset:6144
    ds_read_b128 v[44:47], v9 offset:7168
    s_mov_b32 s68, 1069066811
    s_mov_b32 s69, 1069066811
    v_mov_b32 v10, 0x358637bd
    v_mov_b32 v11, 0x358637bd
    s_lshl_b32 s52, s43, 1
    s_add_u32 s52, s52, s49
    s_lshl_b32 s50, s42, 1
    s_add_u32 s50, s50, s48
    s_lshl_b32 s50, s50, 5
    s_add_u32 s50, s50, s52
    s_lshl_b32 s50, s50, 12
    s_mul_i32 s53, s40, 4194304
    s_add_u32 s53, s53, 1048576
    s_add_u32 s50, s50, s53
    s_waitcnt lgkmcnt(0)
    v_pk_mul_f32 v[12:13], v[16:17], s[68:69]
    v_pk_add_f32 v[16:17], v[16:17], v[10:11]
    v_exp_f32 v12, v12 clamp
    v_exp_f32 v13, v13 clamp
    v_max_f32 v16, v16, v11
    v_max_f32 v17, v17, v11
    v_pk_add_f32 v[16:17], v[16:17], v[12:13]
    v_cvt_pk_bf16_f32 v64, v16, v17
    v_pk_mul_f32 v[2:3], v[18:19], s[68:69]
    v_pk_add_f32 v[18:19], v[18:19], v[10:11]
    v_exp_f32 v2, v2 clamp
    v_exp_f32 v3, v3 clamp
    v_max_f32 v18, v18, v11
    v_max_f32 v19, v19, v11
    v_pk_add_f32 v[18:19], v[18:19], v[2:3]
    v_cvt_pk_bf16_f32 v65, v18, v19
    v_pk_mul_f32 v[12:13], v[32:33], s[68:69]
    v_pk_add_f32 v[32:33], v[32:33], v[10:11]
    v_exp_f32 v12, v12 clamp
    v_exp_f32 v13, v13 clamp
    v_max_f32 v32, v32, v11
    v_max_f32 v33, v33, v11
    v_pk_add_f32 v[32:33], v[32:33], v[12:13]
    v_cvt_pk_bf16_f32 v66, v32, v33
    v_pk_mul_f32 v[2:3], v[34:35], s[68:69]
    v_pk_add_f32 v[34:35], v[34:35], v[10:11]
    v_exp_f32 v2, v2 clamp
    v_exp_f32 v3, v3 clamp
    v_max_f32 v34, v34, v11
    v_max_f32 v35, v35, v11
    v_pk_add_f32 v[34:35], v[34:35], v[2:3]
    v_cvt_pk_bf16_f32 v67, v34, v35
    buffer_store_dwordx4 v[64:67], v14, s[28:31], s50 offen offset:0 sc1
    v_pk_mul_f32 v[12:13], v[20:21], s[68:69]
    v_pk_add_f32 v[20:21], v[20:21], v[10:11]
    v_exp_f32 v12, v12 clamp
    v_exp_f32 v13, v13 clamp
    v_max_f32 v20, v20, v11
    v_max_f32 v21, v21, v11
    v_pk_add_f32 v[20:21], v[20:21], v[12:13]
    v_cvt_pk_bf16_f32 v68, v20, v21
    v_pk_mul_f32 v[2:3], v[22:23], s[68:69]
    v_pk_add_f32 v[22:23], v[22:23], v[10:11]
    v_exp_f32 v2, v2 clamp
    v_exp_f32 v3, v3 clamp
    v_max_f32 v22, v22, v11
    v_max_f32 v23, v23, v11
    v_pk_add_f32 v[22:23], v[22:23], v[2:3]
    v_cvt_pk_bf16_f32 v69, v22, v23
    v_pk_mul_f32 v[12:13], v[36:37], s[68:69]
    v_pk_add_f32 v[36:37], v[36:37], v[10:11]
    v_exp_f32 v12, v12 clamp
    v_exp_f32 v13, v13 clamp
    v_max_f32 v36, v36, v11
    v_max_f32 v37, v37, v11
    v_pk_add_f32 v[36:37], v[36:37], v[12:13]
    v_cvt_pk_bf16_f32 v70, v36, v37
    v_pk_mul_f32 v[2:3], v[38:39], s[68:69]
    v_pk_add_f32 v[38:39], v[38:39], v[10:11]
    v_exp_f32 v2, v2 clamp
    v_exp_f32 v3, v3 clamp
    v_max_f32 v38, v38, v11
    v_max_f32 v39, v39, v11
    v_pk_add_f32 v[38:39], v[38:39], v[2:3]
    v_cvt_pk_bf16_f32 v71, v38, v39
    buffer_store_dwordx4 v[68:71], v14, s[28:31], s50 offen offset:1024 sc1
    v_pk_mul_f32 v[12:13], v[24:25], s[68:69]
    v_pk_add_f32 v[24:25], v[24:25], v[10:11]
    v_exp_f32 v12, v12 clamp
    v_exp_f32 v13, v13 clamp
    v_max_f32 v24, v24, v11
    v_max_f32 v25, v25, v11
    v_pk_add_f32 v[24:25], v[24:25], v[12:13]
    v_cvt_pk_bf16_f32 v72, v24, v25
    v_pk_mul_f32 v[2:3], v[26:27], s[68:69]
    v_pk_add_f32 v[26:27], v[26:27], v[10:11]
    v_exp_f32 v2, v2 clamp
    v_exp_f32 v3, v3 clamp
    v_max_f32 v26, v26, v11
    v_max_f32 v27, v27, v11
    v_pk_add_f32 v[26:27], v[26:27], v[2:3]
    v_cvt_pk_bf16_f32 v73, v26, v27
    v_pk_mul_f32 v[12:13], v[40:41], s[68:69]
    v_pk_add_f32 v[40:41], v[40:41], v[10:11]
    v_exp_f32 v12, v12 clamp
    v_exp_f32 v13, v13 clamp
    v_max_f32 v40, v40, v11
    v_max_f32 v41, v41, v11
    v_pk_add_f32 v[40:41], v[40:41], v[12:13]
    v_cvt_pk_bf16_f32 v74, v40, v41
    v_pk_mul_f32 v[2:3], v[42:43], s[68:69]
    v_pk_add_f32 v[42:43], v[42:43], v[10:11]
    v_exp_f32 v2, v2 clamp
    v_exp_f32 v3, v3 clamp
    v_max_f32 v42, v42, v11
    v_max_f32 v43, v43, v11
    v_pk_add_f32 v[42:43], v[42:43], v[2:3]
    v_cvt_pk_bf16_f32 v75, v42, v43
    buffer_store_dwordx4 v[72:75], v14, s[28:31], s50 offen offset:2048 sc1
    s_barrier
    v_pk_mul_f32 v[12:13], v[28:29], s[68:69]
    v_pk_add_f32 v[28:29], v[28:29], v[10:11]
    v_exp_f32 v12, v12 clamp
    v_exp_f32 v13, v13 clamp
    v_max_f32 v28, v28, v11
    v_max_f32 v29, v29, v11
    v_pk_add_f32 v[28:29], v[28:29], v[12:13]
    v_cvt_pk_bf16_f32 v76, v28, v29
    v_pk_mul_f32 v[2:3], v[30:31], s[68:69]
    v_pk_add_f32 v[30:31], v[30:31], v[10:11]
    v_exp_f32 v2, v2 clamp
    v_exp_f32 v3, v3 clamp
    v_max_f32 v30, v30, v11
    v_max_f32 v31, v31, v11
    v_pk_add_f32 v[30:31], v[30:31], v[2:3]
    v_cvt_pk_bf16_f32 v77, v30, v31
    v_pk_mul_f32 v[12:13], v[44:45], s[68:69]
    v_pk_add_f32 v[44:45], v[44:45], v[10:11]
    v_exp_f32 v12, v12 clamp
    v_exp_f32 v13, v13 clamp
    v_max_f32 v44, v44, v11
    v_max_f32 v45, v45, v11
    v_pk_add_f32 v[44:45], v[44:45], v[12:13]
    v_cvt_pk_bf16_f32 v78, v44, v45
    v_pk_mul_f32 v[2:3], v[46:47], s[68:69]
    v_pk_add_f32 v[46:47], v[46:47], v[10:11]
    v_exp_f32 v2, v2 clamp
    v_exp_f32 v3, v3 clamp
    v_max_f32 v46, v46, v11
    v_max_f32 v47, v47, v11
    v_pk_add_f32 v[46:47], v[46:47], v[2:3]
    v_cvt_pk_bf16_f32 v79, v46, v47
    buffer_store_dwordx4 v[76:79], v14, s[28:31], s50 offen offset:3072 sc1
L_k1_done_183:
    s_branch L_after_k1
L_fin:
    s_waitcnt vmcnt(0)
L_exit:
    s_endpgm
L_code_end:
.set CODE_BYTES, L_code_end-interleave_layers__linear_attn_block__spectral_fnet__prompt_kernel
.section .rodata,"a"
.p2align 6
.amdhsa_kernel interleave_layers__linear_attn_block__spectral_fnet__prompt_kernel
  .amdhsa_next_free_vgpr 256
  .amdhsa_next_free_sgpr 102
  .amdhsa_accum_offset 256
  .amdhsa_group_segment_fixed_size 0
  .amdhsa_kernarg_size 88
  .amdhsa_user_sgpr_count 2
  .amdhsa_user_sgpr_kernarg_segment_ptr 1
  .amdhsa_system_sgpr_workgroup_id_x 1
  .amdhsa_float_denorm_mode_32 3
  .amdhsa_float_denorm_mode_16_64 3
.end_amdhsa_kernel
```
